```python
import torch

def _softmax(x, axis=-1):
    return torch.softmax(x, dim=axis)
def _gelu(x):
    return torch.nn.functional.gelu(x, approximate="tanh")
def _silu(x):
    return torch.nn.functional.silu(x)
def _sigmoid(x):
    return torch.sigmoid(x)
def _layernorm(x, axis=-1, eps=1e-5):
    m = x.mean(dim=axis, keepdim=True)
    v = x.var(dim=axis, keepdim=True, unbiased=False)
    return (x - m) / torch.sqrt(v + eps)
def _scatter_add(tgt, idx, src, axis=0):
    return tgt.clone().index_add_(axis, idx, src)
def _segment_sum(src, seg, n):
    out = torch.zeros((n,) + src.shape[1:], dtype=src.dtype)
    return out.index_add_(0, seg, src)
def _pad(x, pw):
    flat = tuple(v for pair in reversed(pw) for v in pair)
    return torch.nn.functional.pad(x, flat)

kernel_name = 'parallel_sum__softmax_full_mha__geglu_ffn__prompt'

def setup_inputs():

    _w = (lambda a: (lambda t: t.to(torch.bfloat16) if t.is_floating_point() else t)(torch.as_tensor(a)))
    def _A_setup():
        B, S, D = 1, 2048, 640
        return {
            "x": _w((lambda *s: torch.randn(*s, dtype=torch.bfloat16) * 0.05)(B, S, D)),
            "wqkv": _w((lambda *s: torch.randn(*s, dtype=torch.bfloat16) * 0.2)(D, 3 * D)),
            "wo": _w((lambda *s: torch.randn(*s, dtype=torch.bfloat16) * 0.1)(D, D)),
        }
    _A_in = _A_setup()

    def _B_setup():
        B, S, D, F = 1, 2048, 640, 1728
        return {
            "x": _w((lambda *s: torch.randn(*s, dtype=torch.bfloat16) * 0.05)(B, S, D)),
            "w_gate": _w((lambda *s: torch.randn(*s, dtype=torch.bfloat16) * 0.1)(D, F)),
            "w_up": _w((lambda *s: torch.randn(*s, dtype=torch.bfloat16) * 0.1)(D, F)),
            "w_down": _w((lambda *s: torch.randn(*s, dtype=torch.bfloat16) * 0.1)(F, D)),
        }
    _B_in = _B_setup()

    return {
        "A_x": _A_in["x"],
        "A_wqkv": _A_in["wqkv"],
        "A_wo": _A_in["wo"],
        "B_x": _B_in["x"],
        "B_w_gate": _B_in["w_gate"],
        "B_w_up": _B_in["w_up"],
        "B_w_down": _B_in["w_down"],
    }

def reference(A_x, A_wqkv, A_wo, B_x, B_w_gate, B_w_up, B_w_down):
    def _A_ref(x, wqkv, wo):
        B, S, D = x.shape
        H = 32; Dh = D // H
        qkv = (lambda x, *d: x.permute(*d))((x @ wqkv).reshape(B, S, 3, H, Dh), 2, 0, 3, 1, 4)
        q, k, v = qkv[0], qkv[1], qkv[2]
        scale = Dh ** -0.5
        scores = torch.einsum("bhqd,bhkd->bhqk", q, k) * scale
        p = _softmax(scores, axis=-1)
        o = torch.einsum("bhqk,bhkd->bhqd", p, v)
        return (lambda x, *d: x.permute(*d))(o, 0, 2, 1, 3).reshape(B, S, D) @ wo

    def _B_ref(x, w_gate, w_up, w_down):
        return (_gelu(x @ w_gate) * (x @ w_up)) @ w_down

    x = A_x
    xn = _layernorm(x, axis=-1)
    return x + _A_ref(xn, A_wqkv, A_wo) + _B_ref(xn, B_w_gate, B_w_up, B_w_down)
```

```asm
; @launch grid=(512,1,1) block=(256,1,1) lds=81920
.amdgcn_target "amdgcn-amd-amdhsa--gfx950"
.text
.globl parallel_sum__softmax_full_mha__geglu_ffn__prompt_kernel
.p2align 12
.p2align 8
.type parallel_sum__softmax_full_mha__geglu_ffn__prompt_kernel,@function
parallel_sum__softmax_full_mha__geglu_ffn__prompt_kernel:
    s_cmp_ge_u32 s2, 512
    s_cbranch_scc1 L_exit
    s_load_dwordx16 s[4:19], s[0:1], 0
    s_load_dwordx4 s[20:23], s[0:1], 64
    s_memrealtime s[44:45]
    v_lshrrev_b32 v1, 6, v0
    s_and_b32 s47, s2, 255
    v_readfirstlane_b32 s46, v1
    s_cmp_ge_u32 s2, 256
    s_cbranch_scc1 L_roleB
    s_setprio 2
    s_bfe_u32 s56, s47, 0x20001
    s_mul_i32 s56, s56, 30
    s_lshr_b32 s57, s47, 3
    s_add_u32 s56, s56, s57
    s_lshr_b32 s49, s56, 3
    s_and_b32 s56, s56, 7
    s_and_b32 s57, s47, 1
    s_lshl_b32 s57, s57, 3
    s_add_u32 s48, s56, s57
    s_lshl_b32 s55, s48, 2
    s_add_u32 s55, s55, s46
    v_and_b32 v1, 63, v0
    v_lshrrev_b32 v2, 5, v1
    v_and_b32 v3, 31, v1
    s_lshl_b32 s53, s46, 13
    s_add_u32 s53, s53, 32768
    s_lshl_b32 s54, s46, 11
    s_mul_i32 s56, s55, 40960
    v_lshrrev_b32 v23, 3, v1
    v_mul_u32_u24 v24, 1280, v23
    v_add_u32 v24, s56, v24
    v_lshrrev_b32 v23, 1, v23
    v_xor_b32 v23, v23, v1
    v_and_b32 v23, 7, v23
    v_lshl_add_u32 v6, v23, 4, v24
    v_xor_b32 v7, 64, v6
    v_add_u32 v7, 10240, v7
    v_add_u32 v8, 20480, v6
    v_add_u32 v9, 20480, v7
    s_mul_i32 s56, s46, 30720
    s_lshl_b32 s57, s49, 8
    s_add_u32 s56, s56, s57
    v_lshrrev_b32 v23, 4, v1
    v_mul_u32_u24 v24, 3840, v23
    v_add_u32 v24, s56, v24
    v_lshlrev_b32 v23, 2, v23
    v_xor_b32 v23, v23, v1
    v_and_b32 v23, 15, v23
    v_lshl_add_u32 v10, v23, 4, v24
    v_add_u32 v11, 15360, v10
    s_and_b32 s56, s48, 7
    s_mul_i32 s56, s56, 5
    s_lshr_b32 s56, s56, 2
    s_mul_i32 s57, s49, 3
    s_add_u32 s56, s56, s57
    s_mul_i32 s57, s56, 6554
    s_lshr_b32 s57, s57, 16
    s_mul_i32 s57, s57, 10
    s_sub_u32 s56, s56, s57
    s_lshl_b32 s50, s56, 7
    s_mul_i32 s51, s56, 245760
    s_waitcnt lgkmcnt(0)
    s_mov_b32 s24, s22
    s_and_b32 s25, s23, 0xffff
    s_mov_b32 s26, 0x4000000
    s_mov_b32 s27, 0x00020000
    s_mov_b32 s28, s20
    s_and_b32 s29, s21, 0xffff
    s_mov_b32 s30, 0x100
    s_mov_b32 s31, 0x00020000
    s_mov_b32 s95, s44
    s_or_b32 s56, s2, s46
    s_cmp_lg_u32 s56, 0
    s_cbranch_scc1 L_notag
    s_or_b32 s44, s44, 1
    v_mov_b32 v104, s44
    v_mov_b32 v105, s45
    v_mov_b32 v106, 0
    s_mov_b64 exec, 1
    buffer_store_dwordx2 v[104:105], v106, s[28:31], 0 offen sc1
    buffer_store_dwordx2 v[104:105], v106, s[28:31], 0 offen offset:128 sc1
    s_mov_b64 exec, -1
L_notag:
    s_cmp_ge_u32 s47, 240
    s_cbranch_scc1 L_noqkv
    s_mov_b32 s32, s4
    s_and_b32 s33, s5, 0xffff
    s_mov_b32 s34, 0x280000
    s_mov_b32 s35, 0x00020000
    s_mov_b32 s36, s6
    s_and_b32 s37, s7, 0xffff
    s_mov_b32 s38, 0x258000
    s_mov_b32 s39, 0x00020000
    s_add_u32 m0, s53, 0
    s_nop 0
    buffer_load_dwordx4 v6, s[32:35], s50 offen lds
    s_add_u32 m0, s54, 0
    s_nop 0
    buffer_load_dwordx4 v10, s[36:39], s51 offen lds
    s_lshl_b32 s56, s55, 9
    s_add_u32 s56, s56, 0x1c00000
    v_lshlrev_b32 v23, 4, v3
    v_add_u32 v5, s56, v23
    v_mov_b32 v4, 0
    v_bfe_u32 v23, v3, 1, 3
    v_xor_b32 v23, v23, v2
    v_lshlrev_b32 v24, 7, v3
    v_add_u32 v24, s53, v24
    v_lshl_add_u32 v12, v23, 4, v24
    v_xor_b32 v13, 32, v12
    v_xor_b32 v14, 64, v12
    v_xor_b32 v15, 96, v12
    v_bfe_u32 v23, v1, 2, 2
    v_lshl_add_u32 v24, v2, 3, v23
    v_lshlrev_b32 v24, 8, v24
    v_lshl_add_u32 v24, v23, 6, v24
    v_bfe_u32 v23, v1, 4, 1
    v_lshl_add_u32 v24, v23, 5, v24
    v_and_b32 v23, 3, v1
    v_lshl_add_u32 v16, v23, 3, v24
    v_xor_b32 v17, 64, v16
    v_xor_b32 v18, 128, v16
    v_xor_b32 v19, 192, v16
    s_lshl_b32 s56, s49, 12
    s_add_u32 s56, s56, 0x1c10000
    v_lshlrev_b32 v23, 5, v3
    v_add_u32 v22, s56, v23
    s_lshl_b32 s56, s46, 7
    s_add_u32 s56, s56, 0x10000
    v_lshlrev_b32 v23, 2, v3
    v_add_u32 v20, s56, v23
    v_lshlrev_b32 v23, 4, v2
    v_add_u32 v21, s56, v23
    v_mov_b32 v70, 0
    v_mov_b32 v71, 0
    v_mov_b32 v74, 0
    v_mov_b32 v75, 0
    v_mov_b32 v78, 0
    v_mov_b32 v79, 0
    v_mov_b32 v82, 0
    v_mov_b32 v83, 0
    v_mov_b32 v86, 0
    v_mov_b32 v87, 0
    s_cmp_eq_u32 s46, 0
    s_cselect_b32 s62, 7, 99
    s_cmp_ge_u32 s49, 10
    s_cbranch_scc1 L_qkv_v
    s_add_u32 m0, s53, 1024
    s_nop 0
    buffer_load_dwordx4 v7, s[32:35], s50 offen lds
    s_add_u32 m0, s54, 1024
    s_nop 0
    buffer_load_dwordx4 v11, s[36:39], s51 offen lds
    s_add_u32 s51, s51, 122880
    s_cmp_eq_u32 s51, 2457600
    s_cselect_b32 s51, 0, s51
    s_add_u32 m0, s53, 2048
    s_nop 0
    buffer_load_dwordx4 v8, s[32:35], s50 offen lds
    s_add_u32 m0, s53, 3072
    s_nop 0
    buffer_load_dwordx4 v9, s[32:35], s50 offen lds
    s_add_u32 s50, s50, 128
    s_cmp_eq_u32 s50, 1280
    s_cselect_b32 s50, 0, s50
    s_add_u32 m0, s54, 8192
    s_nop 0
    buffer_load_dwordx4 v10, s[36:39], s51 offen lds
    s_add_u32 m0, s54, 9216
    s_nop 0
    buffer_load_dwordx4 v11, s[36:39], s51 offen lds
    s_add_u32 s51, s51, 122880
    s_cmp_eq_u32 s51, 2457600
    s_cselect_b32 s51, 0, s51
    s_add_u32 m0, s53, 4096
    s_nop 0
    buffer_load_dwordx4 v6, s[32:35], s50 offen lds
    s_add_u32 m0, s53, 5120
    s_nop 0
    buffer_load_dwordx4 v7, s[32:35], s50 offen lds
    s_add_u32 m0, s54, 16384
    s_nop 0
    buffer_load_dwordx4 v10, s[36:39], s51 offen lds
    s_add_u32 m0, s54, 17408
    s_nop 0
    buffer_load_dwordx4 v11, s[36:39], s51 offen lds
    s_add_u32 s51, s51, 122880
    s_cmp_eq_u32 s51, 2457600
    s_cselect_b32 s51, 0, s51
    s_add_u32 m0, s53, 6144
    s_nop 0
    buffer_load_dwordx4 v8, s[32:35], s50 offen lds
    s_add_u32 m0, s53, 7168
    s_nop 0
    buffer_load_dwordx4 v9, s[32:35], s50 offen lds
    s_add_u32 s50, s50, 128
    s_cmp_eq_u32 s50, 1280
    s_cselect_b32 s50, 0, s50
    s_add_u32 m0, s54, 24576
    s_nop 0
    buffer_load_dwordx4 v10, s[36:39], s51 offen lds
    s_add_u32 m0, s54, 25600
    s_nop 0
    buffer_load_dwordx4 v11, s[36:39], s51 offen lds
    s_add_u32 s51, s51, 122880
    s_cmp_eq_u32 s51, 2457600
    s_cselect_b32 s51, 0, s51
    v_mov_b32 v168, 0
    v_mov_b32 v169, 0
    v_mov_b32 v170, 0
    v_mov_b32 v171, 0
    v_mov_b32 v172, 0
    v_mov_b32 v173, 0
    v_mov_b32 v174, 0
    v_mov_b32 v175, 0
    v_mov_b32 v176, 0
    v_mov_b32 v177, 0
    v_mov_b32 v178, 0
    v_mov_b32 v179, 0
    v_mov_b32 v180, 0
    v_mov_b32 v181, 0
    v_mov_b32 v182, 0
    v_mov_b32 v183, 0
    v_mov_b32 v184, 0
    v_mov_b32 v185, 0
    v_mov_b32 v186, 0
    v_mov_b32 v187, 0
    v_mov_b32 v188, 0
    v_mov_b32 v189, 0
    v_mov_b32 v190, 0
    v_mov_b32 v191, 0
    v_mov_b32 v192, 0
    v_mov_b32 v193, 0
    v_mov_b32 v194, 0
    v_mov_b32 v195, 0
    v_mov_b32 v196, 0
    v_mov_b32 v197, 0
    v_mov_b32 v198, 0
    v_mov_b32 v199, 0
    v_mov_b32 v200, 0
    v_mov_b32 v201, 0
    v_mov_b32 v202, 0
    v_mov_b32 v203, 0
    v_mov_b32 v204, 0
    v_mov_b32 v205, 0
    v_mov_b32 v206, 0
    v_mov_b32 v207, 0
    v_mov_b32 v208, 0
    v_mov_b32 v209, 0
    v_mov_b32 v210, 0
    v_mov_b32 v211, 0
    v_mov_b32 v212, 0
    v_mov_b32 v213, 0
    v_mov_b32 v214, 0
    v_mov_b32 v215, 0
    v_mov_b32 v216, 0
    v_mov_b32 v217, 0
    v_mov_b32 v218, 0
    v_mov_b32 v219, 0
    v_mov_b32 v220, 0
    v_mov_b32 v221, 0
    v_mov_b32 v222, 0
    v_mov_b32 v223, 0
    v_mov_b32 v224, 0
    v_mov_b32 v225, 0
    v_mov_b32 v226, 0
    v_mov_b32 v227, 0
    v_mov_b32 v228, 0
    v_mov_b32 v229, 0
    v_mov_b32 v230, 0
    v_mov_b32 v231, 0
    s_waitcnt vmcnt(10)
    s_barrier
    ds_read_b128 v[104:107], v12 offset:0
    ds_read_b128 v[108:111], v13 offset:0
    ds_read_b128 v[112:115], v14 offset:0
    ds_read_b128 v[116:119], v15 offset:0
    ds_read_b64_tr_b16 v[136:137], v16 offset:0
    ds_read_b64_tr_b16 v[138:139], v16 offset:1024
    ds_read_b64_tr_b16 v[140:141], v17 offset:0
    ds_read_b64_tr_b16 v[142:143], v17 offset:1024
    ds_read_b64_tr_b16 v[144:145], v18 offset:0
    ds_read_b64_tr_b16 v[146:147], v18 offset:1024
    ds_read_b64_tr_b16 v[148:149], v19 offset:0
    ds_read_b64_tr_b16 v[150:151], v19 offset:1024
    s_mov_b32 s52, 0
.p2align 3
L_qkv_qk_loop:
    s_waitcnt lgkmcnt(6)
    v_mfma_f32_32x32x16_bf16 v[168:183], v[136:139], v[104:107], v[168:183]
    ds_read_b64_tr_b16 v[152:153], v16 offset:4096
    ds_read_b64_tr_b16 v[154:155], v16 offset:5120
    ds_read_b64_tr_b16 v[156:157], v17 offset:4096
    ds_read_b64_tr_b16 v[158:159], v17 offset:5120
    s_waitcnt lgkmcnt(8)
    v_mfma_f32_32x32x16_bf16 v[184:199], v[140:143], v[104:107], v[184:199]
    ds_read_b64_tr_b16 v[160:161], v18 offset:4096
    ds_read_b64_tr_b16 v[162:163], v18 offset:5120
    ds_read_b64_tr_b16 v[164:165], v19 offset:4096
    ds_read_b64_tr_b16 v[166:167], v19 offset:5120
    s_add_u32 m0, s53, 0
    s_nop 0
    buffer_load_dwordx4 v6, s[32:35], s50 offen lds
    s_waitcnt lgkmcnt(10)
    v_mfma_f32_32x32x16_bf16 v[200:215], v[144:147], v[104:107], v[200:215]
    s_add_u32 m0, s53, 1024
    s_nop 0
    buffer_load_dwordx4 v7, s[32:35], s50 offen lds
    s_add_u32 m0, s53, 2048
    s_nop 0
    buffer_load_dwordx4 v8, s[32:35], s50 offen lds
    s_waitcnt lgkmcnt(8)
    v_mfma_f32_32x32x16_bf16 v[216:231], v[148:151], v[104:107], v[216:231]
    s_add_u32 m0, s53, 3072
    s_nop 0
    buffer_load_dwordx4 v9, s[32:35], s50 offen lds
    s_add_u32 s50, s50, 128
    s_cmp_eq_u32 s50, 1280
    s_cselect_b32 s50, 0, s50
    s_waitcnt vmcnt(12) lgkmcnt(0)
    s_barrier
    v_mfma_f32_32x32x16_bf16 v[168:183], v[152:155], v[108:111], v[168:183]
    ds_read_b64_tr_b16 v[136:137], v16 offset:8192
    ds_read_b64_tr_b16 v[138:139], v16 offset:9216
    ds_read_b64_tr_b16 v[140:141], v17 offset:8192
    v_mfma_f32_32x32x16_bf16 v[184:199], v[156:159], v[108:111], v[184:199]
    s_add_u32 m0, s54, 0
    ds_read_b64_tr_b16 v[142:143], v17 offset:9216
    ds_read_b64_tr_b16 v[144:145], v18 offset:8192
    ds_read_b64_tr_b16 v[146:147], v18 offset:9216
    buffer_load_dwordx4 v10, s[36:39], s51 offen lds
    v_mfma_f32_32x32x16_bf16 v[200:215], v[160:163], v[108:111], v[200:215]
    ds_read_b64_tr_b16 v[148:149], v19 offset:8192
    ds_read_b64_tr_b16 v[150:151], v19 offset:9216
    v_mfma_f32_32x32x16_bf16 v[216:231], v[164:167], v[108:111], v[216:231]
    s_add_u32 m0, s54, 1024
    s_nop 0
    buffer_load_dwordx4 v11, s[36:39], s51 offen lds
    s_add_u32 s51, s51, 122880
    s_cmp_eq_u32 s51, 2457600
    s_cselect_b32 s51, 0, s51
    s_waitcnt lgkmcnt(6)
    v_mfma_f32_32x32x16_bf16 v[168:183], v[136:139], v[112:115], v[168:183]
    ds_read_b64_tr_b16 v[152:153], v16 offset:12288
    ds_read_b64_tr_b16 v[154:155], v16 offset:13312
    ds_read_b64_tr_b16 v[156:157], v17 offset:12288
    ds_read_b64_tr_b16 v[158:159], v17 offset:13312
    s_waitcnt lgkmcnt(8)
    v_mfma_f32_32x32x16_bf16 v[184:199], v[140:143], v[112:115], v[184:199]
    ds_read_b64_tr_b16 v[160:161], v18 offset:12288
    ds_read_b64_tr_b16 v[162:163], v18 offset:13312
    ds_read_b64_tr_b16 v[164:165], v19 offset:12288
    ds_read_b64_tr_b16 v[166:167], v19 offset:13312
    s_waitcnt lgkmcnt(10)
    v_mfma_f32_32x32x16_bf16 v[200:215], v[144:147], v[112:115], v[200:215]
    s_waitcnt lgkmcnt(8)
    v_mfma_f32_32x32x16_bf16 v[216:231], v[148:151], v[112:115], v[216:231]
    s_waitcnt vmcnt(8) lgkmcnt(0)
    s_barrier
    v_mfma_f32_32x32x16_bf16 v[168:183], v[152:155], v[116:119], v[168:183]
    ds_read_b128 v[120:123], v12 offset:4096
    ds_read_b128 v[124:127], v13 offset:4096
    ds_read_b128 v[128:131], v14 offset:4096
    ds_read_b128 v[132:135], v15 offset:4096
    v_mfma_f32_32x32x16_bf16 v[184:199], v[156:159], v[116:119], v[184:199]
    s_add_u32 m0, s54, 8192
    ds_read_b64_tr_b16 v[136:137], v16 offset:16384
    ds_read_b64_tr_b16 v[138:139], v16 offset:17408
    ds_read_b64_tr_b16 v[140:141], v17 offset:16384
    ds_read_b64_tr_b16 v[142:143], v17 offset:17408
    buffer_load_dwordx4 v10, s[36:39], s51 offen lds
    v_mfma_f32_32x32x16_bf16 v[200:215], v[160:163], v[116:119], v[200:215]
    ds_read_b64_tr_b16 v[144:145], v18 offset:16384
    ds_read_b64_tr_b16 v[146:147], v18 offset:17408
    ds_read_b64_tr_b16 v[148:149], v19 offset:16384
    ds_read_b64_tr_b16 v[150:151], v19 offset:17408
    v_mfma_f32_32x32x16_bf16 v[216:231], v[164:167], v[116:119], v[216:231]
    s_add_u32 m0, s54, 9216
    s_nop 0
    buffer_load_dwordx4 v11, s[36:39], s51 offen lds
    s_add_u32 s51, s51, 122880
    s_cmp_eq_u32 s51, 2457600
    s_cselect_b32 s51, 0, s51
    s_waitcnt lgkmcnt(6)
    v_mfma_f32_32x32x16_bf16 v[168:183], v[136:139], v[120:123], v[168:183]
    ds_read_b64_tr_b16 v[152:153], v16 offset:20480
    ds_read_b64_tr_b16 v[154:155], v16 offset:21504
    ds_read_b64_tr_b16 v[156:157], v17 offset:20480
    ds_read_b64_tr_b16 v[158:159], v17 offset:21504
    s_waitcnt lgkmcnt(8)
    v_mfma_f32_32x32x16_bf16 v[184:199], v[140:143], v[120:123], v[184:199]
    ds_read_b64_tr_b16 v[160:161], v18 offset:20480
    ds_read_b64_tr_b16 v[162:163], v18 offset:21504
    ds_read_b64_tr_b16 v[164:165], v19 offset:20480
    ds_read_b64_tr_b16 v[166:167], v19 offset:21504
    s_add_u32 m0, s53, 4096
    s_nop 0
    buffer_load_dwordx4 v6, s[32:35], s50 offen lds
    s_waitcnt lgkmcnt(10)
    v_mfma_f32_32x32x16_bf16 v[200:215], v[144:147], v[120:123], v[200:215]
    s_add_u32 m0, s53, 5120
    s_nop 0
    buffer_load_dwordx4 v7, s[32:35], s50 offen lds
    s_add_u32 m0, s53, 6144
    s_nop 0
    buffer_load_dwordx4 v8, s[32:35], s50 offen lds
    s_waitcnt lgkmcnt(8)
    v_mfma_f32_32x32x16_bf16 v[216:231], v[148:151], v[120:123], v[216:231]
    s_add_u32 m0, s53, 7168
    s_nop 0
    buffer_load_dwordx4 v9, s[32:35], s50 offen lds
    s_add_u32 s50, s50, 128
    s_cmp_eq_u32 s50, 1280
    s_cselect_b32 s50, 0, s50
    s_waitcnt vmcnt(12) lgkmcnt(0)
    s_barrier
    v_mfma_f32_32x32x16_bf16 v[168:183], v[152:155], v[124:127], v[168:183]
    ds_read_b64_tr_b16 v[136:137], v16 offset:24576
    ds_read_b64_tr_b16 v[138:139], v16 offset:25600
    ds_read_b64_tr_b16 v[140:141], v17 offset:24576
    v_mfma_f32_32x32x16_bf16 v[184:199], v[156:159], v[124:127], v[184:199]
    s_add_u32 m0, s54, 16384
    ds_read_b64_tr_b16 v[142:143], v17 offset:25600
    ds_read_b64_tr_b16 v[144:145], v18 offset:24576
    ds_read_b64_tr_b16 v[146:147], v18 offset:25600
    buffer_load_dwordx4 v10, s[36:39], s51 offen lds
    v_mfma_f32_32x32x16_bf16 v[200:215], v[160:163], v[124:127], v[200:215]
    ds_read_b64_tr_b16 v[148:149], v19 offset:24576
    ds_read_b64_tr_b16 v[150:151], v19 offset:25600
    v_mfma_f32_32x32x16_bf16 v[216:231], v[164:167], v[124:127], v[216:231]
    s_add_u32 m0, s54, 17408
    s_nop 0
    buffer_load_dwordx4 v11, s[36:39], s51 offen lds
    s_add_u32 s51, s51, 122880
    s_cmp_eq_u32 s51, 2457600
    s_cselect_b32 s51, 0, s51
    s_waitcnt lgkmcnt(6)
    v_mfma_f32_32x32x16_bf16 v[168:183], v[136:139], v[128:131], v[168:183]
    ds_read_b64_tr_b16 v[152:153], v16 offset:28672
    ds_read_b64_tr_b16 v[154:155], v16 offset:29696
    ds_read_b64_tr_b16 v[156:157], v17 offset:28672
    ds_read_b64_tr_b16 v[158:159], v17 offset:29696
    s_waitcnt lgkmcnt(8)
    v_mfma_f32_32x32x16_bf16 v[184:199], v[140:143], v[128:131], v[184:199]
    ds_read_b64_tr_b16 v[160:161], v18 offset:28672
    ds_read_b64_tr_b16 v[162:163], v18 offset:29696
    ds_read_b64_tr_b16 v[164:165], v19 offset:28672
    ds_read_b64_tr_b16 v[166:167], v19 offset:29696
    s_waitcnt lgkmcnt(10)
    v_mfma_f32_32x32x16_bf16 v[200:215], v[144:147], v[128:131], v[200:215]
    s_waitcnt lgkmcnt(8)
    v_mfma_f32_32x32x16_bf16 v[216:231], v[148:151], v[128:131], v[216:231]
    s_waitcnt vmcnt(8) lgkmcnt(0)
    s_barrier
    v_mfma_f32_32x32x16_bf16 v[168:183], v[152:155], v[132:135], v[168:183]
    ds_read_b128 v[104:107], v12 offset:0
    ds_read_b128 v[108:111], v13 offset:0
    ds_read_b128 v[112:115], v14 offset:0
    ds_read_b128 v[116:119], v15 offset:0
    v_mfma_f32_32x32x16_bf16 v[184:199], v[156:159], v[132:135], v[184:199]
    s_add_u32 m0, s54, 24576
    ds_read_b64_tr_b16 v[136:137], v16 offset:0
    ds_read_b64_tr_b16 v[138:139], v16 offset:1024
    ds_read_b64_tr_b16 v[140:141], v17 offset:0
    ds_read_b64_tr_b16 v[142:143], v17 offset:1024
    buffer_load_dwordx4 v10, s[36:39], s51 offen lds
    v_mfma_f32_32x32x16_bf16 v[200:215], v[160:163], v[132:135], v[200:215]
    ds_read_b64_tr_b16 v[144:145], v18 offset:0
    ds_read_b64_tr_b16 v[146:147], v18 offset:1024
    ds_read_b64_tr_b16 v[148:149], v19 offset:0
    ds_read_b64_tr_b16 v[150:151], v19 offset:1024
    v_mfma_f32_32x32x16_bf16 v[216:231], v[164:167], v[132:135], v[216:231]
    s_add_u32 m0, s54, 25600
    s_nop 0
    buffer_load_dwordx4 v11, s[36:39], s51 offen lds
    s_add_u32 s51, s51, 122880
    s_cmp_eq_u32 s51, 2457600
    s_cselect_b32 s51, 0, s51
    s_add_u32 s52, s52, 1
    s_cmp_lt_u32 s52, 4
    s_cbranch_scc1 L_qkv_qk_loop
    s_mov_b32 s32, s12
    s_and_b32 s33, s13, 0xffff
    s_mov_b32 s34, 0x21c000
    s_mov_b32 s35, 0x00020000
    s_mov_b32 s40, s14
    s_and_b32 s41, s15, 0xffff
    s_mov_b32 s42, 0x21c000
    s_mov_b32 s43, 0x00020000
    s_lshr_b32 s56, s47, 3
    s_lshl_b32 s56, s56, 2
    s_add_u32 s56, s56, s46
    s_mul_i32 s56, s56, 3456
    s_bfe_u32 s57, s47, 0x20001
    s_mul_i32 s57, s57, 27
    s_lshr_b32 s57, s57, 2
    s_lshl_b32 s57, s57, 7
    s_add_u32 s56, s56, s57
    v_lshlrev_b32 v26, 4, v1
    s_waitcnt lgkmcnt(6)
    v_mfma_f32_32x32x16_bf16 v[168:183], v[136:139], v[104:107], v[168:183]
    ds_read_b64_tr_b16 v[152:153], v16 offset:4096
    ds_read_b64_tr_b16 v[154:155], v16 offset:5120
    ds_read_b64_tr_b16 v[156:157], v17 offset:4096
    ds_read_b64_tr_b16 v[158:159], v17 offset:5120
    buffer_load_dwordx2 v[32:33], v4, s[28:31], 0 offen sc1
    buffer_load_dwordx4 v[28:31], v5, s[24:27], 0 offen sc1
    buffer_load_dwordx4 v[36:39], v22, s[24:27], 0 offen offset:0 sc1
    s_waitcnt lgkmcnt(8)
    v_mfma_f32_32x32x16_bf16 v[184:199], v[140:143], v[104:107], v[184:199]
    ds_read_b64_tr_b16 v[160:161], v18 offset:4096
    ds_read_b64_tr_b16 v[162:163], v18 offset:5120
    ds_read_b64_tr_b16 v[164:165], v19 offset:4096
    ds_read_b64_tr_b16 v[166:167], v19 offset:5120
    buffer_load_dwordx4 v[40:43], v22, s[24:27], 0 offen offset:16 sc1
    buffer_load_dwordx4 v[44:47], v22, s[24:27], 0 offen offset:1024 sc1
    buffer_load_dwordx4 v[48:51], v22, s[24:27], 0 offen offset:1040 sc1
    s_waitcnt lgkmcnt(10)
    v_mfma_f32_32x32x16_bf16 v[200:215], v[144:147], v[104:107], v[200:215]
    buffer_load_dwordx4 v[52:55], v22, s[24:27], 0 offen offset:2048 sc1
    buffer_load_dwordx4 v[56:59], v22, s[24:27], 0 offen offset:2064 sc1
    buffer_load_dwordx4 v[60:63], v22, s[24:27], 0 offen offset:3072 sc1
    s_waitcnt lgkmcnt(8)
    v_mfma_f32_32x32x16_bf16 v[216:231], v[148:151], v[104:107], v[216:231]
    buffer_load_dwordx4 v[64:67], v22, s[24:27], 0 offen offset:3088 sc1
    s_waitcnt vmcnt(18) lgkmcnt(0)
    s_barrier
    v_mfma_f32_32x32x16_bf16 v[168:183], v[152:155], v[108:111], v[168:183]
    ds_read_b64_tr_b16 v[136:137], v16 offset:8192
    ds_read_b64_tr_b16 v[138:139], v16 offset:9216
    ds_read_b64_tr_b16 v[140:141], v17 offset:8192
    buffer_load_dwordx4 v[232:235], v26, s[32:35], s56 offen
    buffer_load_dwordx4 v[232:235], v26, s[40:43], s56 offen
    s_add_u32 s56, s56, 414720
    v_mfma_f32_32x32x16_bf16 v[184:199], v[156:159], v[108:111], v[184:199]
    ds_read_b64_tr_b16 v[142:143], v17 offset:9216
    ds_read_b64_tr_b16 v[144:145], v18 offset:8192
    ds_read_b64_tr_b16 v[146:147], v18 offset:9216
    buffer_load_dwordx4 v[232:235], v26, s[32:35], s56 offen
    buffer_load_dwordx4 v[232:235], v26, s[40:43], s56 offen
    s_add_u32 s56, s56, 414720
    v_mfma_f32_32x32x16_bf16 v[200:215], v[160:163], v[108:111], v[200:215]
    ds_read_b64_tr_b16 v[148:149], v19 offset:8192
    ds_read_b64_tr_b16 v[150:151], v19 offset:9216
    buffer_load_dwordx4 v[232:235], v26, s[32:35], s56 offen
    buffer_load_dwordx4 v[232:235], v26, s[40:43], s56 offen
    s_add_u32 s56, s56, 414720
    v_mfma_f32_32x32x16_bf16 v[216:231], v[164:167], v[108:111], v[216:231]
    s_waitcnt lgkmcnt(6)
    v_mfma_f32_32x32x16_bf16 v[168:183], v[136:139], v[112:115], v[168:183]
    ds_read_b64_tr_b16 v[152:153], v16 offset:12288
    ds_read_b64_tr_b16 v[154:155], v16 offset:13312
    ds_read_b64_tr_b16 v[156:157], v17 offset:12288
    ds_read_b64_tr_b16 v[158:159], v17 offset:13312
    buffer_load_dwordx4 v[232:235], v26, s[32:35], s56 offen
    buffer_load_dwordx4 v[232:235], v26, s[40:43], s56 offen
    s_add_u32 s56, s56, 414720
    s_waitcnt lgkmcnt(8)
    v_mfma_f32_32x32x16_bf16 v[184:199], v[140:143], v[112:115], v[184:199]
    ds_read_b64_tr_b16 v[160:161], v18 offset:12288
    ds_read_b64_tr_b16 v[162:163], v18 offset:13312
    ds_read_b64_tr_b16 v[164:165], v19 offset:12288
    ds_read_b64_tr_b16 v[166:167], v19 offset:13312
    buffer_load_dwordx4 v[232:235], v26, s[32:35], s56 offen
    buffer_load_dwordx4 v[232:235], v26, s[40:43], s56 offen
    s_add_u32 s56, s56, 414720
    s_waitcnt lgkmcnt(10)
    v_mfma_f32_32x32x16_bf16 v[200:215], v[144:147], v[112:115], v[200:215]
    buffer_load_dwordx4 v[232:235], v26, s[32:35], s56 offen
    buffer_load_dwordx4 v[232:235], v26, s[40:43], s56 offen
    s_add_u32 s56, s56, 414720
    s_waitcnt lgkmcnt(8)
    v_mfma_f32_32x32x16_bf16 v[216:231], v[148:151], v[112:115], v[216:231]
    s_waitcnt vmcnt(24) lgkmcnt(0)
    s_barrier
    v_mfma_f32_32x32x16_bf16 v[168:183], v[152:155], v[116:119], v[168:183]
    ds_read_b128 v[120:123], v12 offset:4096
    ds_read_b128 v[124:127], v13 offset:4096
    ds_read_b128 v[128:131], v14 offset:4096
    ds_read_b128 v[132:135], v15 offset:4096
    v_mfma_f32_32x32x16_bf16 v[184:199], v[156:159], v[116:119], v[184:199]
    ds_read_b64_tr_b16 v[136:137], v16 offset:16384
    ds_read_b64_tr_b16 v[138:139], v16 offset:17408
    ds_read_b64_tr_b16 v[140:141], v17 offset:16384
    ds_read_b64_tr_b16 v[142:143], v17 offset:17408
    v_mfma_f32_32x32x16_bf16 v[200:215], v[160:163], v[116:119], v[200:215]
    ds_read_b64_tr_b16 v[144:145], v18 offset:16384
    ds_read_b64_tr_b16 v[146:147], v18 offset:17408
    ds_read_b64_tr_b16 v[148:149], v19 offset:16384
    ds_read_b64_tr_b16 v[150:151], v19 offset:17408
    v_mfma_f32_32x32x16_bf16 v[216:231], v[164:167], v[116:119], v[216:231]
    s_waitcnt lgkmcnt(6)
    v_mfma_f32_32x32x16_bf16 v[168:183], v[136:139], v[120:123], v[168:183]
    ds_read_b64_tr_b16 v[152:153], v16 offset:20480
    ds_read_b64_tr_b16 v[154:155], v16 offset:21504
    ds_read_b64_tr_b16 v[156:157], v17 offset:20480
    ds_read_b64_tr_b16 v[158:159], v17 offset:21504
    s_waitcnt lgkmcnt(8)
    v_mfma_f32_32x32x16_bf16 v[184:199], v[140:143], v[120:123], v[184:199]
    ds_read_b64_tr_b16 v[160:161], v18 offset:20480
    ds_read_b64_tr_b16 v[162:163], v18 offset:21504
    ds_read_b64_tr_b16 v[164:165], v19 offset:20480
    ds_read_b64_tr_b16 v[166:167], v19 offset:21504
    s_waitcnt lgkmcnt(10)
    v_mfma_f32_32x32x16_bf16 v[200:215], v[144:147], v[120:123], v[200:215]
    s_waitcnt lgkmcnt(8)
    v_mfma_f32_32x32x16_bf16 v[216:231], v[148:151], v[120:123], v[216:231]
    s_waitcnt vmcnt(22) lgkmcnt(0)
    s_barrier
    v_mfma_f32_32x32x16_bf16 v[168:183], v[152:155], v[124:127], v[168:183]
    ds_read_b64_tr_b16 v[136:137], v16 offset:24576
    ds_read_b64_tr_b16 v[138:139], v16 offset:25600
    ds_read_b64_tr_b16 v[140:141], v17 offset:24576
    v_mfma_f32_32x32x16_bf16 v[184:199], v[156:159], v[124:127], v[184:199]
    ds_read_b64_tr_b16 v[142:143], v17 offset:25600
    ds_read_b64_tr_b16 v[144:145], v18 offset:24576
    ds_read_b64_tr_b16 v[146:147], v18 offset:25600
    v_mfma_f32_32x32x16_bf16 v[200:215], v[160:163], v[124:127], v[200:215]
    ds_read_b64_tr_b16 v[148:149], v19 offset:24576
    ds_read_b64_tr_b16 v[150:151], v19 offset:25600
    v_mfma_f32_32x32x16_bf16 v[216:231], v[164:167], v[124:127], v[216:231]
    s_mov_b32 s3, 0
    s_waitcnt vmcnt(12)
    s_branch L_gr_1_b
L_gr_1:
    s_waitcnt vmcnt(0)
L_gr_1_b:
    v_readfirstlane_b32 s44, v32
    v_readfirstlane_b32 s45, v33
    v_xor_b32 v23, v32, v30
    v_xor_b32 v24, v33, v31
    v_or_b32 v23, v23, v24
    v_xor_b32 v24, v32, v37
    v_xor_b32 v25, v32, v39
    v_or3_b32 v23, v23, v24, v25
    v_xor_b32 v24, v32, v41
    v_xor_b32 v25, v32, v43
    v_or3_b32 v23, v23, v24, v25
    v_xor_b32 v24, v32, v45
    v_xor_b32 v25, v32, v47
    v_or3_b32 v23, v23, v24, v25
    v_xor_b32 v24, v32, v49
    v_xor_b32 v25, v32, v51
    v_or3_b32 v23, v23, v24, v25
    v_xor_b32 v24, v32, v53
    v_xor_b32 v25, v32, v55
    v_or3_b32 v23, v23, v24, v25
    v_xor_b32 v24, v32, v57
    v_xor_b32 v25, v32, v59
    v_or3_b32 v23, v23, v24, v25
    v_xor_b32 v24, v32, v61
    v_xor_b32 v25, v32, v63
    v_or3_b32 v23, v23, v24, v25
    v_xor_b32 v24, v32, v65
    v_xor_b32 v25, v32, v67
    v_or3_b32 v23, v23, v24, v25
    v_cmp_ne_u32 vcc, 0, v23
    s_branch L_ps_0_0
L_pw_a0_0:
    s_branch L_pw_a0_1
L_pw_b0_0:
    s_branch L_pw_b0_1
L_pw_c0_0:
    s_branch L_pw_c0_1
L_ps_0_0:
    s_cmp_eq_u32 s44, 0
    s_cselect_b64 vcc, -1, vcc
    s_cmp_eq_u64 vcc, 0
    s_cbranch_scc1 L_grok_2
    buffer_load_dwordx2 v[32:33], v4, s[28:31], 0 offen sc1
    buffer_load_dwordx4 v[28:31], v5, s[24:27], 0 offen sc1
    buffer_load_dwordx4 v[36:39], v22, s[24:27], 0 offen offset:0 sc1
    buffer_load_dwordx4 v[40:43], v22, s[24:27], 0 offen offset:16 sc1
    buffer_load_dwordx4 v[44:47], v22, s[24:27], 0 offen offset:1024 sc1
    buffer_load_dwordx4 v[48:51], v22, s[24:27], 0 offen offset:1040 sc1
    buffer_load_dwordx4 v[52:55], v22, s[24:27], 0 offen offset:2048 sc1
    buffer_load_dwordx4 v[56:59], v22, s[24:27], 0 offen offset:2064 sc1
    buffer_load_dwordx4 v[60:63], v22, s[24:27], 0 offen offset:3072 sc1
    buffer_load_dwordx4 v[64:67], v22, s[24:27], 0 offen offset:3088 sc1
    s_add_u32 s3, s3, 1
    s_cmp_gt_u32 s3, 40000
    s_cbranch_scc1 L_end
    s_branch L_gr_1
L_grok_2:
    s_mov_b32 s60, -1
    s_mov_b32 s61, 0
    s_waitcnt lgkmcnt(0)
    v_mfma_f32_32x32x16_bf16 v[168:183], v[136:139], v[128:131], v[168:183]
    ds_read_b64_tr_b16 v[152:153], v16 offset:28672
    ds_read_b64_tr_b16 v[154:155], v16 offset:29696
    ds_read_b64_tr_b16 v[156:157], v17 offset:28672
    v_cvt_pk_bf16_f32 v84, v28, v28
    v_cvt_pk_bf16_f32 v85, v28, 0
    v_add_f32 v36, v36, v38
    v_add_f32 v40, v40, v42
    v_add_f32 v36, v36, v40
    v_cvt_pk_bf16_f32 v37, v36, v36
    v_and_b32 v37, 0xffff0000, v37
    v_mfma_f32_32x32x16_bf16 v[184:199], v[140:143], v[128:131], v[184:199]
    ds_read_b64_tr_b16 v[158:159], v17 offset:29696
    ds_read_b64_tr_b16 v[160:161], v18 offset:28672
    ds_read_b64_tr_b16 v[162:163], v18 offset:29696
    v_sub_f32 v37, v36, v37
    v_cvt_pk_bf16_f32 v38, v37, v37
    v_and_b32 v38, 0xffff0000, v38
    v_sub_f32 v38, v37, v38
    v_cvt_pk_bf16_f32 v36, v36, v37
    v_cvt_pk_bf16_f32 v38, v38, 0
    v_cndmask_b32 v68, 0, v36, s[60:61]
    v_mfma_f32_32x32x16_bf16 v[200:215], v[144:147], v[128:131], v[200:215]
    ds_read_b64_tr_b16 v[164:165], v19 offset:28672
    ds_read_b64_tr_b16 v[166:167], v19 offset:29696
    v_cndmask_b32 v69, 0, v38, s[60:61]
    v_add_f32 v44, v44, v46
    v_add_f32 v48, v48, v50
    v_add_f32 v44, v44, v48
    v_cvt_pk_bf16_f32 v45, v44, v44
    v_and_b32 v45, 0xffff0000, v45
    v_sub_f32 v45, v44, v45
    v_mfma_f32_32x32x16_bf16 v[216:231], v[148:151], v[128:131], v[216:231]
    v_cvt_pk_bf16_f32 v46, v45, v45
    v_and_b32 v46, 0xffff0000, v46
    v_sub_f32 v46, v45, v46
    v_cvt_pk_bf16_f32 v44, v44, v45
    v_cvt_pk_bf16_f32 v46, v46, 0
    v_cndmask_b32 v72, 0, v44, s[60:61]
    s_waitcnt lgkmcnt(0)
    v_mfma_f32_32x32x16_bf16 v[168:183], v[152:155], v[132:135], v[168:183]
    v_cndmask_b32 v73, 0, v46, s[60:61]
    v_add_f32 v52, v52, v54
    v_add_f32 v56, v56, v58
    v_add_f32 v52, v52, v56
    v_cvt_pk_bf16_f32 v53, v52, v52
    v_and_b32 v53, 0xffff0000, v53
    v_sub_f32 v53, v52, v53
    v_mfma_f32_32x32x16_bf16 v[184:199], v[156:159], v[132:135], v[184:199]
    v_cvt_pk_bf16_f32 v54, v53, v53
    v_and_b32 v54, 0xffff0000, v54
    v_sub_f32 v54, v53, v54
    v_cvt_pk_bf16_f32 v52, v52, v53
    v_cvt_pk_bf16_f32 v54, v54, 0
    v_cndmask_b32 v76, 0, v52, s[60:61]
    v_cndmask_b32 v77, 0, v54, s[60:61]
    v_mfma_f32_32x32x16_bf16 v[200:215], v[160:163], v[132:135], v[200:215]
    v_add_f32 v60, v60, v62
    v_add_f32 v64, v64, v66
    v_add_f32 v60, v60, v64
    v_cvt_pk_bf16_f32 v61, v60, v60
    v_and_b32 v61, 0xffff0000, v61
    v_sub_f32 v61, v60, v61
    v_cvt_pk_bf16_f32 v62, v61, v61
    v_mfma_f32_32x32x16_bf16 v[216:231], v[164:167], v[132:135], v[216:231]
    v_and_b32 v62, 0xffff0000, v62
    v_sub_f32 v62, v61, v62
    v_cvt_pk_bf16_f32 v60, v60, v61
    v_cvt_pk_bf16_f32 v62, v62, 0
    v_cndmask_b32 v80, 0, v60, s[60:61]
    v_cndmask_b32 v81, 0, v62, s[60:61]
    s_cmp_lg_u32 s46, 0
    s_cbranch_scc1 L_ph_3
    s_add_u32 s56, s95, 500
    s_lshl_b32 s57, s47, 7
    s_add_u32 s57, s57, 0x1d04000
    v_mov_b32 v23, s56
    v_mov_b32 v4, 0
    s_mov_b64 exec, 1
    buffer_store_dword v23, v4, s[24:27], s57 offen
    s_mov_b64 exec, -1
L_ph_3:
    v_mfma_f32_32x32x16_bf16 v[168:183], v[68:71], v[84:87], v[168:183]
    v_mfma_f32_32x32x16_bf16 v[184:199], v[72:75], v[84:87], v[184:199]
    v_mfma_f32_32x32x16_bf16 v[200:215], v[76:79], v[84:87], v[200:215]
    v_mfma_f32_32x32x16_bf16 v[216:231], v[80:83], v[84:87], v[216:231]
    s_cmp_lt_u32 s49, 5
    s_cbranch_scc0 L_qkv_kb
    v_mul_f32 v29, 0x3ea52b5c, v29
    s_lshl_b32 s56, s55, 10
    s_add_u32 s56, s56, 0x0
    s_lshl_b32 s57, s55, 8
    s_add_u32 s57, s57, 0x200000
    s_mov_b32 s58, 65536
    s_mov_b32 s59, 16384
    s_mov_b32 s60, s49
    s_branch L_qkv_kb2
L_qkv_kb:
    s_lshr_b32 s56, s55, 1
    s_mul_i32 s56, s56, 2560
    s_add_u32 s56, s56, 0x400000
    s_and_b32 s58, s55, 1
    s_lshl_b32 s57, s58, 8
    s_add_u32 s57, s57, s56
    s_add_u32 s57, s57, 2048
    s_lshl_b32 s58, s58, 10
    s_add_u32 s56, s56, s58
    s_mov_b32 s58, 81920
    s_mov_b32 s59, 81920
    s_sub_u32 s60, s49, 5
L_qkv_kb2:
    v_lshlrev_b32 v23, 4, v1
    v_mul_lo_u32 v24, v2, s59
    v_lshl_add_u32 v24, v3, 3, v24
    v_mov_b32 v28, v29
    v_pk_mul_f32 v[168:169], v[168:169], v[28:29]
    v_pk_mul_f32 v[170:171], v[170:171], v[28:29]
    v_pk_mul_f32 v[172:173], v[172:173], v[28:29]
    v_pk_mul_f32 v[174:175], v[174:175], v[28:29]
    v_pk_mul_f32 v[176:177], v[176:177], v[28:29]
    v_pk_mul_f32 v[178:179], v[178:179], v[28:29]
    v_pk_mul_f32 v[180:181], v[180:181], v[28:29]
    v_pk_mul_f32 v[182:183], v[182:183], v[28:29]
    v_pk_mul_f32 v[184:185], v[184:185], v[28:29]
    v_pk_mul_f32 v[186:187], v[186:187], v[28:29]
    v_pk_mul_f32 v[188:189], v[188:189], v[28:29]
    v_pk_mul_f32 v[190:191], v[190:191], v[28:29]
    v_pk_mul_f32 v[192:193], v[192:193], v[28:29]
    v_pk_mul_f32 v[194:195], v[194:195], v[28:29]
    v_pk_mul_f32 v[196:197], v[196:197], v[28:29]
    v_pk_mul_f32 v[198:199], v[198:199], v[28:29]
    v_pk_mul_f32 v[200:201], v[200:201], v[28:29]
    v_pk_mul_f32 v[202:203], v[202:203], v[28:29]
    v_pk_mul_f32 v[204:205], v[204:205], v[28:29]
    v_pk_mul_f32 v[206:207], v[206:207], v[28:29]
    v_pk_mul_f32 v[208:209], v[208:209], v[28:29]
    v_pk_mul_f32 v[210:211], v[210:211], v[28:29]
    v_pk_mul_f32 v[212:213], v[212:213], v[28:29]
    v_pk_mul_f32 v[214:215], v[214:215], v[28:29]
    v_pk_mul_f32 v[216:217], v[216:217], v[28:29]
    v_pk_mul_f32 v[218:219], v[218:219], v[28:29]
    v_pk_mul_f32 v[220:221], v[220:221], v[28:29]
    v_pk_mul_f32 v[222:223], v[222:223], v[28:29]
    v_pk_mul_f32 v[224:225], v[224:225], v[28:29]
    v_pk_mul_f32 v[226:227], v[226:227], v[28:29]
    v_pk_mul_f32 v[228:229], v[228:229], v[28:29]
    v_pk_mul_f32 v[230:231], v[230:231], v[28:29]
    v_cvt_pk_bf16_f32 v168, v168, v169
    v_cvt_pk_bf16_f32 v169, v170, v171
    v_cvt_pk_bf16_f32 v170, v172, v173
    v_cvt_pk_bf16_f32 v171, v174, v175
    v_cvt_pk_bf16_f32 v172, v176, v177
    v_cvt_pk_bf16_f32 v173, v178, v179
    v_cvt_pk_bf16_f32 v174, v180, v181
    v_cvt_pk_bf16_f32 v175, v182, v183
    v_cvt_pk_bf16_f32 v176, v184, v185
    v_cvt_pk_bf16_f32 v177, v186, v187
    v_cvt_pk_bf16_f32 v178, v188, v189
    v_cvt_pk_bf16_f32 v179, v190, v191
    v_cvt_pk_bf16_f32 v180, v192, v193
    v_cvt_pk_bf16_f32 v181, v194, v195
    v_cvt_pk_bf16_f32 v182, v196, v197
    v_cvt_pk_bf16_f32 v183, v198, v199
    v_cvt_pk_bf16_f32 v184, v200, v201
    v_cvt_pk_bf16_f32 v185, v202, v203
    v_cvt_pk_bf16_f32 v186, v204, v205
    v_cvt_pk_bf16_f32 v187, v206, v207
    v_cvt_pk_bf16_f32 v188, v208, v209
    v_cvt_pk_bf16_f32 v189, v210, v211
    v_cvt_pk_bf16_f32 v190, v212, v213
    v_cvt_pk_bf16_f32 v191, v214, v215
    v_cvt_pk_bf16_f32 v192, v216, v217
    v_cvt_pk_bf16_f32 v193, v218, v219
    v_cvt_pk_bf16_f32 v194, v220, v221
    v_cvt_pk_bf16_f32 v195, v222, v223
    v_cvt_pk_bf16_f32 v196, v224, v225
    v_cvt_pk_bf16_f32 v197, v226, v227
    v_cvt_pk_bf16_f32 v198, v228, v229
    v_cvt_pk_bf16_f32 v199, v230, v231
    s_cmp_eq_u32 s60, 1
    s_cbranch_scc1 L_qkv_st1
    s_cmp_eq_u32 s60, 2
    s_cbranch_scc1 L_qkv_st2
    s_cmp_eq_u32 s60, 3
    s_cbranch_scc1 L_qkv_st3
    s_cmp_eq_u32 s60, 4
    s_cbranch_scc1 L_qkv_st4
L_qkv_st0:
    s_mul_i32 s61, s58, 0
    s_add_u32 s61, s61, s56
    buffer_store_dwordx4 v[168:171], v23, s[24:27], s61 offen sc1
    s_mul_i32 s61, s59, 0
    s_add_u32 s61, s61, s57
    buffer_store_dwordx2 v[172:173], v24, s[24:27], s61 offen sc1
    s_mul_i32 s61, s58, 1
    s_add_u32 s61, s61, s56
    buffer_store_dwordx4 v[174:177], v23, s[24:27], s61 offen sc1
    s_mul_i32 s61, s58, 2
    s_add_u32 s61, s61, s56
    buffer_store_dwordx4 v[178:181], v23, s[24:27], s61 offen sc1
    s_mul_i32 s61, s59, 2
    s_add_u32 s61, s61, s57
    buffer_store_dwordx2 v[182:183], v24, s[24:27], s61 offen sc1
    s_mul_i32 s61, s58, 3
    s_add_u32 s61, s61, s56
    buffer_store_dwordx4 v[184:187], v23, s[24:27], s61 offen sc1
    s_mul_i32 s61, s58, 4
    s_add_u32 s61, s61, s56
    buffer_store_dwordx4 v[188:191], v23, s[24:27], s61 offen sc1
    s_mul_i32 s61, s59, 4
    s_add_u32 s61, s61, s57
    buffer_store_dwordx2 v[192:193], v24, s[24:27], s61 offen sc1
    s_mul_i32 s61, s58, 5
    s_add_u32 s61, s61, s56
    buffer_store_dwordx4 v[194:197], v23, s[24:27], s61 offen sc1
    s_mul_i32 s61, s58, 6
    s_add_u32 s61, s61, s56
    buffer_store_dwordx2 v[198:199], v23, s[24:27], s61 offen offset:0 sc1
    s_branch L_qkv_done
L_pw_a0_1:
    s_branch L_pw_a0_2
L_pw_b0_1:
    s_branch L_pw_b0_2
L_pw_c0_1:
    s_branch L_pw_c0_2
L_qkv_st1:
    s_mul_i32 s61, s58, 6
    s_add_u32 s61, s61, s56
    buffer_store_dwordx2 v[168:169], v23, s[24:27], s61 offen offset:8 sc1
    s_mul_i32 s61, s59, 6
    s_add_u32 s61, s61, s57
    buffer_store_dwordx2 v[170:171], v24, s[24:27], s61 offen sc1
    s_mul_i32 s61, s58, 7
    s_add_u32 s61, s61, s56
    buffer_store_dwordx4 v[172:175], v23, s[24:27], s61 offen sc1
    s_mul_i32 s61, s58, 8
    s_add_u32 s61, s61, s56
    buffer_store_dwordx4 v[176:179], v23, s[24:27], s61 offen sc1
    s_mul_i32 s61, s59, 8
    s_add_u32 s61, s61, s57
    buffer_store_dwordx2 v[180:181], v24, s[24:27], s61 offen sc1
    s_mul_i32 s61, s58, 9
    s_add_u32 s61, s61, s56
    buffer_store_dwordx4 v[182:185], v23, s[24:27], s61 offen sc1
    s_mul_i32 s61, s58, 10
    s_add_u32 s61, s61, s56
    buffer_store_dwordx4 v[186:189], v23, s[24:27], s61 offen sc1
    s_mul_i32 s61, s59, 10
    s_add_u32 s61, s61, s57
    buffer_store_dwordx2 v[190:191], v24, s[24:27], s61 offen sc1
    s_mul_i32 s61, s58, 11
    s_add_u32 s61, s61, s56
    buffer_store_dwordx4 v[192:195], v23, s[24:27], s61 offen sc1
    s_mul_i32 s61, s58, 12
    s_add_u32 s61, s61, s56
    buffer_store_dwordx4 v[196:199], v23, s[24:27], s61 offen sc1
    s_branch L_qkv_done
L_pw_a0_2:
    s_branch L_pw_a0_3
L_pw_b0_2:
    s_branch L_pw_b0_3
L_pw_c0_2:
    s_branch L_pw_c0_3
L_qkv_st2:
    s_mul_i32 s61, s59, 12
    s_add_u32 s61, s61, s57
    buffer_store_dwordx2 v[168:169], v24, s[24:27], s61 offen sc1
    s_mul_i32 s61, s58, 13
    s_add_u32 s61, s61, s56
    buffer_store_dwordx4 v[170:173], v23, s[24:27], s61 offen sc1
    s_mul_i32 s61, s58, 14
    s_add_u32 s61, s61, s56
    buffer_store_dwordx4 v[174:177], v23, s[24:27], s61 offen sc1
    s_mul_i32 s61, s59, 14
    s_add_u32 s61, s61, s57
    buffer_store_dwordx2 v[178:179], v24, s[24:27], s61 offen sc1
    s_mul_i32 s61, s58, 15
    s_add_u32 s61, s61, s56
    buffer_store_dwordx4 v[180:183], v23, s[24:27], s61 offen sc1
    s_mul_i32 s61, s58, 16
    s_add_u32 s61, s61, s56
    buffer_store_dwordx4 v[184:187], v23, s[24:27], s61 offen sc1
    s_mul_i32 s61, s59, 16
    s_add_u32 s61, s61, s57
    buffer_store_dwordx2 v[188:189], v24, s[24:27], s61 offen sc1
    s_mul_i32 s61, s58, 17
    s_add_u32 s61, s61, s56
    buffer_store_dwordx4 v[190:193], v23, s[24:27], s61 offen sc1
    s_mul_i32 s61, s58, 18
    s_add_u32 s61, s61, s56
    buffer_store_dwordx4 v[194:197], v23, s[24:27], s61 offen sc1
    s_mul_i32 s61, s59, 18
    s_add_u32 s61, s61, s57
    buffer_store_dwordx2 v[198:199], v24, s[24:27], s61 offen sc1
    s_branch L_qkv_done
L_pw_a0_3:
    s_branch L_pw_a0_4
L_pw_b0_3:
    s_branch L_pw_b0_4
L_pw_c0_3:
    s_branch L_pw_c0_4
L_qkv_st3:
    s_mul_i32 s61, s58, 19
    s_add_u32 s61, s61, s56
    buffer_store_dwordx4 v[168:171], v23, s[24:27], s61 offen sc1
    s_mul_i32 s61, s58, 20
    s_add_u32 s61, s61, s56
    buffer_store_dwordx4 v[172:175], v23, s[24:27], s61 offen sc1
    s_mul_i32 s61, s59, 20
    s_add_u32 s61, s61, s57
    buffer_store_dwordx2 v[176:177], v24, s[24:27], s61 offen sc1
    s_mul_i32 s61, s58, 21
    s_add_u32 s61, s61, s56
    buffer_store_dwordx4 v[178:181], v23, s[24:27], s61 offen sc1
    s_mul_i32 s61, s58, 22
    s_add_u32 s61, s61, s56
    buffer_store_dwordx4 v[182:185], v23, s[24:27], s61 offen sc1
    s_mul_i32 s61, s59, 22
    s_add_u32 s61, s61, s57
    buffer_store_dwordx2 v[186:187], v24, s[24:27], s61 offen sc1
    s_mul_i32 s61, s58, 23
    s_add_u32 s61, s61, s56
    buffer_store_dwordx4 v[188:191], v23, s[24:27], s61 offen sc1
    s_mul_i32 s61, s58, 24
    s_add_u32 s61, s61, s56
    buffer_store_dwordx4 v[192:195], v23, s[24:27], s61 offen sc1
    s_mul_i32 s61, s59, 24
    s_add_u32 s61, s61, s57
    buffer_store_dwordx2 v[196:197], v24, s[24:27], s61 offen sc1
    s_mul_i32 s61, s58, 25
    s_add_u32 s61, s61, s56
    buffer_store_dwordx2 v[198:199], v23, s[24:27], s61 offen offset:0 sc1
    s_branch L_qkv_done
L_pw_a0_4:
    s_branch L_pw_a_ret
L_pw_b0_4:
    s_branch L_pw_b_ret
L_pw_c0_4:
    s_branch L_pw_c_ret
L_qkv_st4:
    s_mul_i32 s61, s58, 25
    s_add_u32 s61, s61, s56
    buffer_store_dwordx2 v[168:169], v23, s[24:27], s61 offen offset:8 sc1
    s_mul_i32 s61, s58, 26
    s_add_u32 s61, s61, s56
    buffer_store_dwordx4 v[170:173], v23, s[24:27], s61 offen sc1
    s_mul_i32 s61, s59, 26
    s_add_u32 s61, s61, s57
    buffer_store_dwordx2 v[174:175], v24, s[24:27], s61 offen sc1
    s_mul_i32 s61, s58, 27
    s_add_u32 s61, s61, s56
    buffer_store_dwordx4 v[176:179], v23, s[24:27], s61 offen sc1
    s_mul_i32 s61, s58, 28
    s_add_u32 s61, s61, s56
    buffer_store_dwordx4 v[180:183], v23, s[24:27], s61 offen sc1
    s_mul_i32 s61, s59, 28
    s_add_u32 s61, s61, s57
    buffer_store_dwordx2 v[184:185], v24, s[24:27], s61 offen sc1
    s_mul_i32 s61, s58, 29
    s_add_u32 s61, s61, s56
    buffer_store_dwordx4 v[186:189], v23, s[24:27], s61 offen sc1
    s_mul_i32 s61, s58, 30
    s_add_u32 s61, s61, s56
    buffer_store_dwordx4 v[190:193], v23, s[24:27], s61 offen sc1
    s_mul_i32 s61, s59, 30
    s_add_u32 s61, s61, s57
    buffer_store_dwordx2 v[194:195], v24, s[24:27], s61 offen sc1
    s_mul_i32 s61, s58, 31
    s_add_u32 s61, s61, s56
    buffer_store_dwordx4 v[196:199], v23, s[24:27], s61 offen sc1
    s_branch L_qkv_done
L_qkv_v:
    s_lshr_b32 s63, s55, 1
    s_mul_i32 s63, s63, 11264
    s_add_u32 s63, s63, 0x800000
    s_and_b32 s58, s55, 1
    s_mul_i32 s58, s58, 5632
    s_add_u32 s63, s63, s58
    s_sub_u32 s60, s49, 10
    s_lshl_b32 s60, s60, 7
    s_add_u32 m0, s53, 1024
    s_nop 0
    buffer_load_dwordx4 v7, s[32:35], s50 offen lds
    s_add_u32 m0, s54, 1024
    s_nop 0
    buffer_load_dwordx4 v11, s[36:39], s51 offen lds
    s_add_u32 s51, s51, 122880
    s_cmp_eq_u32 s51, 2457600
    s_cselect_b32 s51, 0, s51
    s_add_u32 m0, s53, 2048
    s_nop 0
    buffer_load_dwordx4 v8, s[32:35], s50 offen lds
    s_add_u32 m0, s53, 3072
    s_nop 0
    buffer_load_dwordx4 v9, s[32:35], s50 offen lds
    s_add_u32 s50, s50, 128
    s_cmp_eq_u32 s50, 1280
    s_cselect_b32 s50, 0, s50
    s_add_u32 m0, s54, 8192
    s_nop 0
    buffer_load_dwordx4 v10, s[36:39], s51 offen lds
    s_add_u32 m0, s54, 9216
    s_nop 0
    buffer_load_dwordx4 v11, s[36:39], s51 offen lds
    s_add_u32 s51, s51, 122880
    s_cmp_eq_u32 s51, 2457600
    s_cselect_b32 s51, 0, s51
    s_add_u32 m0, s53, 4096
    s_nop 0
    buffer_load_dwordx4 v6, s[32:35], s50 offen lds
    s_add_u32 m0, s53, 5120
    s_nop 0
    buffer_load_dwordx4 v7, s[32:35], s50 offen lds
    s_add_u32 m0, s54, 16384
    s_nop 0
    buffer_load_dwordx4 v10, s[36:39], s51 offen lds
    s_add_u32 m0, s54, 17408
    s_nop 0
    buffer_load_dwordx4 v11, s[36:39], s51 offen lds
    s_add_u32 s51, s51, 122880
    s_cmp_eq_u32 s51, 2457600
    s_cselect_b32 s51, 0, s51
    s_add_u32 m0, s53, 6144
    s_nop 0
    buffer_load_dwordx4 v8, s[32:35], s50 offen lds
    s_add_u32 m0, s53, 7168
    s_nop 0
    buffer_load_dwordx4 v9, s[32:35], s50 offen lds
    s_add_u32 s50, s50, 128
    s_cmp_eq_u32 s50, 1280
    s_cselect_b32 s50, 0, s50
    s_add_u32 m0, s54, 24576
    s_nop 0
    buffer_load_dwordx4 v10, s[36:39], s51 offen lds
    s_add_u32 m0, s54, 25600
    s_nop 0
    buffer_load_dwordx4 v11, s[36:39], s51 offen lds
    s_add_u32 s51, s51, 122880
    s_cmp_eq_u32 s51, 2457600
    s_cselect_b32 s51, 0, s51
    v_mov_b32 v168, 0
    v_mov_b32 v169, 0
    v_mov_b32 v170, 0
    v_mov_b32 v171, 0
    v_mov_b32 v172, 0
    v_mov_b32 v173, 0
    v_mov_b32 v174, 0
    v_mov_b32 v175, 0
    v_mov_b32 v176, 0
    v_mov_b32 v177, 0
    v_mov_b32 v178, 0
    v_mov_b32 v179, 0
    v_mov_b32 v180, 0
    v_mov_b32 v181, 0
    v_mov_b32 v182, 0
    v_mov_b32 v183, 0
    v_mov_b32 v184, 0
    v_mov_b32 v185, 0
    v_mov_b32 v186, 0
    v_mov_b32 v187, 0
    v_mov_b32 v188, 0
    v_mov_b32 v189, 0
    v_mov_b32 v190, 0
    v_mov_b32 v191, 0
    v_mov_b32 v192, 0
    v_mov_b32 v193, 0
    v_mov_b32 v194, 0
    v_mov_b32 v195, 0
    v_mov_b32 v196, 0
    v_mov_b32 v197, 0
    v_mov_b32 v198, 0
    v_mov_b32 v199, 0
    v_mov_b32 v200, 0
    v_mov_b32 v201, 0
    v_mov_b32 v202, 0
    v_mov_b32 v203, 0
    v_mov_b32 v204, 0
    v_mov_b32 v205, 0
    v_mov_b32 v206, 0
    v_mov_b32 v207, 0
    v_mov_b32 v208, 0
    v_mov_b32 v209, 0
    v_mov_b32 v210, 0
    v_mov_b32 v211, 0
    v_mov_b32 v212, 0
    v_mov_b32 v213, 0
    v_mov_b32 v214, 0
    v_mov_b32 v215, 0
    v_mov_b32 v216, 0
    v_mov_b32 v217, 0
    v_mov_b32 v218, 0
    v_mov_b32 v219, 0
    v_mov_b32 v220, 0
    v_mov_b32 v221, 0
    v_mov_b32 v222, 0
    v_mov_b32 v223, 0
    v_mov_b32 v224, 0
    v_mov_b32 v225, 0
    v_mov_b32 v226, 0
    v_mov_b32 v227, 0
    v_mov_b32 v228, 0
    v_mov_b32 v229, 0
    v_mov_b32 v230, 0
    v_mov_b32 v231, 0
    v_mul_u32_u24 v26, 1408, v2
    v_add_u32 v23, s60, v3
    v_mul_u32_u24 v24, 820, v23
    v_lshrrev_b32 v24, 16, v24
    v_mul_u32_u24 v24, 0x57b00, v24
    v_lshl_add_u32 v24, v23, 4, v24
    v_add_u32 v236, v24, v26
    v_add_u32 v23, s60, v3
    v_add_u32 v23, 32, v23
    v_mul_u32_u24 v24, 820, v23
    v_lshrrev_b32 v24, 16, v24
    v_mul_u32_u24 v24, 0x57b00, v24
    v_lshl_add_u32 v24, v23, 4, v24
    v_add_u32 v237, v24, v26
    v_add_u32 v23, s60, v3
    v_add_u32 v23, 64, v23
    v_mul_u32_u24 v24, 820, v23
    v_lshrrev_b32 v24, 16, v24
    v_mul_u32_u24 v24, 0x57b00, v24
    v_lshl_add_u32 v24, v23, 4, v24
    v_add_u32 v238, v24, v26
    v_add_u32 v23, s60, v3
    v_add_u32 v23, 96, v23
    v_mul_u32_u24 v24, 820, v23
    v_lshrrev_b32 v24, 16, v24
    v_mul_u32_u24 v24, 0x57b00, v24
    v_lshl_add_u32 v24, v23, 4, v24
    v_add_u32 v239, v24, v26
    s_mul_i32 s61, s60, 820
    s_lshr_b32 s61, s61, 16
    s_add_u32 s60, s60, 128
    v_lshrrev_b32 v23, 4, v1
    v_add_u32 v23, s61, v23
    v_mul_u32_u24 v24, 80, v23
    v_mul_u32_u24 v23, 0x58000, v23
    v_bfe_u32 v25, v1, 2, 2
    v_mul_u32_u24 v25, 1408, v25
    v_add_u32 v23, v23, v25
    v_and_b32 v25, 3, v1
    v_lshl_add_u32 v23, v25, 4, v23
    v_cmp_gt_u32 vcc, s60, v24
    v_mov_b32 v24, 0x7ffffff0
    s_nop 0
    v_cndmask_b32 v240, v24, v23, vcc
    v_mov_b32 v244, 0x3f803f80
    v_mov_b32 v245, 0x3f803f80
    v_mov_b32 v246, 0x3f803f80
    v_mov_b32 v247, 0x3f803f80
    s_waitcnt vmcnt(10)
    s_barrier
    ds_read_b128 v[104:107], v12 offset:0
    ds_read_b128 v[108:111], v13 offset:0
    ds_read_b128 v[112:115], v14 offset:0
    ds_read_b128 v[116:119], v15 offset:0
    ds_read_b64_tr_b16 v[136:137], v16 offset:0
    ds_read_b64_tr_b16 v[138:139], v16 offset:1024
    ds_read_b64_tr_b16 v[140:141], v17 offset:0
    ds_read_b64_tr_b16 v[142:143], v17 offset:1024
    ds_read_b64_tr_b16 v[144:145], v18 offset:0
    ds_read_b64_tr_b16 v[146:147], v18 offset:1024
    ds_read_b64_tr_b16 v[148:149], v19 offset:0
    ds_read_b64_tr_b16 v[150:151], v19 offset:1024
    s_mov_b32 s52, 0
.p2align 3
L_qkv_v_loop:
    s_waitcnt lgkmcnt(6)
    v_mfma_f32_32x32x16_bf16 v[168:183], v[104:107], v[136:139], v[168:183]
    ds_read_b64_tr_b16 v[152:153], v16 offset:4096
    ds_read_b64_tr_b16 v[154:155], v16 offset:5120
    ds_read_b64_tr_b16 v[156:157], v17 offset:4096
    ds_read_b64_tr_b16 v[158:159], v17 offset:5120
    s_waitcnt lgkmcnt(8)
    v_mfma_f32_32x32x16_bf16 v[184:199], v[104:107], v[140:143], v[184:199]
    ds_read_b64_tr_b16 v[160:161], v18 offset:4096
    ds_read_b64_tr_b16 v[162:163], v18 offset:5120
    ds_read_b64_tr_b16 v[164:165], v19 offset:4096
    ds_read_b64_tr_b16 v[166:167], v19 offset:5120
    s_add_u32 m0, s53, 0
    s_nop 0
    buffer_load_dwordx4 v6, s[32:35], s50 offen lds
    s_waitcnt lgkmcnt(10)
    v_mfma_f32_32x32x16_bf16 v[200:215], v[104:107], v[144:147], v[200:215]
    s_add_u32 m0, s53, 1024
    s_nop 0
    buffer_load_dwordx4 v7, s[32:35], s50 offen lds
    s_add_u32 m0, s53, 2048
    s_nop 0
    buffer_load_dwordx4 v8, s[32:35], s50 offen lds
    s_waitcnt lgkmcnt(8)
    v_mfma_f32_32x32x16_bf16 v[216:231], v[104:107], v[148:151], v[216:231]
    s_add_u32 m0, s53, 3072
    s_nop 0
    buffer_load_dwordx4 v9, s[32:35], s50 offen lds
    s_add_u32 s50, s50, 128
    s_cmp_eq_u32 s50, 1280
    s_cselect_b32 s50, 0, s50
    s_waitcnt vmcnt(12) lgkmcnt(0)
    s_barrier
    v_mfma_f32_32x32x16_bf16 v[168:183], v[108:111], v[152:155], v[168:183]
    ds_read_b64_tr_b16 v[136:137], v16 offset:8192
    ds_read_b64_tr_b16 v[138:139], v16 offset:9216
    ds_read_b64_tr_b16 v[140:141], v17 offset:8192
    v_mfma_f32_32x32x16_bf16 v[184:199], v[108:111], v[156:159], v[184:199]
    s_add_u32 m0, s54, 0
    ds_read_b64_tr_b16 v[142:143], v17 offset:9216
    ds_read_b64_tr_b16 v[144:145], v18 offset:8192
    ds_read_b64_tr_b16 v[146:147], v18 offset:9216
    buffer_load_dwordx4 v10, s[36:39], s51 offen lds
    v_mfma_f32_32x32x16_bf16 v[200:215], v[108:111], v[160:163], v[200:215]
    ds_read_b64_tr_b16 v[148:149], v19 offset:8192
    ds_read_b64_tr_b16 v[150:151], v19 offset:9216
    v_mfma_f32_32x32x16_bf16 v[216:231], v[108:111], v[164:167], v[216:231]
    s_add_u32 m0, s54, 1024
    s_nop 0
    buffer_load_dwordx4 v11, s[36:39], s51 offen lds
    s_add_u32 s51, s51, 122880
    s_cmp_eq_u32 s51, 2457600
    s_cselect_b32 s51, 0, s51
    s_waitcnt lgkmcnt(6)
    v_mfma_f32_32x32x16_bf16 v[168:183], v[112:115], v[136:139], v[168:183]
    ds_read_b64_tr_b16 v[152:153], v16 offset:12288
    ds_read_b64_tr_b16 v[154:155], v16 offset:13312
    ds_read_b64_tr_b16 v[156:157], v17 offset:12288
    ds_read_b64_tr_b16 v[158:159], v17 offset:13312
    s_waitcnt lgkmcnt(8)
    v_mfma_f32_32x32x16_bf16 v[184:199], v[112:115], v[140:143], v[184:199]
    ds_read_b64_tr_b16 v[160:161], v18 offset:12288
    ds_read_b64_tr_b16 v[162:163], v18 offset:13312
    ds_read_b64_tr_b16 v[164:165], v19 offset:12288
    ds_read_b64_tr_b16 v[166:167], v19 offset:13312
    s_waitcnt lgkmcnt(10)
    v_mfma_f32_32x32x16_bf16 v[200:215], v[112:115], v[144:147], v[200:215]
    s_waitcnt lgkmcnt(8)
    v_mfma_f32_32x32x16_bf16 v[216:231], v[112:115], v[148:151], v[216:231]
    s_waitcnt vmcnt(8) lgkmcnt(0)
    s_barrier
    v_mfma_f32_32x32x16_bf16 v[168:183], v[116:119], v[152:155], v[168:183]
    ds_read_b128 v[120:123], v12 offset:4096
    ds_read_b128 v[124:127], v13 offset:4096
    ds_read_b128 v[128:131], v14 offset:4096
    ds_read_b128 v[132:135], v15 offset:4096
    v_mfma_f32_32x32x16_bf16 v[184:199], v[116:119], v[156:159], v[184:199]
    s_add_u32 m0, s54, 8192
    ds_read_b64_tr_b16 v[136:137], v16 offset:16384
    ds_read_b64_tr_b16 v[138:139], v16 offset:17408
    ds_read_b64_tr_b16 v[140:141], v17 offset:16384
    ds_read_b64_tr_b16 v[142:143], v17 offset:17408
    buffer_load_dwordx4 v10, s[36:39], s51 offen lds
    v_mfma_f32_32x32x16_bf16 v[200:215], v[116:119], v[160:163], v[200:215]
    ds_read_b64_tr_b16 v[144:145], v18 offset:16384
    ds_read_b64_tr_b16 v[146:147], v18 offset:17408
    ds_read_b64_tr_b16 v[148:149], v19 offset:16384
    ds_read_b64_tr_b16 v[150:151], v19 offset:17408
    v_mfma_f32_32x32x16_bf16 v[216:231], v[116:119], v[164:167], v[216:231]
    s_add_u32 m0, s54, 9216
    s_nop 0
    buffer_load_dwordx4 v11, s[36:39], s51 offen lds
    s_add_u32 s51, s51, 122880
    s_cmp_eq_u32 s51, 2457600
    s_cselect_b32 s51, 0, s51
    s_waitcnt lgkmcnt(6)
    v_mfma_f32_32x32x16_bf16 v[168:183], v[120:123], v[136:139], v[168:183]
    ds_read_b64_tr_b16 v[152:153], v16 offset:20480
    ds_read_b64_tr_b16 v[154:155], v16 offset:21504
    ds_read_b64_tr_b16 v[156:157], v17 offset:20480
    ds_read_b64_tr_b16 v[158:159], v17 offset:21504
    s_waitcnt lgkmcnt(8)
    v_mfma_f32_32x32x16_bf16 v[184:199], v[120:123], v[140:143], v[184:199]
    ds_read_b64_tr_b16 v[160:161], v18 offset:20480
    ds_read_b64_tr_b16 v[162:163], v18 offset:21504
    ds_read_b64_tr_b16 v[164:165], v19 offset:20480
    ds_read_b64_tr_b16 v[166:167], v19 offset:21504
    s_add_u32 m0, s53, 4096
    s_nop 0
    buffer_load_dwordx4 v6, s[32:35], s50 offen lds
    s_waitcnt lgkmcnt(10)
    v_mfma_f32_32x32x16_bf16 v[200:215], v[120:123], v[144:147], v[200:215]
    s_add_u32 m0, s53, 5120
    s_nop 0
    buffer_load_dwordx4 v7, s[32:35], s50 offen lds
    s_add_u32 m0, s53, 6144
    s_nop 0
    buffer_load_dwordx4 v8, s[32:35], s50 offen lds
    s_waitcnt lgkmcnt(8)
    v_mfma_f32_32x32x16_bf16 v[216:231], v[120:123], v[148:151], v[216:231]
    s_add_u32 m0, s53, 7168
    s_nop 0
    buffer_load_dwordx4 v9, s[32:35], s50 offen lds
    s_add_u32 s50, s50, 128
    s_cmp_eq_u32 s50, 1280
    s_cselect_b32 s50, 0, s50
    s_waitcnt vmcnt(12) lgkmcnt(0)
    s_barrier
    v_mfma_f32_32x32x16_bf16 v[168:183], v[124:127], v[152:155], v[168:183]
    ds_read_b64_tr_b16 v[136:137], v16 offset:24576
    ds_read_b64_tr_b16 v[138:139], v16 offset:25600
    ds_read_b64_tr_b16 v[140:141], v17 offset:24576
    v_mfma_f32_32x32x16_bf16 v[184:199], v[124:127], v[156:159], v[184:199]
    s_add_u32 m0, s54, 16384
    ds_read_b64_tr_b16 v[142:143], v17 offset:25600
    ds_read_b64_tr_b16 v[144:145], v18 offset:24576
    ds_read_b64_tr_b16 v[146:147], v18 offset:25600
    buffer_load_dwordx4 v10, s[36:39], s51 offen lds
    v_mfma_f32_32x32x16_bf16 v[200:215], v[124:127], v[160:163], v[200:215]
    ds_read_b64_tr_b16 v[148:149], v19 offset:24576
    ds_read_b64_tr_b16 v[150:151], v19 offset:25600
    v_mfma_f32_32x32x16_bf16 v[216:231], v[124:127], v[164:167], v[216:231]
    s_add_u32 m0, s54, 17408
    s_nop 0
    buffer_load_dwordx4 v11, s[36:39], s51 offen lds
    s_add_u32 s51, s51, 122880
    s_cmp_eq_u32 s51, 2457600
    s_cselect_b32 s51, 0, s51
    s_waitcnt lgkmcnt(6)
    v_mfma_f32_32x32x16_bf16 v[168:183], v[128:131], v[136:139], v[168:183]
    ds_read_b64_tr_b16 v[152:153], v16 offset:28672
    ds_read_b64_tr_b16 v[154:155], v16 offset:29696
    ds_read_b64_tr_b16 v[156:157], v17 offset:28672
    ds_read_b64_tr_b16 v[158:159], v17 offset:29696
    s_waitcnt lgkmcnt(8)
    v_mfma_f32_32x32x16_bf16 v[184:199], v[128:131], v[140:143], v[184:199]
    ds_read_b64_tr_b16 v[160:161], v18 offset:28672
    ds_read_b64_tr_b16 v[162:163], v18 offset:29696
    ds_read_b64_tr_b16 v[164:165], v19 offset:28672
    ds_read_b64_tr_b16 v[166:167], v19 offset:29696
    s_waitcnt lgkmcnt(10)
    v_mfma_f32_32x32x16_bf16 v[200:215], v[128:131], v[144:147], v[200:215]
    s_waitcnt lgkmcnt(8)
    v_mfma_f32_32x32x16_bf16 v[216:231], v[128:131], v[148:151], v[216:231]
    s_waitcnt vmcnt(8) lgkmcnt(0)
    s_barrier
    v_mfma_f32_32x32x16_bf16 v[168:183], v[132:135], v[152:155], v[168:183]
    ds_read_b128 v[104:107], v12 offset:0
    ds_read_b128 v[108:111], v13 offset:0
    ds_read_b128 v[112:115], v14 offset:0
    ds_read_b128 v[116:119], v15 offset:0
    v_mfma_f32_32x32x16_bf16 v[184:199], v[132:135], v[156:159], v[184:199]
    s_add_u32 m0, s54, 24576
    ds_read_b64_tr_b16 v[136:137], v16 offset:0
    ds_read_b64_tr_b16 v[138:139], v16 offset:1024
    ds_read_b64_tr_b16 v[140:141], v17 offset:0
    ds_read_b64_tr_b16 v[142:143], v17 offset:1024
    buffer_load_dwordx4 v10, s[36:39], s51 offen lds
    v_mfma_f32_32x32x16_bf16 v[200:215], v[132:135], v[160:163], v[200:215]
    ds_read_b64_tr_b16 v[144:145], v18 offset:0
    ds_read_b64_tr_b16 v[146:147], v18 offset:1024
    ds_read_b64_tr_b16 v[148:149], v19 offset:0
    ds_read_b64_tr_b16 v[150:151], v19 offset:1024
    v_mfma_f32_32x32x16_bf16 v[216:231], v[132:135], v[164:167], v[216:231]
    s_add_u32 m0, s54, 25600
    s_nop 0
    buffer_load_dwordx4 v11, s[36:39], s51 offen lds
    s_add_u32 s51, s51, 122880
    s_cmp_eq_u32 s51, 2457600
    s_cselect_b32 s51, 0, s51
    s_add_u32 s52, s52, 1
    s_cmp_lt_u32 s52, 4
    s_cbranch_scc1 L_qkv_v_loop
    s_mov_b32 s32, s12
    s_and_b32 s33, s13, 0xffff
    s_mov_b32 s34, 0x21c000
    s_mov_b32 s35, 0x00020000
    s_mov_b32 s40, s14
    s_and_b32 s41, s15, 0xffff
    s_mov_b32 s42, 0x21c000
    s_mov_b32 s43, 0x00020000
    s_lshr_b32 s56, s47, 3
    s_lshl_b32 s56, s56, 2
    s_add_u32 s56, s56, s46
    s_mul_i32 s56, s56, 3456
    s_bfe_u32 s57, s47, 0x20001
    s_mul_i32 s57, s57, 27
    s_lshr_b32 s57, s57, 2
    s_lshl_b32 s57, s57, 7
    s_add_u32 s56, s56, s57
    v_lshlrev_b32 v26, 4, v1
    s_waitcnt lgkmcnt(6)
    v_mfma_f32_32x32x16_bf16 v[168:183], v[104:107], v[136:139], v[168:183]
    ds_read_b64_tr_b16 v[152:153], v16 offset:4096
    ds_read_b64_tr_b16 v[154:155], v16 offset:5120
    ds_read_b64_tr_b16 v[156:157], v17 offset:4096
    ds_read_b64_tr_b16 v[158:159], v17 offset:5120
    buffer_load_dwordx2 v[32:33], v4, s[28:31], 0 offen sc1
    buffer_load_dwordx4 v[28:31], v5, s[24:27], 0 offen sc1
    buffer_load_dwordx4 v[36:39], v22, s[24:27], 0 offen offset:0 sc1
    s_waitcnt lgkmcnt(8)
    v_mfma_f32_32x32x16_bf16 v[184:199], v[104:107], v[140:143], v[184:199]
    ds_read_b64_tr_b16 v[160:161], v18 offset:4096
    ds_read_b64_tr_b16 v[162:163], v18 offset:5120
    ds_read_b64_tr_b16 v[164:165], v19 offset:4096
    ds_read_b64_tr_b16 v[166:167], v19 offset:5120
    buffer_load_dwordx4 v[40:43], v22, s[24:27], 0 offen offset:16 sc1
    buffer_load_dwordx4 v[44:47], v22, s[24:27], 0 offen offset:1024 sc1
    buffer_load_dwordx4 v[48:51], v22, s[24:27], 0 offen offset:1040 sc1
    s_waitcnt lgkmcnt(10)
    v_mfma_f32_32x32x16_bf16 v[200:215], v[104:107], v[144:147], v[200:215]
    buffer_load_dwordx4 v[52:55], v22, s[24:27], 0 offen offset:2048 sc1
    buffer_load_dwordx4 v[56:59], v22, s[24:27], 0 offen offset:2064 sc1
    buffer_load_dwordx4 v[60:63], v22, s[24:27], 0 offen offset:3072 sc1
    s_waitcnt lgkmcnt(8)
    v_mfma_f32_32x32x16_bf16 v[216:231], v[104:107], v[148:151], v[216:231]
    buffer_load_dwordx4 v[64:67], v22, s[24:27], 0 offen offset:3088 sc1
    s_waitcnt vmcnt(18) lgkmcnt(0)
    s_barrier
    v_mfma_f32_32x32x16_bf16 v[168:183], v[108:111], v[152:155], v[168:183]
    ds_read_b64_tr_b16 v[136:137], v16 offset:8192
    ds_read_b64_tr_b16 v[138:139], v16 offset:9216
    ds_read_b64_tr_b16 v[140:141], v17 offset:8192
    buffer_load_dwordx4 v[232:235], v26, s[32:35], s56 offen
    buffer_load_dwordx4 v[232:235], v26, s[40:43], s56 offen
    s_add_u32 s56, s56, 414720
    v_mfma_f32_32x32x16_bf16 v[184:199], v[108:111], v[156:159], v[184:199]
    ds_read_b64_tr_b16 v[142:143], v17 offset:9216
    ds_read_b64_tr_b16 v[144:145], v18 offset:8192
    ds_read_b64_tr_b16 v[146:147], v18 offset:9216
    buffer_load_dwordx4 v[232:235], v26, s[32:35], s56 offen
    buffer_load_dwordx4 v[232:235], v26, s[40:43], s56 offen
    s_add_u32 s56, s56, 414720
    v_mfma_f32_32x32x16_bf16 v[200:215], v[108:111], v[160:163], v[200:215]
    ds_read_b64_tr_b16 v[148:149], v19 offset:8192
    ds_read_b64_tr_b16 v[150:151], v19 offset:9216
    buffer_load_dwordx4 v[232:235], v26, s[32:35], s56 offen
    buffer_load_dwordx4 v[232:235], v26, s[40:43], s56 offen
    s_add_u32 s56, s56, 414720
    v_mfma_f32_32x32x16_bf16 v[216:231], v[108:111], v[164:167], v[216:231]
    s_waitcnt lgkmcnt(6)
    v_mfma_f32_32x32x16_bf16 v[168:183], v[112:115], v[136:139], v[168:183]
    ds_read_b64_tr_b16 v[152:153], v16 offset:12288
    ds_read_b64_tr_b16 v[154:155], v16 offset:13312
    ds_read_b64_tr_b16 v[156:157], v17 offset:12288
    ds_read_b64_tr_b16 v[158:159], v17 offset:13312
    buffer_load_dwordx4 v[232:235], v26, s[32:35], s56 offen
    buffer_load_dwordx4 v[232:235], v26, s[40:43], s56 offen
    s_add_u32 s56, s56, 414720
    s_waitcnt lgkmcnt(8)
    v_mfma_f32_32x32x16_bf16 v[184:199], v[112:115], v[140:143], v[184:199]
    ds_read_b64_tr_b16 v[160:161], v18 offset:12288
    ds_read_b64_tr_b16 v[162:163], v18 offset:13312
    ds_read_b64_tr_b16 v[164:165], v19 offset:12288
    ds_read_b64_tr_b16 v[166:167], v19 offset:13312
    buffer_load_dwordx4 v[232:235], v26, s[32:35], s56 offen
    buffer_load_dwordx4 v[232:235], v26, s[40:43], s56 offen
    s_add_u32 s56, s56, 414720
    s_waitcnt lgkmcnt(10)
    v_mfma_f32_32x32x16_bf16 v[200:215], v[112:115], v[144:147], v[200:215]
    buffer_load_dwordx4 v[232:235], v26, s[32:35], s56 offen
    buffer_load_dwordx4 v[232:235], v26, s[40:43], s56 offen
    s_add_u32 s56, s56, 414720
    s_waitcnt lgkmcnt(8)
    v_mfma_f32_32x32x16_bf16 v[216:231], v[112:115], v[148:151], v[216:231]
    s_waitcnt vmcnt(24) lgkmcnt(0)
    s_barrier
    v_mfma_f32_32x32x16_bf16 v[168:183], v[116:119], v[152:155], v[168:183]
    ds_read_b128 v[120:123], v12 offset:4096
    ds_read_b128 v[124:127], v13 offset:4096
    ds_read_b128 v[128:131], v14 offset:4096
    ds_read_b128 v[132:135], v15 offset:4096
    v_mfma_f32_32x32x16_bf16 v[184:199], v[116:119], v[156:159], v[184:199]
    ds_read_b64_tr_b16 v[136:137], v16 offset:16384
    ds_read_b64_tr_b16 v[138:139], v16 offset:17408
    ds_read_b64_tr_b16 v[140:141], v17 offset:16384
    ds_read_b64_tr_b16 v[142:143], v17 offset:17408
    v_mfma_f32_32x32x16_bf16 v[200:215], v[116:119], v[160:163], v[200:215]
    ds_read_b64_tr_b16 v[144:145], v18 offset:16384
    ds_read_b64_tr_b16 v[146:147], v18 offset:17408
    ds_read_b64_tr_b16 v[148:149], v19 offset:16384
    ds_read_b64_tr_b16 v[150:151], v19 offset:17408
    v_mfma_f32_32x32x16_bf16 v[216:231], v[116:119], v[164:167], v[216:231]
    s_waitcnt lgkmcnt(6)
    v_mfma_f32_32x32x16_bf16 v[168:183], v[120:123], v[136:139], v[168:183]
    ds_read_b64_tr_b16 v[152:153], v16 offset:20480
    ds_read_b64_tr_b16 v[154:155], v16 offset:21504
    ds_read_b64_tr_b16 v[156:157], v17 offset:20480
    ds_read_b64_tr_b16 v[158:159], v17 offset:21504
    s_waitcnt lgkmcnt(8)
    v_mfma_f32_32x32x16_bf16 v[184:199], v[120:123], v[140:143], v[184:199]
    ds_read_b64_tr_b16 v[160:161], v18 offset:20480
    ds_read_b64_tr_b16 v[162:163], v18 offset:21504
    ds_read_b64_tr_b16 v[164:165], v19 offset:20480
    ds_read_b64_tr_b16 v[166:167], v19 offset:21504
    s_waitcnt lgkmcnt(10)
    v_mfma_f32_32x32x16_bf16 v[200:215], v[120:123], v[144:147], v[200:215]
    s_waitcnt lgkmcnt(8)
    v_mfma_f32_32x32x16_bf16 v[216:231], v[120:123], v[148:151], v[216:231]
    s_waitcnt vmcnt(22) lgkmcnt(0)
    s_barrier
    v_mfma_f32_32x32x16_bf16 v[168:183], v[124:127], v[152:155], v[168:183]
    ds_read_b64_tr_b16 v[136:137], v16 offset:24576
    ds_read_b64_tr_b16 v[138:139], v16 offset:25600
    ds_read_b64_tr_b16 v[140:141], v17 offset:24576
    v_mfma_f32_32x32x16_bf16 v[184:199], v[124:127], v[156:159], v[184:199]
    ds_read_b64_tr_b16 v[142:143], v17 offset:25600
    ds_read_b64_tr_b16 v[144:145], v18 offset:24576
    ds_read_b64_tr_b16 v[146:147], v18 offset:25600
    v_mfma_f32_32x32x16_bf16 v[200:215], v[124:127], v[160:163], v[200:215]
    ds_read_b64_tr_b16 v[148:149], v19 offset:24576
    ds_read_b64_tr_b16 v[150:151], v19 offset:25600
    v_mfma_f32_32x32x16_bf16 v[216:231], v[124:127], v[164:167], v[216:231]
    s_mov_b32 s3, 0
    s_waitcnt vmcnt(12)
    s_branch L_gr_4_b
L_gr_4:
    s_waitcnt vmcnt(0)
L_gr_4_b:
    v_readfirstlane_b32 s44, v32
    v_readfirstlane_b32 s45, v33
    v_xor_b32 v23, v32, v30
    v_xor_b32 v24, v33, v31
    v_or_b32 v23, v23, v24
    v_xor_b32 v24, v32, v37
    v_xor_b32 v25, v32, v39
    v_or3_b32 v23, v23, v24, v25
    v_xor_b32 v24, v32, v41
    v_xor_b32 v25, v32, v43
    v_or3_b32 v23, v23, v24, v25
    v_xor_b32 v24, v32, v45
    v_xor_b32 v25, v32, v47
    v_or3_b32 v23, v23, v24, v25
    v_xor_b32 v24, v32, v49
    v_xor_b32 v25, v32, v51
    v_or3_b32 v23, v23, v24, v25
    v_xor_b32 v24, v32, v53
    v_xor_b32 v25, v32, v55
    v_or3_b32 v23, v23, v24, v25
    v_xor_b32 v24, v32, v57
    v_xor_b32 v25, v32, v59
    v_or3_b32 v23, v23, v24, v25
    v_xor_b32 v24, v32, v61
    v_xor_b32 v25, v32, v63
    v_or3_b32 v23, v23, v24, v25
    v_xor_b32 v24, v32, v65
    v_xor_b32 v25, v32, v67
    v_or3_b32 v23, v23, v24, v25
    v_cmp_ne_u32 vcc, 0, v23
    s_cmp_eq_u32 s44, 0
    s_cselect_b64 vcc, -1, vcc
    s_cmp_eq_u64 vcc, 0
    s_cbranch_scc1 L_grok_5
    buffer_load_dwordx2 v[32:33], v4, s[28:31], 0 offen sc1
    buffer_load_dwordx4 v[28:31], v5, s[24:27], 0 offen sc1
    buffer_load_dwordx4 v[36:39], v22, s[24:27], 0 offen offset:0 sc1
    buffer_load_dwordx4 v[40:43], v22, s[24:27], 0 offen offset:16 sc1
    buffer_load_dwordx4 v[44:47], v22, s[24:27], 0 offen offset:1024 sc1
    buffer_load_dwordx4 v[48:51], v22, s[24:27], 0 offen offset:1040 sc1
    buffer_load_dwordx4 v[52:55], v22, s[24:27], 0 offen offset:2048 sc1
    buffer_load_dwordx4 v[56:59], v22, s[24:27], 0 offen offset:2064 sc1
    buffer_load_dwordx4 v[60:63], v22, s[24:27], 0 offen offset:3072 sc1
    buffer_load_dwordx4 v[64:67], v22, s[24:27], 0 offen offset:3088 sc1
    s_add_u32 s3, s3, 1
    s_cmp_gt_u32 s3, 40000
    s_cbranch_scc1 L_end
    s_branch L_gr_4
L_grok_5:
    buffer_store_dwordx4 v[244:247], v240, s[24:27], s63 offen offset:1280 sc1
    s_mov_b32 s60, -1
    s_mov_b32 s61, 0
    s_waitcnt lgkmcnt(0)
    v_mfma_f32_32x32x16_bf16 v[168:183], v[128:131], v[136:139], v[168:183]
    ds_read_b64_tr_b16 v[152:153], v16 offset:28672
    ds_read_b64_tr_b16 v[154:155], v16 offset:29696
    ds_read_b64_tr_b16 v[156:157], v17 offset:28672
    ds_write_b32 v20, v29
    v_cvt_pk_bf16_f32 v84, v28, v28
    v_cvt_pk_bf16_f32 v85, v28, 0
    v_add_f32 v36, v36, v38
    v_add_f32 v40, v40, v42
    v_add_f32 v36, v36, v40
    v_cvt_pk_bf16_f32 v37, v36, v36
    v_mfma_f32_32x32x16_bf16 v[184:199], v[128:131], v[140:143], v[184:199]
    ds_read_b64_tr_b16 v[158:159], v17 offset:29696
    ds_read_b64_tr_b16 v[160:161], v18 offset:28672
    ds_read_b64_tr_b16 v[162:163], v18 offset:29696
    v_and_b32 v37, 0xffff0000, v37
    v_sub_f32 v37, v36, v37
    v_cvt_pk_bf16_f32 v38, v37, v37
    v_and_b32 v38, 0xffff0000, v38
    v_sub_f32 v38, v37, v38
    v_cvt_pk_bf16_f32 v36, v36, v37
    v_cvt_pk_bf16_f32 v38, v38, 0
    v_mfma_f32_32x32x16_bf16 v[200:215], v[128:131], v[144:147], v[200:215]
    ds_read_b64_tr_b16 v[164:165], v19 offset:28672
    ds_read_b64_tr_b16 v[166:167], v19 offset:29696
    v_cndmask_b32 v68, 0, v36, s[60:61]
    v_cndmask_b32 v69, 0, v38, s[60:61]
    v_add_f32 v44, v44, v46
    v_add_f32 v48, v48, v50
    v_add_f32 v44, v44, v48
    v_cvt_pk_bf16_f32 v45, v44, v44
    v_and_b32 v45, 0xffff0000, v45
    v_mfma_f32_32x32x16_bf16 v[216:231], v[128:131], v[148:151], v[216:231]
    v_sub_f32 v45, v44, v45
    v_cvt_pk_bf16_f32 v46, v45, v45
    v_and_b32 v46, 0xffff0000, v46
    v_sub_f32 v46, v45, v46
    v_cvt_pk_bf16_f32 v44, v44, v45
    v_cvt_pk_bf16_f32 v46, v46, 0
    s_waitcnt lgkmcnt(0)
    v_mfma_f32_32x32x16_bf16 v[168:183], v[132:135], v[152:155], v[168:183]
    ds_read_b128 v[88:91], v21 offset:0
    ds_read_b128 v[92:95], v21 offset:32
    v_cndmask_b32 v72, 0, v44, s[60:61]
    v_cndmask_b32 v73, 0, v46, s[60:61]
    v_add_f32 v52, v52, v54
    v_add_f32 v56, v56, v58
    v_add_f32 v52, v52, v56
    v_cvt_pk_bf16_f32 v53, v52, v52
    v_and_b32 v53, 0xffff0000, v53
    v_mfma_f32_32x32x16_bf16 v[184:199], v[132:135], v[156:159], v[184:199]
    ds_read_b128 v[96:99], v21 offset:64
    ds_read_b128 v[100:103], v21 offset:96
    v_sub_f32 v53, v52, v53
    v_cvt_pk_bf16_f32 v54, v53, v53
    v_and_b32 v54, 0xffff0000, v54
    v_sub_f32 v54, v53, v54
    v_cvt_pk_bf16_f32 v52, v52, v53
    v_cvt_pk_bf16_f32 v54, v54, 0
    v_cndmask_b32 v76, 0, v52, s[60:61]
    v_mfma_f32_32x32x16_bf16 v[200:215], v[132:135], v[160:163], v[200:215]
    v_cndmask_b32 v77, 0, v54, s[60:61]
    v_add_f32 v60, v60, v62
    v_add_f32 v64, v64, v66
    v_add_f32 v60, v60, v64
    v_cvt_pk_bf16_f32 v61, v60, v60
    v_and_b32 v61, 0xffff0000, v61
    v_sub_f32 v61, v60, v61
    v_mfma_f32_32x32x16_bf16 v[216:231], v[132:135], v[164:167], v[216:231]
    v_cvt_pk_bf16_f32 v62, v61, v61
    v_and_b32 v62, 0xffff0000, v62
    v_sub_f32 v62, v61, v62
    v_cvt_pk_bf16_f32 v60, v60, v61
    v_cvt_pk_bf16_f32 v62, v62, 0
    v_cndmask_b32 v80, 0, v60, s[60:61]
    v_cndmask_b32 v81, 0, v62, s[60:61]
    s_cmp_lg_u32 s46, 0
    s_cbranch_scc1 L_ph_6
    s_add_u32 s56, s95, 500
    s_lshl_b32 s57, s47, 7
    s_add_u32 s57, s57, 0x1d04000
    v_mov_b32 v23, s56
    v_mov_b32 v4, 0
    s_mov_b64 exec, 1
    buffer_store_dword v23, v4, s[24:27], s57 offen
    s_mov_b64 exec, -1
L_ph_6:
    v_mfma_f32_32x32x16_bf16 v[168:183], v[84:87], v[68:71], v[168:183]
    v_mfma_f32_32x32x16_bf16 v[184:199], v[84:87], v[72:75], v[184:199]
    v_mfma_f32_32x32x16_bf16 v[200:215], v[84:87], v[76:79], v[200:215]
    v_mfma_f32_32x32x16_bf16 v[216:231], v[84:87], v[80:83], v[216:231]
    s_waitcnt lgkmcnt(0)
    s_nop 7
    v_pk_mul_f32 v[168:169], v[168:169], v[88:89]
    v_pk_mul_f32 v[170:171], v[170:171], v[90:91]
    v_pk_mul_f32 v[172:173], v[172:173], v[92:93]
    v_pk_mul_f32 v[174:175], v[174:175], v[94:95]
    v_pk_mul_f32 v[176:177], v[176:177], v[96:97]
    v_pk_mul_f32 v[178:179], v[178:179], v[98:99]
    v_pk_mul_f32 v[180:181], v[180:181], v[100:101]
    v_pk_mul_f32 v[182:183], v[182:183], v[102:103]
    v_cvt_pk_bf16_f32 v168, v168, v169
    v_cvt_pk_bf16_f32 v169, v170, v171
    v_cvt_pk_bf16_f32 v170, v172, v173
    v_cvt_pk_bf16_f32 v171, v174, v175
    v_cvt_pk_bf16_f32 v172, v176, v177
    v_cvt_pk_bf16_f32 v173, v178, v179
    v_cvt_pk_bf16_f32 v174, v180, v181
    v_cvt_pk_bf16_f32 v175, v182, v183
    buffer_store_dwordx4 v[168:171], v236, s[24:27], s63 offen sc1
    buffer_store_dwordx4 v[172:175], v236, s[24:27], s63 offen offset:2816 sc1
    v_pk_mul_f32 v[184:185], v[184:185], v[88:89]
    v_pk_mul_f32 v[186:187], v[186:187], v[90:91]
    v_pk_mul_f32 v[188:189], v[188:189], v[92:93]
    v_pk_mul_f32 v[190:191], v[190:191], v[94:95]
    v_pk_mul_f32 v[192:193], v[192:193], v[96:97]
    v_pk_mul_f32 v[194:195], v[194:195], v[98:99]
    v_pk_mul_f32 v[196:197], v[196:197], v[100:101]
    v_pk_mul_f32 v[198:199], v[198:199], v[102:103]
    v_cvt_pk_bf16_f32 v184, v184, v185
    v_cvt_pk_bf16_f32 v185, v186, v187
    v_cvt_pk_bf16_f32 v186, v188, v189
    v_cvt_pk_bf16_f32 v187, v190, v191
    v_cvt_pk_bf16_f32 v188, v192, v193
    v_cvt_pk_bf16_f32 v189, v194, v195
    v_cvt_pk_bf16_f32 v190, v196, v197
    v_cvt_pk_bf16_f32 v191, v198, v199
    buffer_store_dwordx4 v[184:187], v237, s[24:27], s63 offen sc1
    buffer_store_dwordx4 v[188:191], v237, s[24:27], s63 offen offset:2816 sc1
    v_pk_mul_f32 v[200:201], v[200:201], v[88:89]
    v_pk_mul_f32 v[202:203], v[202:203], v[90:91]
    v_pk_mul_f32 v[204:205], v[204:205], v[92:93]
    v_pk_mul_f32 v[206:207], v[206:207], v[94:95]
    v_pk_mul_f32 v[208:209], v[208:209], v[96:97]
    v_pk_mul_f32 v[210:211], v[210:211], v[98:99]
    v_pk_mul_f32 v[212:213], v[212:213], v[100:101]
    v_pk_mul_f32 v[214:215], v[214:215], v[102:103]
    v_cvt_pk_bf16_f32 v200, v200, v201
    v_cvt_pk_bf16_f32 v201, v202, v203
    v_cvt_pk_bf16_f32 v202, v204, v205
    v_cvt_pk_bf16_f32 v203, v206, v207
    v_cvt_pk_bf16_f32 v204, v208, v209
    v_cvt_pk_bf16_f32 v205, v210, v211
    v_cvt_pk_bf16_f32 v206, v212, v213
    v_cvt_pk_bf16_f32 v207, v214, v215
    buffer_store_dwordx4 v[200:203], v238, s[24:27], s63 offen sc1
    buffer_store_dwordx4 v[204:207], v238, s[24:27], s63 offen offset:2816 sc1
    v_pk_mul_f32 v[216:217], v[216:217], v[88:89]
    v_pk_mul_f32 v[218:219], v[218:219], v[90:91]
    v_pk_mul_f32 v[220:221], v[220:221], v[92:93]
    v_pk_mul_f32 v[222:223], v[222:223], v[94:95]
    v_pk_mul_f32 v[224:225], v[224:225], v[96:97]
    v_pk_mul_f32 v[226:227], v[226:227], v[98:99]
    v_pk_mul_f32 v[228:229], v[228:229], v[100:101]
    v_pk_mul_f32 v[230:231], v[230:231], v[102:103]
    v_cvt_pk_bf16_f32 v216, v216, v217
    v_cvt_pk_bf16_f32 v217, v218, v219
    v_cvt_pk_bf16_f32 v218, v220, v221
    v_cvt_pk_bf16_f32 v219, v222, v223
    v_cvt_pk_bf16_f32 v220, v224, v225
    v_cvt_pk_bf16_f32 v221, v226, v227
    v_cvt_pk_bf16_f32 v222, v228, v229
    v_cvt_pk_bf16_f32 v223, v230, v231
    buffer_store_dwordx4 v[216:219], v239, s[24:27], s63 offen sc1
    buffer_store_dwordx4 v[220:223], v239, s[24:27], s63 offen offset:2816 sc1
    s_branch L_ps_1_0
L_pw_a1_0:
    s_branch L_pw_a1_1
L_pw_b1_0:
    s_branch L_pw_b1_1
L_pw_c1_0:
    s_branch L_pw_c1_1
L_ps_1_0:
L_qkv_done:
    s_lshl_b32 s56, s49, 8
    s_lshl_b32 s57, s48, 3
    s_add_u32 s56, s56, s57
    s_add_u32 s56, s56, 0x1d01000
    s_waitcnt vmcnt(0)
    s_barrier
    s_cmp_lg_u32 s46, 0
    s_cbranch_scc1 L_sig_7
    v_mov_b32 v28, s44
    v_mov_b32 v29, s45
    v_mov_b32 v30, 0
    s_mov_b64 exec, 1
    buffer_store_dwordx2 v[28:29], v30, s[24:27], s56 offen sc1
    s_mov_b64 exec, -1
L_sig_7:
    s_branch L_att
L_noqkv:
    v_mov_b32 v4, 0
    s_mov_b32 s3, 0
L_tag_8:
    buffer_load_dwordx2 v[2:3], v4, s[28:31], 0 offen offset:128 sc1
    s_add_u32 s3, s3, 1
    s_cmp_gt_u32 s3, 40000
    s_cbranch_scc1 L_end
    s_waitcnt vmcnt(0)
    v_readfirstlane_b32 s44, v2
    v_readfirstlane_b32 s45, v3
    s_nop 3
    s_cmp_eq_u32 s44, 0
    s_cbranch_scc1 L_tag_8
    s_bfe_u32 s48, s47, 0x20001
    s_bfe_u32 s49, s47, 0x10003
    s_lshl_b32 s49, s49, 1
    s_and_b32 s60, s47, 1
    s_add_u32 s49, s49, s60
    s_add_u32 s49, s49, 0
    s_mul_i32 s60, s48, 7
    s_add_u32 s60, s60, s49
    s_cmp_ge_u32 s49, 7
    s_cbranch_scc1 L_cs2c_end
    s_cmp_ge_u32 s60, 27
    s_cbranch_scc1 L_cs2c_end
    s_lshl_b32 s50, s60, 7
    s_lshl_b32 s51, s60, 11
    s_add_u32 s51, s51, 0x1c20000
    s_mov_b32 s32, s12
    s_and_b32 s33, s13, 0xffff
    s_mov_b32 s34, 0x21c000
    s_mov_b32 s35, 0x00020000
    v_and_b32 v1, 63, v0
    v_lshrrev_b32 v2, 3, v1
    v_and_b32 v3, 7, v1
    v_mul_u32_u24 v2, 3456, v2
    v_lshl_add_u32 v3, v3, 4, v2
    s_and_b32 s60, s46, 1
    s_mul_i32 s60, s60, 1105920
    s_add_u32 s60, s60, s50
    s_cmp_lt_u32 s46, 2
    s_cbranch_scc1 L_cs_c_a
    s_mov_b32 s32, s14
    s_and_b32 s33, s15, 0xffff
    s_mov_b32 s34, 0x21c000
    s_mov_b32 s35, 0x00020000
L_cs_c_a:
    buffer_load_dwordx4 v[16:19], v3, s[32:35], s60 offen
    s_add_u32 s60, s60, 27648
    buffer_load_dwordx4 v[20:23], v3, s[32:35], s60 offen
    s_add_u32 s60, s60, 27648
    buffer_load_dwordx4 v[24:27], v3, s[32:35], s60 offen
    s_add_u32 s60, s60, 27648
    buffer_load_dwordx4 v[28:31], v3, s[32:35], s60 offen
    s_add_u32 s60, s60, 27648
    buffer_load_dwordx4 v[32:35], v3, s[32:35], s60 offen
    s_add_u32 s60, s60, 27648
    buffer_load_dwordx4 v[36:39], v3, s[32:35], s60 offen
    s_add_u32 s60, s60, 27648
    buffer_load_dwordx4 v[40:43], v3, s[32:35], s60 offen
    s_add_u32 s60, s60, 27648
    buffer_load_dwordx4 v[44:47], v3, s[32:35], s60 offen
    s_add_u32 s60, s60, 27648
    v_mov_b32 v240, 0
    v_mov_b32 v241, 0
    v_mov_b32 v242, 0
    v_mov_b32 v243, 0
    v_mov_b32 v244, 0
    v_mov_b32 v245, 0
    v_mov_b32 v246, 0
    v_mov_b32 v247, 0
    s_waitcnt vmcnt(7)
    buffer_load_dwordx4 v[48:51], v3, s[32:35], s60 offen
    s_add_u32 s60, s60, 27648
    v_lshlrev_b32 v6, 16, v16
    v_and_b32 v7, 0xffff0000, v16
    v_add_f32 v240, v240, v6
    v_add_f32 v241, v241, v7
    v_lshlrev_b32 v6, 16, v17
    v_and_b32 v7, 0xffff0000, v17
    v_add_f32 v242, v242, v6
    v_add_f32 v243, v243, v7
    v_lshlrev_b32 v6, 16, v18
    v_and_b32 v7, 0xffff0000, v18
    v_add_f32 v244, v244, v6
    v_add_f32 v245, v245, v7
    v_lshlrev_b32 v6, 16, v19
    v_and_b32 v7, 0xffff0000, v19
    v_add_f32 v246, v246, v6
    v_add_f32 v247, v247, v7
    s_waitcnt vmcnt(7)
    buffer_load_dwordx4 v[52:55], v3, s[32:35], s60 offen
    s_add_u32 s60, s60, 27648
    v_lshlrev_b32 v6, 16, v20
    v_and_b32 v7, 0xffff0000, v20
    v_add_f32 v240, v240, v6
    v_add_f32 v241, v241, v7
    v_lshlrev_b32 v6, 16, v21
    v_and_b32 v7, 0xffff0000, v21
    v_add_f32 v242, v242, v6
    v_add_f32 v243, v243, v7
    v_lshlrev_b32 v6, 16, v22
    v_and_b32 v7, 0xffff0000, v22
    v_add_f32 v244, v244, v6
    v_add_f32 v245, v245, v7
    v_lshlrev_b32 v6, 16, v23
    v_and_b32 v7, 0xffff0000, v23
    v_add_f32 v246, v246, v6
    v_add_f32 v247, v247, v7
    s_waitcnt vmcnt(7)
    buffer_load_dwordx4 v[56:59], v3, s[32:35], s60 offen
    s_add_u32 s60, s60, 27648
    v_lshlrev_b32 v6, 16, v24
    v_and_b32 v7, 0xffff0000, v24
    v_add_f32 v240, v240, v6
    v_add_f32 v241, v241, v7
    v_lshlrev_b32 v6, 16, v25
    v_and_b32 v7, 0xffff0000, v25
    v_add_f32 v242, v242, v6
    v_add_f32 v243, v243, v7
    v_lshlrev_b32 v6, 16, v26
    v_and_b32 v7, 0xffff0000, v26
    v_add_f32 v244, v244, v6
    v_add_f32 v245, v245, v7
    v_lshlrev_b32 v6, 16, v27
    v_and_b32 v7, 0xffff0000, v27
    v_add_f32 v246, v246, v6
    v_add_f32 v247, v247, v7
    s_waitcnt vmcnt(7)
    buffer_load_dwordx4 v[60:63], v3, s[32:35], s60 offen
    s_add_u32 s60, s60, 27648
    v_lshlrev_b32 v6, 16, v28
    v_and_b32 v7, 0xffff0000, v28
    v_add_f32 v240, v240, v6
    v_add_f32 v241, v241, v7
    v_lshlrev_b32 v6, 16, v29
    v_and_b32 v7, 0xffff0000, v29
    v_add_f32 v242, v242, v6
    v_add_f32 v243, v243, v7
    v_lshlrev_b32 v6, 16, v30
    v_and_b32 v7, 0xffff0000, v30
    v_add_f32 v244, v244, v6
    v_add_f32 v245, v245, v7
    v_lshlrev_b32 v6, 16, v31
    v_and_b32 v7, 0xffff0000, v31
    v_add_f32 v246, v246, v6
    v_add_f32 v247, v247, v7
    s_waitcnt vmcnt(7)
    buffer_load_dwordx4 v[64:67], v3, s[32:35], s60 offen
    s_add_u32 s60, s60, 27648
    v_lshlrev_b32 v6, 16, v32
    v_and_b32 v7, 0xffff0000, v32
    v_add_f32 v240, v240, v6
    v_add_f32 v241, v241, v7
    v_lshlrev_b32 v6, 16, v33
    v_and_b32 v7, 0xffff0000, v33
    v_add_f32 v242, v242, v6
    v_add_f32 v243, v243, v7
    v_lshlrev_b32 v6, 16, v34
    v_and_b32 v7, 0xffff0000, v34
    v_add_f32 v244, v244, v6
    v_add_f32 v245, v245, v7
    v_lshlrev_b32 v6, 16, v35
    v_and_b32 v7, 0xffff0000, v35
    v_add_f32 v246, v246, v6
    v_add_f32 v247, v247, v7
    s_waitcnt vmcnt(7)
    buffer_load_dwordx4 v[68:71], v3, s[32:35], s60 offen
    s_add_u32 s60, s60, 27648
    v_lshlrev_b32 v6, 16, v36
    v_and_b32 v7, 0xffff0000, v36
    v_add_f32 v240, v240, v6
    v_add_f32 v241, v241, v7
    v_lshlrev_b32 v6, 16, v37
    v_and_b32 v7, 0xffff0000, v37
    v_add_f32 v242, v242, v6
    v_add_f32 v243, v243, v7
    v_lshlrev_b32 v6, 16, v38
    v_and_b32 v7, 0xffff0000, v38
    v_add_f32 v244, v244, v6
    v_add_f32 v245, v245, v7
    v_lshlrev_b32 v6, 16, v39
    v_and_b32 v7, 0xffff0000, v39
    v_add_f32 v246, v246, v6
    v_add_f32 v247, v247, v7
    s_waitcnt vmcnt(7)
    buffer_load_dwordx4 v[72:75], v3, s[32:35], s60 offen
    s_add_u32 s60, s60, 27648
    v_lshlrev_b32 v6, 16, v40
    v_and_b32 v7, 0xffff0000, v40
    v_add_f32 v240, v240, v6
    v_add_f32 v241, v241, v7
    v_lshlrev_b32 v6, 16, v41
    v_and_b32 v7, 0xffff0000, v41
    v_add_f32 v242, v242, v6
    v_add_f32 v243, v243, v7
    v_lshlrev_b32 v6, 16, v42
    v_and_b32 v7, 0xffff0000, v42
    v_add_f32 v244, v244, v6
    v_add_f32 v245, v245, v7
    v_lshlrev_b32 v6, 16, v43
    v_and_b32 v7, 0xffff0000, v43
    v_add_f32 v246, v246, v6
    v_add_f32 v247, v247, v7
    s_waitcnt vmcnt(7)
    buffer_load_dwordx4 v[76:79], v3, s[32:35], s60 offen
    s_add_u32 s60, s60, 27648
    v_lshlrev_b32 v6, 16, v44
    v_and_b32 v7, 0xffff0000, v44
    v_add_f32 v240, v240, v6
    v_add_f32 v241, v241, v7
    v_lshlrev_b32 v6, 16, v45
    v_and_b32 v7, 0xffff0000, v45
    v_add_f32 v242, v242, v6
    v_add_f32 v243, v243, v7
    v_lshlrev_b32 v6, 16, v46
    v_and_b32 v7, 0xffff0000, v46
    v_add_f32 v244, v244, v6
    v_add_f32 v245, v245, v7
    v_lshlrev_b32 v6, 16, v47
    v_and_b32 v7, 0xffff0000, v47
    v_add_f32 v246, v246, v6
    v_add_f32 v247, v247, v7
    s_waitcnt vmcnt(7)
    buffer_load_dwordx4 v[80:83], v3, s[32:35], s60 offen
    s_add_u32 s60, s60, 27648
    v_lshlrev_b32 v6, 16, v48
    v_and_b32 v7, 0xffff0000, v48
    v_add_f32 v240, v240, v6
    v_add_f32 v241, v241, v7
    v_lshlrev_b32 v6, 16, v49
    v_and_b32 v7, 0xffff0000, v49
    v_add_f32 v242, v242, v6
    v_add_f32 v243, v243, v7
    v_lshlrev_b32 v6, 16, v50
    v_and_b32 v7, 0xffff0000, v50
    v_add_f32 v244, v244, v6
    v_add_f32 v245, v245, v7
    v_lshlrev_b32 v6, 16, v51
    v_and_b32 v7, 0xffff0000, v51
    v_add_f32 v246, v246, v6
    v_add_f32 v247, v247, v7
    s_waitcnt vmcnt(7)
    buffer_load_dwordx4 v[84:87], v3, s[32:35], s60 offen
    s_add_u32 s60, s60, 27648
    v_lshlrev_b32 v6, 16, v52
    v_and_b32 v7, 0xffff0000, v52
    v_add_f32 v240, v240, v6
    v_add_f32 v241, v241, v7
    v_lshlrev_b32 v6, 16, v53
    v_and_b32 v7, 0xffff0000, v53
    v_add_f32 v242, v242, v6
    v_add_f32 v243, v243, v7
    v_lshlrev_b32 v6, 16, v54
    v_and_b32 v7, 0xffff0000, v54
    v_add_f32 v244, v244, v6
    v_add_f32 v245, v245, v7
    v_lshlrev_b32 v6, 16, v55
    v_and_b32 v7, 0xffff0000, v55
    v_add_f32 v246, v246, v6
    v_add_f32 v247, v247, v7
    s_waitcnt vmcnt(7)
    buffer_load_dwordx4 v[88:91], v3, s[32:35], s60 offen
    s_add_u32 s60, s60, 27648
    v_lshlrev_b32 v6, 16, v56
    v_and_b32 v7, 0xffff0000, v56
    v_add_f32 v240, v240, v6
    v_add_f32 v241, v241, v7
    v_lshlrev_b32 v6, 16, v57
    v_and_b32 v7, 0xffff0000, v57
    v_add_f32 v242, v242, v6
    v_add_f32 v243, v243, v7
    v_lshlrev_b32 v6, 16, v58
    v_and_b32 v7, 0xffff0000, v58
    v_add_f32 v244, v244, v6
    v_add_f32 v245, v245, v7
    v_lshlrev_b32 v6, 16, v59
    v_and_b32 v7, 0xffff0000, v59
    v_add_f32 v246, v246, v6
    v_add_f32 v247, v247, v7
    s_waitcnt vmcnt(7)
    buffer_load_dwordx4 v[92:95], v3, s[32:35], s60 offen
    s_add_u32 s60, s60, 27648
    v_lshlrev_b32 v6, 16, v60
    v_and_b32 v7, 0xffff0000, v60
    v_add_f32 v240, v240, v6
    v_add_f32 v241, v241, v7
    v_lshlrev_b32 v6, 16, v61
    v_and_b32 v7, 0xffff0000, v61
    v_add_f32 v242, v242, v6
    v_add_f32 v243, v243, v7
    v_lshlrev_b32 v6, 16, v62
    v_and_b32 v7, 0xffff0000, v62
    v_add_f32 v244, v244, v6
    v_add_f32 v245, v245, v7
    v_lshlrev_b32 v6, 16, v63
    v_and_b32 v7, 0xffff0000, v63
    v_add_f32 v246, v246, v6
    v_add_f32 v247, v247, v7
    s_waitcnt vmcnt(7)
    buffer_load_dwordx4 v[96:99], v3, s[32:35], s60 offen
    s_add_u32 s60, s60, 27648
    v_lshlrev_b32 v6, 16, v64
    v_and_b32 v7, 0xffff0000, v64
    v_add_f32 v240, v240, v6
    v_add_f32 v241, v241, v7
    v_lshlrev_b32 v6, 16, v65
    v_and_b32 v7, 0xffff0000, v65
    v_add_f32 v242, v242, v6
    v_add_f32 v243, v243, v7
    v_lshlrev_b32 v6, 16, v66
    v_and_b32 v7, 0xffff0000, v66
    v_add_f32 v244, v244, v6
    v_add_f32 v245, v245, v7
    v_lshlrev_b32 v6, 16, v67
    v_and_b32 v7, 0xffff0000, v67
    v_add_f32 v246, v246, v6
    v_add_f32 v247, v247, v7
    s_waitcnt vmcnt(7)
    buffer_load_dwordx4 v[100:103], v3, s[32:35], s60 offen
    s_add_u32 s60, s60, 27648
    v_lshlrev_b32 v6, 16, v68
    v_and_b32 v7, 0xffff0000, v68
    v_add_f32 v240, v240, v6
    v_add_f32 v241, v241, v7
    v_lshlrev_b32 v6, 16, v69
    v_and_b32 v7, 0xffff0000, v69
    v_add_f32 v242, v242, v6
    v_add_f32 v243, v243, v7
    v_lshlrev_b32 v6, 16, v70
    v_and_b32 v7, 0xffff0000, v70
    v_add_f32 v244, v244, v6
    v_add_f32 v245, v245, v7
    v_lshlrev_b32 v6, 16, v71
    v_and_b32 v7, 0xffff0000, v71
    v_add_f32 v246, v246, v6
    v_add_f32 v247, v247, v7
    s_waitcnt vmcnt(7)
    buffer_load_dwordx4 v[104:107], v3, s[32:35], s60 offen
    s_add_u32 s60, s60, 27648
    v_lshlrev_b32 v6, 16, v72
    v_and_b32 v7, 0xffff0000, v72
    v_add_f32 v240, v240, v6
    v_add_f32 v241, v241, v7
    v_lshlrev_b32 v6, 16, v73
    v_and_b32 v7, 0xffff0000, v73
    v_add_f32 v242, v242, v6
    v_add_f32 v243, v243, v7
    v_lshlrev_b32 v6, 16, v74
    v_and_b32 v7, 0xffff0000, v74
    v_add_f32 v244, v244, v6
    v_add_f32 v245, v245, v7
    v_lshlrev_b32 v6, 16, v75
    v_and_b32 v7, 0xffff0000, v75
    v_add_f32 v246, v246, v6
    v_add_f32 v247, v247, v7
    s_waitcnt vmcnt(7)
    buffer_load_dwordx4 v[108:111], v3, s[32:35], s60 offen
    s_add_u32 s60, s60, 27648
    v_lshlrev_b32 v6, 16, v76
    v_and_b32 v7, 0xffff0000, v76
    v_add_f32 v240, v240, v6
    v_add_f32 v241, v241, v7
    v_lshlrev_b32 v6, 16, v77
    v_and_b32 v7, 0xffff0000, v77
    v_add_f32 v242, v242, v6
    v_add_f32 v243, v243, v7
    v_lshlrev_b32 v6, 16, v78
    v_and_b32 v7, 0xffff0000, v78
    v_add_f32 v244, v244, v6
    v_add_f32 v245, v245, v7
    v_lshlrev_b32 v6, 16, v79
    v_and_b32 v7, 0xffff0000, v79
    v_add_f32 v246, v246, v6
    v_add_f32 v247, v247, v7
    s_waitcnt vmcnt(7)
    buffer_load_dwordx4 v[112:115], v3, s[32:35], s60 offen
    s_add_u32 s60, s60, 27648
    v_lshlrev_b32 v6, 16, v80
    v_and_b32 v7, 0xffff0000, v80
    v_add_f32 v240, v240, v6
    v_add_f32 v241, v241, v7
    v_lshlrev_b32 v6, 16, v81
    v_and_b32 v7, 0xffff0000, v81
    v_add_f32 v242, v242, v6
    v_add_f32 v243, v243, v7
    v_lshlrev_b32 v6, 16, v82
    v_and_b32 v7, 0xffff0000, v82
    v_add_f32 v244, v244, v6
    v_add_f32 v245, v245, v7
    v_lshlrev_b32 v6, 16, v83
    v_and_b32 v7, 0xffff0000, v83
    v_add_f32 v246, v246, v6
    v_add_f32 v247, v247, v7
    s_waitcnt vmcnt(7)
    buffer_load_dwordx4 v[116:119], v3, s[32:35], s60 offen
    s_add_u32 s60, s60, 27648
    v_lshlrev_b32 v6, 16, v84
    v_and_b32 v7, 0xffff0000, v84
    v_add_f32 v240, v240, v6
    v_add_f32 v241, v241, v7
    v_lshlrev_b32 v6, 16, v85
    v_and_b32 v7, 0xffff0000, v85
    v_add_f32 v242, v242, v6
    v_add_f32 v243, v243, v7
    v_lshlrev_b32 v6, 16, v86
    v_and_b32 v7, 0xffff0000, v86
    v_add_f32 v244, v244, v6
    v_add_f32 v245, v245, v7
    v_lshlrev_b32 v6, 16, v87
    v_and_b32 v7, 0xffff0000, v87
    v_add_f32 v246, v246, v6
    v_add_f32 v247, v247, v7
    s_waitcnt vmcnt(7)
    buffer_load_dwordx4 v[120:123], v3, s[32:35], s60 offen
    s_add_u32 s60, s60, 27648
    v_lshlrev_b32 v6, 16, v88
    v_and_b32 v7, 0xffff0000, v88
    v_add_f32 v240, v240, v6
    v_add_f32 v241, v241, v7
    v_lshlrev_b32 v6, 16, v89
    v_and_b32 v7, 0xffff0000, v89
    v_add_f32 v242, v242, v6
    v_add_f32 v243, v243, v7
    v_lshlrev_b32 v6, 16, v90
    v_and_b32 v7, 0xffff0000, v90
    v_add_f32 v244, v244, v6
    v_add_f32 v245, v245, v7
    v_lshlrev_b32 v6, 16, v91
    v_and_b32 v7, 0xffff0000, v91
    v_add_f32 v246, v246, v6
    v_add_f32 v247, v247, v7
    s_waitcnt vmcnt(7)
    buffer_load_dwordx4 v[124:127], v3, s[32:35], s60 offen
    s_add_u32 s60, s60, 27648
    v_lshlrev_b32 v6, 16, v92
    v_and_b32 v7, 0xffff0000, v92
    v_add_f32 v240, v240, v6
    v_add_f32 v241, v241, v7
    v_lshlrev_b32 v6, 16, v93
    v_and_b32 v7, 0xffff0000, v93
    v_add_f32 v242, v242, v6
    v_add_f32 v243, v243, v7
    v_lshlrev_b32 v6, 16, v94
    v_and_b32 v7, 0xffff0000, v94
    v_add_f32 v244, v244, v6
    v_add_f32 v245, v245, v7
    v_lshlrev_b32 v6, 16, v95
    v_and_b32 v7, 0xffff0000, v95
    v_add_f32 v246, v246, v6
    v_add_f32 v247, v247, v7
    s_waitcnt vmcnt(7)
    buffer_load_dwordx4 v[128:131], v3, s[32:35], s60 offen
    s_add_u32 s60, s60, 27648
    v_lshlrev_b32 v6, 16, v96
    v_and_b32 v7, 0xffff0000, v96
    v_add_f32 v240, v240, v6
    v_add_f32 v241, v241, v7
    v_lshlrev_b32 v6, 16, v97
    v_and_b32 v7, 0xffff0000, v97
    v_add_f32 v242, v242, v6
    v_add_f32 v243, v243, v7
    v_lshlrev_b32 v6, 16, v98
    v_and_b32 v7, 0xffff0000, v98
    v_add_f32 v244, v244, v6
    v_add_f32 v245, v245, v7
    v_lshlrev_b32 v6, 16, v99
    v_and_b32 v7, 0xffff0000, v99
    v_add_f32 v246, v246, v6
    v_add_f32 v247, v247, v7
    s_waitcnt vmcnt(7)
    buffer_load_dwordx4 v[132:135], v3, s[32:35], s60 offen
    s_add_u32 s60, s60, 27648
    v_lshlrev_b32 v6, 16, v100
    v_and_b32 v7, 0xffff0000, v100
    v_add_f32 v240, v240, v6
    v_add_f32 v241, v241, v7
    v_lshlrev_b32 v6, 16, v101
    v_and_b32 v7, 0xffff0000, v101
    v_add_f32 v242, v242, v6
    v_add_f32 v243, v243, v7
    v_lshlrev_b32 v6, 16, v102
    v_and_b32 v7, 0xffff0000, v102
    v_add_f32 v244, v244, v6
    v_add_f32 v245, v245, v7
    v_lshlrev_b32 v6, 16, v103
    v_and_b32 v7, 0xffff0000, v103
    v_add_f32 v246, v246, v6
    v_add_f32 v247, v247, v7
    s_waitcnt vmcnt(7)
    buffer_load_dwordx4 v[136:139], v3, s[32:35], s60 offen
    s_add_u32 s60, s60, 27648
    v_lshlrev_b32 v6, 16, v104
    v_and_b32 v7, 0xffff0000, v104
    v_add_f32 v240, v240, v6
    v_add_f32 v241, v241, v7
    v_lshlrev_b32 v6, 16, v105
    v_and_b32 v7, 0xffff0000, v105
    v_add_f32 v242, v242, v6
    v_add_f32 v243, v243, v7
    v_lshlrev_b32 v6, 16, v106
    v_and_b32 v7, 0xffff0000, v106
    v_add_f32 v244, v244, v6
    v_add_f32 v245, v245, v7
    v_lshlrev_b32 v6, 16, v107
    v_and_b32 v7, 0xffff0000, v107
    v_add_f32 v246, v246, v6
    v_add_f32 v247, v247, v7
    s_waitcnt vmcnt(7)
    buffer_load_dwordx4 v[140:143], v3, s[32:35], s60 offen
    s_add_u32 s60, s60, 27648
    v_lshlrev_b32 v6, 16, v108
    v_and_b32 v7, 0xffff0000, v108
    v_add_f32 v240, v240, v6
    v_add_f32 v241, v241, v7
    v_lshlrev_b32 v6, 16, v109
    v_and_b32 v7, 0xffff0000, v109
    v_add_f32 v242, v242, v6
    v_add_f32 v243, v243, v7
    v_lshlrev_b32 v6, 16, v110
    v_and_b32 v7, 0xffff0000, v110
    v_add_f32 v244, v244, v6
    v_add_f32 v245, v245, v7
    v_lshlrev_b32 v6, 16, v111
    v_and_b32 v7, 0xffff0000, v111
    v_add_f32 v246, v246, v6
    v_add_f32 v247, v247, v7
    s_waitcnt vmcnt(7)
    buffer_load_dwordx4 v[144:147], v3, s[32:35], s60 offen
    s_add_u32 s60, s60, 27648
    v_lshlrev_b32 v6, 16, v112
    v_and_b32 v7, 0xffff0000, v112
    v_add_f32 v240, v240, v6
    v_add_f32 v241, v241, v7
    v_lshlrev_b32 v6, 16, v113
    v_and_b32 v7, 0xffff0000, v113
    v_add_f32 v242, v242, v6
    v_add_f32 v243, v243, v7
    v_lshlrev_b32 v6, 16, v114
    v_and_b32 v7, 0xffff0000, v114
    v_add_f32 v244, v244, v6
    v_add_f32 v245, v245, v7
    v_lshlrev_b32 v6, 16, v115
    v_and_b32 v7, 0xffff0000, v115
    v_add_f32 v246, v246, v6
    v_add_f32 v247, v247, v7
    s_waitcnt vmcnt(7)
    buffer_load_dwordx4 v[148:151], v3, s[32:35], s60 offen
    s_add_u32 s60, s60, 27648
    v_lshlrev_b32 v6, 16, v116
    v_and_b32 v7, 0xffff0000, v116
    v_add_f32 v240, v240, v6
    v_add_f32 v241, v241, v7
    v_lshlrev_b32 v6, 16, v117
    v_and_b32 v7, 0xffff0000, v117
    v_add_f32 v242, v242, v6
    v_add_f32 v243, v243, v7
    v_lshlrev_b32 v6, 16, v118
    v_and_b32 v7, 0xffff0000, v118
    v_add_f32 v244, v244, v6
    v_add_f32 v245, v245, v7
    v_lshlrev_b32 v6, 16, v119
    v_and_b32 v7, 0xffff0000, v119
    v_add_f32 v246, v246, v6
    v_add_f32 v247, v247, v7
    s_waitcnt vmcnt(7)
    buffer_load_dwordx4 v[152:155], v3, s[32:35], s60 offen
    s_add_u32 s60, s60, 27648
    v_lshlrev_b32 v6, 16, v120
    v_and_b32 v7, 0xffff0000, v120
    v_add_f32 v240, v240, v6
    v_add_f32 v241, v241, v7
    v_lshlrev_b32 v6, 16, v121
    v_and_b32 v7, 0xffff0000, v121
    v_add_f32 v242, v242, v6
    v_add_f32 v243, v243, v7
    v_lshlrev_b32 v6, 16, v122
    v_and_b32 v7, 0xffff0000, v122
    v_add_f32 v244, v244, v6
    v_add_f32 v245, v245, v7
    v_lshlrev_b32 v6, 16, v123
    v_and_b32 v7, 0xffff0000, v123
    v_add_f32 v246, v246, v6
    v_add_f32 v247, v247, v7
    s_waitcnt vmcnt(7)
    buffer_load_dwordx4 v[156:159], v3, s[32:35], s60 offen
    s_add_u32 s60, s60, 27648
    v_lshlrev_b32 v6, 16, v124
    v_and_b32 v7, 0xffff0000, v124
    v_add_f32 v240, v240, v6
    v_add_f32 v241, v241, v7
    v_lshlrev_b32 v6, 16, v125
    v_and_b32 v7, 0xffff0000, v125
    v_add_f32 v242, v242, v6
    v_add_f32 v243, v243, v7
    v_lshlrev_b32 v6, 16, v126
    v_and_b32 v7, 0xffff0000, v126
    v_add_f32 v244, v244, v6
    v_add_f32 v245, v245, v7
    v_lshlrev_b32 v6, 16, v127
    v_and_b32 v7, 0xffff0000, v127
    v_add_f32 v246, v246, v6
    v_add_f32 v247, v247, v7
    s_waitcnt vmcnt(7)
    buffer_load_dwordx4 v[160:163], v3, s[32:35], s60 offen
    s_add_u32 s60, s60, 27648
    v_lshlrev_b32 v6, 16, v128
    v_and_b32 v7, 0xffff0000, v128
    v_add_f32 v240, v240, v6
    v_add_f32 v241, v241, v7
    v_lshlrev_b32 v6, 16, v129
    v_and_b32 v7, 0xffff0000, v129
    v_add_f32 v242, v242, v6
    v_add_f32 v243, v243, v7
    v_lshlrev_b32 v6, 16, v130
    v_and_b32 v7, 0xffff0000, v130
    v_add_f32 v244, v244, v6
    v_add_f32 v245, v245, v7
    v_lshlrev_b32 v6, 16, v131
    v_and_b32 v7, 0xffff0000, v131
    v_add_f32 v246, v246, v6
    v_add_f32 v247, v247, v7
    s_waitcnt vmcnt(7)
    buffer_load_dwordx4 v[164:167], v3, s[32:35], s60 offen
    s_add_u32 s60, s60, 27648
    v_lshlrev_b32 v6, 16, v132
    v_and_b32 v7, 0xffff0000, v132
    v_add_f32 v240, v240, v6
    v_add_f32 v241, v241, v7
    v_lshlrev_b32 v6, 16, v133
    v_and_b32 v7, 0xffff0000, v133
    v_add_f32 v242, v242, v6
    v_add_f32 v243, v243, v7
    v_lshlrev_b32 v6, 16, v134
    v_and_b32 v7, 0xffff0000, v134
    v_add_f32 v244, v244, v6
    v_add_f32 v245, v245, v7
    v_lshlrev_b32 v6, 16, v135
    v_and_b32 v7, 0xffff0000, v135
    v_add_f32 v246, v246, v6
    v_add_f32 v247, v247, v7
    s_waitcnt vmcnt(7)
    buffer_load_dwordx4 v[168:171], v3, s[32:35], s60 offen
    s_add_u32 s60, s60, 27648
    v_lshlrev_b32 v6, 16, v136
    v_and_b32 v7, 0xffff0000, v136
    v_add_f32 v240, v240, v6
    v_add_f32 v241, v241, v7
    v_lshlrev_b32 v6, 16, v137
    v_and_b32 v7, 0xffff0000, v137
    v_add_f32 v242, v242, v6
    v_add_f32 v243, v243, v7
    v_lshlrev_b32 v6, 16, v138
    v_and_b32 v7, 0xffff0000, v138
    v_add_f32 v244, v244, v6
    v_add_f32 v245, v245, v7
    v_lshlrev_b32 v6, 16, v139
    v_and_b32 v7, 0xffff0000, v139
    v_add_f32 v246, v246, v6
    v_add_f32 v247, v247, v7
    s_waitcnt vmcnt(7)
    buffer_load_dwordx4 v[172:175], v3, s[32:35], s60 offen
    s_add_u32 s60, s60, 27648
    v_lshlrev_b32 v6, 16, v140
    v_and_b32 v7, 0xffff0000, v140
    v_add_f32 v240, v240, v6
    v_add_f32 v241, v241, v7
    v_lshlrev_b32 v6, 16, v141
    v_and_b32 v7, 0xffff0000, v141
    v_add_f32 v242, v242, v6
    v_add_f32 v243, v243, v7
    v_lshlrev_b32 v6, 16, v142
    v_and_b32 v7, 0xffff0000, v142
    v_add_f32 v244, v244, v6
    v_add_f32 v245, v245, v7
    v_lshlrev_b32 v6, 16, v143
    v_and_b32 v7, 0xffff0000, v143
    v_add_f32 v246, v246, v6
    v_add_f32 v247, v247, v7
    s_waitcnt vmcnt(7)
    v_lshlrev_b32 v6, 16, v144
    v_and_b32 v7, 0xffff0000, v144
    v_add_f32 v240, v240, v6
    v_add_f32 v241, v241, v7
    v_lshlrev_b32 v6, 16, v145
    v_and_b32 v7, 0xffff0000, v145
    v_add_f32 v242, v242, v6
    v_add_f32 v243, v243, v7
    v_lshlrev_b32 v6, 16, v146
    v_and_b32 v7, 0xffff0000, v146
    v_add_f32 v244, v244, v6
    v_add_f32 v245, v245, v7
    v_lshlrev_b32 v6, 16, v147
    v_and_b32 v7, 0xffff0000, v147
    v_add_f32 v246, v246, v6
    v_add_f32 v247, v247, v7
    s_waitcnt vmcnt(6)
    v_lshlrev_b32 v6, 16, v148
    v_and_b32 v7, 0xffff0000, v148
    v_add_f32 v240, v240, v6
    v_add_f32 v241, v241, v7
    v_lshlrev_b32 v6, 16, v149
    v_and_b32 v7, 0xffff0000, v149
    v_add_f32 v242, v242, v6
    v_add_f32 v243, v243, v7
    v_lshlrev_b32 v6, 16, v150
    v_and_b32 v7, 0xffff0000, v150
    v_add_f32 v244, v244, v6
    v_add_f32 v245, v245, v7
    v_lshlrev_b32 v6, 16, v151
    v_and_b32 v7, 0xffff0000, v151
    v_add_f32 v246, v246, v6
    v_add_f32 v247, v247, v7
    s_waitcnt vmcnt(5)
    v_lshlrev_b32 v6, 16, v152
    v_and_b32 v7, 0xffff0000, v152
    v_add_f32 v240, v240, v6
    v_add_f32 v241, v241, v7
    v_lshlrev_b32 v6, 16, v153
    v_and_b32 v7, 0xffff0000, v153
    v_add_f32 v242, v242, v6
    v_add_f32 v243, v243, v7
    v_lshlrev_b32 v6, 16, v154
    v_and_b32 v7, 0xffff0000, v154
    v_add_f32 v244, v244, v6
    v_add_f32 v245, v245, v7
    v_lshlrev_b32 v6, 16, v155
    v_and_b32 v7, 0xffff0000, v155
    v_add_f32 v246, v246, v6
    v_add_f32 v247, v247, v7
    s_waitcnt vmcnt(4)
    v_lshlrev_b32 v6, 16, v156
    v_and_b32 v7, 0xffff0000, v156
    v_add_f32 v240, v240, v6
    v_add_f32 v241, v241, v7
    v_lshlrev_b32 v6, 16, v157
    v_and_b32 v7, 0xffff0000, v157
    v_add_f32 v242, v242, v6
    v_add_f32 v243, v243, v7
    v_lshlrev_b32 v6, 16, v158
    v_and_b32 v7, 0xffff0000, v158
    v_add_f32 v244, v244, v6
    v_add_f32 v245, v245, v7
    v_lshlrev_b32 v6, 16, v159
    v_and_b32 v7, 0xffff0000, v159
    v_add_f32 v246, v246, v6
    v_add_f32 v247, v247, v7
    s_waitcnt vmcnt(3)
    v_lshlrev_b32 v6, 16, v160
    v_and_b32 v7, 0xffff0000, v160
    v_add_f32 v240, v240, v6
    v_add_f32 v241, v241, v7
    v_lshlrev_b32 v6, 16, v161
    v_and_b32 v7, 0xffff0000, v161
    v_add_f32 v242, v242, v6
    v_add_f32 v243, v243, v7
    v_lshlrev_b32 v6, 16, v162
    v_and_b32 v7, 0xffff0000, v162
    v_add_f32 v244, v244, v6
    v_add_f32 v245, v245, v7
    v_lshlrev_b32 v6, 16, v163
    v_and_b32 v7, 0xffff0000, v163
    v_add_f32 v246, v246, v6
    v_add_f32 v247, v247, v7
    s_waitcnt vmcnt(2)
    v_lshlrev_b32 v6, 16, v164
    v_and_b32 v7, 0xffff0000, v164
    v_add_f32 v240, v240, v6
    v_add_f32 v241, v241, v7
    v_lshlrev_b32 v6, 16, v165
    v_and_b32 v7, 0xffff0000, v165
    v_add_f32 v242, v242, v6
    v_add_f32 v243, v243, v7
    v_lshlrev_b32 v6, 16, v166
    v_and_b32 v7, 0xffff0000, v166
    v_add_f32 v244, v244, v6
    v_add_f32 v245, v245, v7
    v_lshlrev_b32 v6, 16, v167
    v_and_b32 v7, 0xffff0000, v167
    v_add_f32 v246, v246, v6
    v_add_f32 v247, v247, v7
    s_waitcnt vmcnt(1)
    v_lshlrev_b32 v6, 16, v168
    v_and_b32 v7, 0xffff0000, v168
    v_add_f32 v240, v240, v6
    v_add_f32 v241, v241, v7
    v_lshlrev_b32 v6, 16, v169
    v_and_b32 v7, 0xffff0000, v169
    v_add_f32 v242, v242, v6
    v_add_f32 v243, v243, v7
    v_lshlrev_b32 v6, 16, v170
    v_and_b32 v7, 0xffff0000, v170
    v_add_f32 v244, v244, v6
    v_add_f32 v245, v245, v7
    v_lshlrev_b32 v6, 16, v171
    v_and_b32 v7, 0xffff0000, v171
    v_add_f32 v246, v246, v6
    v_add_f32 v247, v247, v7
    s_waitcnt vmcnt(0)
    v_lshlrev_b32 v6, 16, v172
    v_and_b32 v7, 0xffff0000, v172
    v_add_f32 v240, v240, v6
    v_add_f32 v241, v241, v7
    v_lshlrev_b32 v6, 16, v173
    v_and_b32 v7, 0xffff0000, v173
    v_add_f32 v242, v242, v6
    v_add_f32 v243, v243, v7
    v_lshlrev_b32 v6, 16, v174
    v_and_b32 v7, 0xffff0000, v174
    v_add_f32 v244, v244, v6
    v_add_f32 v245, v245, v7
    v_lshlrev_b32 v6, 16, v175
    v_and_b32 v7, 0xffff0000, v175
    v_add_f32 v246, v246, v6
    v_add_f32 v247, v247, v7
    v_lshlrev_b32 v4, 5, v0
    ds_write_b128 v4, v[240:243]
    ds_write_b128 v4, v[244:247] offset:16
    v_lshlrev_b32 v4, 2, v1
    s_lshl_b32 s60, s46, 11
    v_add_u32 v5, s60, v4
    s_waitcnt lgkmcnt(0)
    ds_read_b32 v16, v5 offset:0
    ds_read_b32 v17, v5 offset:256
    ds_read_b32 v18, v5 offset:512
    ds_read_b32 v19, v5 offset:768
    ds_read_b32 v20, v5 offset:1024
    ds_read_b32 v21, v5 offset:1280
    ds_read_b32 v22, v5 offset:1536
    ds_read_b32 v23, v5 offset:1792
    s_waitcnt lgkmcnt(0)
    v_add_f32 v16, v16, v20
    v_add_f32 v17, v17, v21
    v_add_f32 v18, v18, v22
    v_add_f32 v19, v19, v23
    v_add_f32 v16, v16, v18
    v_add_f32 v17, v17, v19
    v_add_f32 v16, v16, v17
    v_lshlrev_b32 v5, 2, v0
    ds_write_b32 v5, v16 offset:8192
    s_waitcnt lgkmcnt(0)
    s_barrier
    s_bitcmp1_b32 s46, 0
    s_cbranch_scc1 L_cs_c_done
    ds_read_b32 v16, v5 offset:8192
    ds_read_b32 v17, v5 offset:8448
    s_waitcnt lgkmcnt(0)
    v_add_f32 v16, v16, v17
    v_cvt_pk_bf16_f32 v17, v16, v16
    v_and_b32 v17, 0xffff0000, v17
    v_sub_f32 v17, v16, v17
    v_cvt_pk_bf16_f32 v18, v17, v17
    v_and_b32 v18, 0xffff0000, v18
    v_sub_f32 v18, v17, v18
    v_cvt_pk_bf16_f32 v16, v16, v17
    v_cvt_pk_bf16_f32 v17, v18, 0
    v_mov_b32 v18, s44
    v_mov_b32 v19, s45
    s_lshl_b32 s60, s46, 9
    s_add_u32 s60, s60, s51
    v_lshlrev_b32 v4, 4, v1
    buffer_store_dwordx4 v[16:19], v4, s[24:27], s60 offen sc1
L_cs_c_done:
    s_barrier
    s_branch L_ps_1_1
L_pw_a1_1:
    s_branch L_pw_a1_2
L_pw_b1_1:
    s_branch L_pw_b1_2
L_pw_c1_1:
    s_branch L_pw_c1_2
L_ps_1_1:
L_cs2c_end:
L_att:
    s_and_b32 s60, s47, 7
    s_lshl_b32 s48, s60, 2
    s_bfe_u32 s60, s47, 0x20003
    s_add_u32 s48, s48, s60
    s_lshr_b32 s54, s47, 5
    v_and_b32 v1, 63, v0
    v_lshlrev_b32 v3, 4, v1
    v_lshlrev_b32 v2, 3, v1
    s_lshl_b32 s49, s54, 3
    s_and_b32 s60, s46, 1
    s_lshl_b32 s60, s60, 2
    s_add_u32 s49, s49, s60
    s_mov_b32 s56, -1
    s_mov_b32 s57, 0
    v_lshrrev_b32 v6, 5, v1
    v_and_b32 v7, 31, v1
    s_and_b32 s60, s48, 3
    s_mul_i32 s60, s60, 20
    v_add_u32 v8, s60, v7
    v_cmp_eq_u32 vcc, 20, v7
    v_mov_b32 v4, 80
    s_nop 0
    v_cndmask_b32 v8, v8, v4, vcc
    v_mul_u32_u24 v6, 1408, v6
    v_lshl_add_u32 v8, v8, 4, v6
    v_cmp_lt_u32 vcc, 20, v7
    v_mov_b32 v4, 0x7ffffff0
    s_nop 0
    v_cndmask_b32 v4, v8, v4, vcc
    v_add_u32 v5, 5632, v4
    s_mov_b32 s50, 0
    s_mov_b32 s64, 0
    v_mov_b32 v8, 0
    v_mov_b32 v7, 66560
    ds_write_b32 v7, v8
    v_mov_b32 v198, 0x3f803f80
    v_mov_b32 v199, 0x3f80
    v_mov_b32 v202, 0x3f803f80
    v_mov_b32 v203, 0x3f80
    s_mul_i32 s53, s48, 81920
    s_add_u32 s53, s53, 0x400000
    s_mul_i32 s60, s48, 20
    s_add_u32 s61, s60, 19
    s_lshr_b32 s60, s60, 7
    s_lshr_b32 s61, s61, 7
    s_sub_u32 s61, s61, s60
    v_bfe_u32 v6, v1, 3, 1
    v_bfe_u32 v7, v1, 4, 1
    v_mul_u32_u24 v7, 5, v7
    v_add_u32 v7, 5, v7
    v_and_b32 v8, 7, v1
    v_and_b32 v12, 1, v1
    v_mov_b32 v13, s54
    v_cndmask_b32 v6, v12, v6, s[56:57]
    v_cndmask_b32 v7, 0, v7, s[56:57]
    v_cndmask_b32 v8, v13, v8, s[56:57]
    v_mul_lo_u32 v6, v6, s61
    v_add3_u32 v6, v6, v7, s60
    v_lshlrev_b32 v6, 8, v6
    v_lshl_add_u32 v6, v8, 4, v6
    v_add_u32 v6, 0x1d01000, v6
    v_mov_b32 v9, v6
    v_bfe_u32 v6, v1, 1, 1
    v_mul_lo_u32 v6, v6, s61
    v_bfe_u32 v7, v1, 2, 1
    v_mul_u32_u24 v7, 5, v7
    v_add_u32 v7, 5, v7
    v_and_b32 v8, 1, v1
    v_lshlrev_b32 v12, 3, v8
    s_lshl_b32 s62, s54, 1
    v_add_u32 v8, s62, v8
    v_and_b32 v13, 8, v1
    v_cmp_eq_u32 vcc, 0, v13
    s_nop 1
    v_cndmask_b32 v7, 0, v7, vcc
    v_cndmask_b32 v8, v8, v12, vcc
    s_branch L_ps_1_2
L_pw_a1_2:
    s_branch L_pw_a1_3
L_pw_b1_2:
    s_branch L_pw_b1_3
L_pw_c1_2:
    s_branch L_pw_c1_3
L_ps_1_2:
    v_add3_u32 v6, v6, v7, s60
    v_lshlrev_b32 v6, 8, v6
    v_lshl_add_u32 v6, v8, 3, v6
    v_add_u32 v6, 0x1d01000, v6
    v_mov_b32 v68, 0
    v_mov_b32 v69, 0
    v_mov_b32 v70, 0
    v_mov_b32 v71, 0
    v_mov_b32 v72, 0
    v_mov_b32 v73, 0
    v_mov_b32 v74, 0
    v_mov_b32 v75, 0
    v_mov_b32 v76, 0
    v_mov_b32 v77, 0
    v_mov_b32 v78, 0
    v_mov_b32 v79, 0
    v_mov_b32 v80, 0
    v_mov_b32 v81, 0
    v_mov_b32 v82, 0
    v_mov_b32 v83, 0
    v_mov_b32 v38, 0
    v_mov_b32 v39, 0
    v_mov_b32 v42, 0
    v_mov_b32 v43, 0
    v_mov_b32 v84, 0
    v_mov_b32 v85, 0
    v_mov_b32 v86, 0
    v_mov_b32 v87, 0
    v_mov_b32 v88, 0
    v_mov_b32 v89, 0
    v_mov_b32 v90, 0
    v_mov_b32 v91, 0
    v_mov_b32 v92, 0
    v_mov_b32 v93, 0
    v_mov_b32 v94, 0
    v_mov_b32 v95, 0
    v_mov_b32 v96, 0
    v_mov_b32 v97, 0
    v_mov_b32 v98, 0
    v_mov_b32 v99, 0
    v_mov_b32 v46, 0
    v_mov_b32 v47, 0
    v_mov_b32 v50, 0
    v_mov_b32 v51, 0
    v_mov_b32 v100, 0
    v_mov_b32 v101, 0
    v_mov_b32 v102, 0
    v_mov_b32 v103, 0
    v_mov_b32 v104, 0
    v_mov_b32 v105, 0
    v_mov_b32 v106, 0
    v_mov_b32 v107, 0
    v_mov_b32 v108, 0
    v_mov_b32 v109, 0
    v_mov_b32 v110, 0
    v_mov_b32 v111, 0
    v_mov_b32 v112, 0
    v_mov_b32 v113, 0
    v_mov_b32 v114, 0
    v_mov_b32 v115, 0
    v_mov_b32 v54, 0
    v_mov_b32 v55, 0
    v_mov_b32 v58, 0
    v_mov_b32 v59, 0
    v_mov_b32 v116, 0
    v_mov_b32 v117, 0
    v_mov_b32 v118, 0
    v_mov_b32 v119, 0
    v_mov_b32 v120, 0
    v_mov_b32 v121, 0
    v_mov_b32 v122, 0
    v_mov_b32 v123, 0
    v_mov_b32 v124, 0
    v_mov_b32 v125, 0
    v_mov_b32 v126, 0
    v_mov_b32 v127, 0
    v_mov_b32 v128, 0
    v_mov_b32 v129, 0
    v_mov_b32 v130, 0
    v_mov_b32 v131, 0
    v_mov_b32 v62, 0
    v_mov_b32 v63, 0
    v_mov_b32 v66, 0
    v_mov_b32 v67, 0
    v_mov_b32 v176, 0
    v_mov_b32 v177, 0
    v_mov_b32 v178, 0
    v_mov_b32 v179, 0
    s_mov_b32 s32, s22
    s_and_b32 s33, s23, 0xffff
    s_mov_b32 s34, 0x4000000
    s_mov_b32 s35, 0x00020000
    s_lshl_b32 s60, s48, 16
    s_lshl_b32 s61, s49, 10
    s_add_u32 s58, s60, s61
    s_lshl_b32 s60, s48, 14
    s_lshl_b32 s61, s49, 8
    s_add_u32 s60, s60, s61
    s_add_u32 s59, s60, 0x200000
    s_lshr_b32 s60, s46, 1
    s_mul_i32 s60, s60, 40960
    s_add_u32 s52, s53, s60
    s_lshr_b32 s60, s46, 1
    s_mul_i32 s60, s60, 180224
    s_lshr_b32 s61, s48, 2
    s_mul_i32 s61, s61, 360448
    s_add_u32 s60, s60, s61
    s_add_u32 s55, s60, 0x800000
    s_mov_b32 s69, s53
    v_and_b32 v7, 0xff, v2
    s_mov_b32 s51, 0
    s_cmp_lg_u32 s46, 0
    s_cbranch_scc1 L_wait_10
    s_mov_b32 s3, 0
    s_sleep 32
    s_branch L_wait_9_a
L_wait_9:
    s_sleep 16
L_wait_9_a:
    buffer_load_dwordx2 v[12:13], v6, s[24:27], 0 offen sc1
    s_add_u32 s3, s3, 1
    s_cmp_gt_u32 s3, 40000
    s_cbranch_scc1 L_end
    s_waitcnt vmcnt(0)
    v_cmp_ne_u64 vcc, s[44:45], v[12:13]
    s_nop 1
    s_cmp_lg_u64 vcc, 0
    s_cbranch_scc1 L_wait_9
L_wait_10:
    s_barrier
    buffer_load_dwordx4 v[188:191], v3, s[24:27], s69 offen sc1
    buffer_load_dwordx4 v[20:23], v3, s[24:27], s58 offen offset:0 sc1
    buffer_load_dwordx4 v[24:27], v3, s[24:27], s58 offen offset:1024 sc1
    buffer_load_dwordx4 v[28:31], v3, s[24:27], s58 offen offset:2048 sc1
    buffer_load_dwordx4 v[32:35], v3, s[24:27], s58 offen offset:3072 sc1
    buffer_load_dwordx2 v[200:201], v2, s[24:27], s69 offen offset:2048 sc1
    buffer_load_dwordx2 v[36:37], v7, s[24:27], s59 offen offset:0 sc1
    buffer_load_dwordx2 v[44:45], v7, s[24:27], s59 offen offset:256 sc1
    buffer_load_dwordx2 v[52:53], v7, s[24:27], s59 offen offset:512 sc1
    buffer_load_dwordx2 v[60:61], v7, s[24:27], s59 offen offset:768 sc1
    buffer_load_dwordx4 v[180:183], v3, s[24:27], s52 offen sc1
    buffer_load_dwordx4 v[184:187], v3, s[24:27], s52 offen offset:1024 sc1
    buffer_load_dwordx2 v[196:197], v2, s[24:27], s52 offen offset:2048 sc1
    buffer_load_dwordx4 v[204:207], v4, s[24:27], s55 offen offset:0 sc1
    buffer_load_dwordx4 v[208:211], v4, s[24:27], s55 offen offset:2816 sc1
    buffer_load_dwordx4 v[212:215], v5, s[24:27], s55 offen offset:0 sc1
    buffer_load_dwordx4 v[216:219], v5, s[24:27], s55 offen offset:2816 sc1
    s_add_u32 s52, s52, 2560
    s_add_u32 s55, s55, 11264
    s_mov_b64 s[60:61], s[56:57]
    s_cmp_lg_u32 s46, 0
    s_cbranch_scc1 L_ph_11
    s_cmp_lt_u32 s47, 216
    s_cbranch_scc1 L_ph_11
    s_add_u32 s56, s95, 500
    s_lshl_b32 s57, s47, 7
    s_add_u32 s57, s57, 0x1d04040
    v_mov_b32 v6, s56
    v_mov_b32 v7, 0
    s_mov_b64 exec, 1
    buffer_store_dword v6, v7, s[24:27], s57 offen
    s_mov_b64 exec, -1
L_ph_11:
    s_mov_b64 s[56:57], s[60:61]
    s_mov_b32 s60, 0xc2b40000
    s_waitcnt vmcnt(12)
    v_mfma_f32_32x32x16_bf16 v[132:147], v[188:191], v[20:23], 0
    v_mfma_f32_32x32x16_bf16 v[148:163], v[188:191], v[24:27], 0
    s_waitcnt vmcnt(7)
    v_cndmask_b32 v40, v36, 0, s[56:57]
    v_cndmask_b32 v36, 0, v36, s[56:57]
    v_cndmask_b32 v41, v37, 0, s[56:57]
    v_cndmask_b32 v37, 0, v37, s[56:57]
    v_mfma_f32_32x32x16_bf16 v[236:251], v[188:191], v[28:31], 0
    v_cndmask_b32 v48, v44, 0, s[56:57]
    v_cndmask_b32 v44, 0, v44, s[56:57]
    v_cndmask_b32 v49, v45, 0, s[56:57]
    v_cndmask_b32 v45, 0, v45, s[56:57]
    v_mfma_f32_32x32x16_bf16 v[132:147], v[200:203], v[36:39], v[132:147]
    v_cndmask_b32 v56, v52, 0, s[56:57]
    v_cndmask_b32 v52, 0, v52, s[56:57]
    v_cndmask_b32 v57, v53, 0, s[56:57]
    v_cndmask_b32 v53, 0, v53, s[56:57]
    v_mfma_f32_32x32x16_bf16 v[148:163], v[200:203], v[44:47], v[148:163]
    v_cndmask_b32 v64, v60, 0, s[56:57]
    v_cndmask_b32 v60, 0, v60, s[56:57]
    v_cndmask_b32 v65, v61, 0, s[56:57]
    v_cndmask_b32 v61, 0, v61, s[56:57]
    v_mfma_f32_32x32x16_bf16 v[220:235], v[188:191], v[32:35], 0
    v_mfma_f32_32x32x16_bf16 v[236:251], v[200:203], v[52:55], v[236:251]
    v_mfma_f32_32x32x16_bf16 v[220:235], v[200:203], v[60:63], v[220:235]
    buffer_load_dwordx4 v[188:191], v3, s[24:27], s52 offen sc1
    buffer_load_dwordx4 v[192:195], v3, s[24:27], s52 offen offset:1024 sc1
    buffer_load_dwordx2 v[200:201], v2, s[24:27], s52 offen offset:2048 sc1
    s_add_u32 s52, s52, 2560
    v_max3_f32 v16, v132, v133, v134
    v_max3_f32 v16, v135, v136, v16
    v_max3_f32 v16, v137, v138, v16
    v_max3_f32 v16, v139, v140, v16
    v_max3_f32 v16, v141, v142, v16
    v_max3_f32 v16, v143, v144, v16
    v_max3_f32 v16, v145, v146, v16
    v_max_f32 v16, v147, v16
    v_max3_f32 v17, v148, v149, v150
    v_mov_b32 v12, v16
    v_max3_f32 v17, v151, v152, v17
    s_nop 0
    v_permlane32_swap_b32 v12, v16
    v_max3_f32 v17, v153, v154, v17
    v_max_f32 v12, v12, v16
    v_max3_f32 v17, v155, v156, v17
    v_sub_f32 v12, s60, v12
    v_max3_f32 v17, v157, v158, v17
    v_cvt_pk_bf16_f32 v12, v12, 0
    v_max3_f32 v17, v159, v160, v17
    v_cndmask_b32 v38, 0, v12, s[56:57]
    v_max3_f32 v17, v161, v162, v17
    v_cndmask_b32 v42, v12, 0, s[56:57]
    v_max_f32 v17, v163, v17
    s_waitcnt vmcnt(7)
    v_mfma_f32_32x32x16_bf16 v[132:147], v[180:183], v[20:23], 0
    v_max3_f32 v18, v236, v237, v238
    v_mov_b32 v13, v17
    v_max3_f32 v18, v239, v240, v18
    s_nop 0
    v_permlane32_swap_b32 v13, v17
    v_max3_f32 v18, v241, v242, v18
    v_max_f32 v13, v13, v17
    v_max3_f32 v18, v243, v244, v18
    v_sub_f32 v13, s60, v13
    v_max3_f32 v18, v245, v246, v18
    v_cvt_pk_bf16_f32 v13, v13, 0
    v_max3_f32 v18, v247, v248, v18
    v_cndmask_b32 v46, 0, v13, s[56:57]
    v_max3_f32 v18, v249, v250, v18
    v_cndmask_b32 v50, v13, 0, s[56:57]
    v_max_f32 v18, v251, v18
    v_mfma_f32_32x32x16_bf16 v[132:147], v[196:199], v[36:39], v[132:147]
    v_max3_f32 v19, v220, v221, v222
    v_mov_b32 v14, v18
    v_max3_f32 v19, v223, v224, v19
    s_nop 0
    v_permlane32_swap_b32 v14, v18
    v_max3_f32 v19, v225, v226, v19
    v_max_f32 v14, v14, v18
    v_max3_f32 v19, v227, v228, v19
    v_sub_f32 v14, s60, v14
    v_max3_f32 v19, v229, v230, v19
    v_cvt_pk_bf16_f32 v14, v14, 0
    v_max3_f32 v19, v231, v232, v19
    v_cndmask_b32 v54, 0, v14, s[56:57]
    v_max3_f32 v19, v233, v234, v19
    v_cndmask_b32 v58, v14, 0, s[56:57]
    v_max_f32 v19, v235, v19
    v_mov_b32 v15, v19
    v_mov_b32 v232, 0
    s_nop 0
    v_permlane32_swap_b32 v15, v19
    v_mov_b32 v233, 0
    v_max_f32 v15, v15, v19
    v_mov_b32 v234, 0
    v_sub_f32 v15, s60, v15
    v_mov_b32 v235, 0
    v_cvt_pk_bf16_f32 v15, v15, 0
    v_cndmask_b32 v62, 0, v15, s[56:57]
    v_cndmask_b32 v66, v15, 0, s[56:57]
.p2align 3
L_att_loop:
    v_mfma_f32_32x32x16_bf16 v[148:163], v[180:183], v[24:27], 0
    v_exp_f32 v132, v132
    v_exp_f32 v133, v133
    v_exp_f32 v134, v134
    v_exp_f32 v135, v135
    v_exp_f32 v136, v136
    v_mfma_f32_32x32x16_bf16 v[148:163], v[196:199], v[44:47], v[148:163]
    v_exp_f32 v137, v137
    v_exp_f32 v138, v138
    v_exp_f32 v139, v139
    v_cvt_pk_bf16_f32 v164, v132, v133
    v_cvt_pk_bf16_f32 v165, v134, v135
    v_cvt_pk_bf16_f32 v166, v136, v137
    v_cvt_pk_bf16_f32 v167, v138, v139
    v_mfma_f32_32x32x16_bf16 v[116:131], v[232:235], v[176:179], v[116:131]
    v_exp_f32 v140, v140
    v_exp_f32 v141, v141
    v_exp_f32 v142, v142
    v_exp_f32 v143, v143
    v_exp_f32 v144, v144
    s_waitcnt vmcnt(3)
    v_mfma_f32_32x32x16_bf16 v[68:83], v[204:207], v[164:167], v[68:83]
    v_exp_f32 v145, v145
    v_exp_f32 v146, v146
    v_exp_f32 v147, v147
    v_cvt_pk_bf16_f32 v168, v140, v141
    v_cvt_pk_bf16_f32 v169, v142, v143
    v_cvt_pk_bf16_f32 v170, v144, v145
    v_cvt_pk_bf16_f32 v171, v146, v147
    v_mfma_f32_32x32x16_bf16 v[132:147], v[180:183], v[28:31], 0
    v_exp_f32 v148, v148
    buffer_load_dwordx4 v[220:223], v4, s[32:35], s55 offen offset:0 sc1
    v_exp_f32 v149, v149
    buffer_load_dwordx4 v[224:227], v4, s[32:35], s55 offen offset:2816 sc1
    v_exp_f32 v150, v150
    buffer_load_dwordx4 v[228:231], v5, s[32:35], s55 offen offset:0 sc1
    v_exp_f32 v151, v151
    buffer_load_dwordx4 v[232:235], v5, s[32:35], s55 offen offset:2816 sc1
    v_exp_f32 v152, v152
    s_add_u32 s55, s55, 11264
    v_mfma_f32_32x32x16_bf16 v[132:147], v[196:199], v[52:55], v[132:147]
    v_exp_f32 v153, v153
    v_exp_f32 v154, v154
    v_exp_f32 v155, v155
    v_cvt_pk_bf16_f32 v172, v148, v149
    v_cvt_pk_bf16_f32 v173, v150, v151
    v_cvt_pk_bf16_f32 v174, v152, v153
    v_cvt_pk_bf16_f32 v175, v154, v155
    v_mfma_f32_32x32x16_bf16 v[68:83], v[208:211], v[168:171], v[68:83]
    v_exp_f32 v156, v156
    v_exp_f32 v157, v157
    v_exp_f32 v158, v158
    v_exp_f32 v159, v159
    v_exp_f32 v160, v160
    v_mfma_f32_32x32x16_bf16 v[84:99], v[204:207], v[172:175], v[84:99]
    v_exp_f32 v161, v161
    v_exp_f32 v162, v162
    v_exp_f32 v163, v163
    v_cvt_pk_bf16_f32 v176, v156, v157
    v_cvt_pk_bf16_f32 v177, v158, v159
    v_cvt_pk_bf16_f32 v178, v160, v161
    v_cvt_pk_bf16_f32 v179, v162, v163
    v_mfma_f32_32x32x16_bf16 v[148:163], v[180:183], v[32:35], 0
    v_exp_f32 v132, v132
    v_exp_f32 v133, v133
    v_exp_f32 v134, v134
    v_exp_f32 v135, v135
    v_exp_f32 v136, v136
    v_mfma_f32_32x32x16_bf16 v[148:163], v[196:199], v[60:63], v[148:163]
    v_exp_f32 v137, v137
    v_exp_f32 v138, v138
    v_exp_f32 v139, v139
    v_cvt_pk_bf16_f32 v164, v132, v133
    v_cvt_pk_bf16_f32 v165, v134, v135
    v_cvt_pk_bf16_f32 v166, v136, v137
    v_cvt_pk_bf16_f32 v167, v138, v139
    v_mfma_f32_32x32x16_bf16 v[84:99], v[208:211], v[176:179], v[84:99]
    v_exp_f32 v140, v140
    v_exp_f32 v141, v141
    v_exp_f32 v142, v142
    v_exp_f32 v143, v143
    v_exp_f32 v144, v144
    v_mfma_f32_32x32x16_bf16 v[100:115], v[204:207], v[164:167], v[100:115]
    v_exp_f32 v145, v145
    v_exp_f32 v146, v146
    v_exp_f32 v147, v147
    v_cvt_pk_bf16_f32 v168, v140, v141
    v_cvt_pk_bf16_f32 v169, v142, v143
    v_cvt_pk_bf16_f32 v170, v144, v145
    v_cvt_pk_bf16_f32 v171, v146, v147
    s_cmp_eq_u32 s51, 0
    s_cbranch_scc1 L_att_c3
L_att_r3:
    v_mfma_f32_32x32x16_bf16 v[132:147], v[184:187], v[20:23], 0
    v_exp_f32 v148, v148
    v_exp_f32 v149, v149
    v_exp_f32 v150, v150
    v_exp_f32 v151, v151
    v_exp_f32 v152, v152
    v_mfma_f32_32x32x16_bf16 v[132:147], v[196:199], v[40:43], v[132:147]
    v_exp_f32 v153, v153
    v_exp_f32 v154, v154
    v_exp_f32 v155, v155
    v_cvt_pk_bf16_f32 v172, v148, v149
    v_cvt_pk_bf16_f32 v173, v150, v151
    v_cvt_pk_bf16_f32 v174, v152, v153
    v_cvt_pk_bf16_f32 v175, v154, v155
    v_mfma_f32_32x32x16_bf16 v[100:115], v[208:211], v[168:171], v[100:115]
    v_exp_f32 v156, v156
    v_exp_f32 v157, v157
    v_exp_f32 v158, v158
    v_exp_f32 v159, v159
    v_exp_f32 v160, v160
    v_mfma_f32_32x32x16_bf16 v[116:131], v[204:207], v[172:175], v[116:131]
    v_exp_f32 v161, v161
    v_exp_f32 v162, v162
    v_exp_f32 v163, v163
    v_cvt_pk_bf16_f32 v176, v156, v157
    v_cvt_pk_bf16_f32 v177, v158, v159
    v_cvt_pk_bf16_f32 v178, v160, v161
    v_cvt_pk_bf16_f32 v179, v162, v163
    v_mfma_f32_32x32x16_bf16 v[148:163], v[184:187], v[24:27], 0
    v_exp_f32 v132, v132
    v_exp_f32 v133, v133
    v_exp_f32 v134, v134
    v_exp_f32 v135, v135
    v_exp_f32 v136, v136
    v_mfma_f32_32x32x16_bf16 v[148:163], v[196:199], v[48:51], v[148:163]
    v_exp_f32 v137, v137
    v_exp_f32 v138, v138
    v_exp_f32 v139, v139
    v_cvt_pk_bf16_f32 v164, v132, v133
    v_cvt_pk_bf16_f32 v165, v134, v135
    v_cvt_pk_bf16_f32 v166, v136, v137
    v_cvt_pk_bf16_f32 v167, v138, v139
    v_mfma_f32_32x32x16_bf16 v[116:131], v[208:211], v[176:179], v[116:131]
    v_exp_f32 v140, v140
    v_exp_f32 v141, v141
    v_exp_f32 v142, v142
    v_exp_f32 v143, v143
    v_exp_f32 v144, v144
    v_mfma_f32_32x32x16_bf16 v[68:83], v[212:215], v[164:167], v[68:83]
    v_exp_f32 v145, v145
    v_exp_f32 v146, v146
    v_exp_f32 v147, v147
    v_cvt_pk_bf16_f32 v168, v140, v141
    v_cvt_pk_bf16_f32 v169, v142, v143
    v_cvt_pk_bf16_f32 v170, v144, v145
    v_cvt_pk_bf16_f32 v171, v146, v147
    v_mfma_f32_32x32x16_bf16 v[132:147], v[184:187], v[28:31], 0
    v_exp_f32 v148, v148
    v_exp_f32 v149, v149
    v_exp_f32 v150, v150
    v_exp_f32 v151, v151
    v_exp_f32 v152, v152
    v_mfma_f32_32x32x16_bf16 v[132:147], v[196:199], v[56:59], v[132:147]
    v_exp_f32 v153, v153
    v_exp_f32 v154, v154
    v_exp_f32 v155, v155
    v_cvt_pk_bf16_f32 v172, v148, v149
    v_cvt_pk_bf16_f32 v173, v150, v151
    v_cvt_pk_bf16_f32 v174, v152, v153
    v_cvt_pk_bf16_f32 v175, v154, v155
    v_mfma_f32_32x32x16_bf16 v[68:83], v[216:219], v[168:171], v[68:83]
    v_exp_f32 v156, v156
    v_exp_f32 v157, v157
    v_exp_f32 v158, v158
    v_exp_f32 v159, v159
    v_exp_f32 v160, v160
    v_mfma_f32_32x32x16_bf16 v[84:99], v[212:215], v[172:175], v[84:99]
    v_exp_f32 v161, v161
    v_exp_f32 v162, v162
    v_exp_f32 v163, v163
    v_cvt_pk_bf16_f32 v176, v156, v157
    v_cvt_pk_bf16_f32 v177, v158, v159
    v_cvt_pk_bf16_f32 v178, v160, v161
    v_cvt_pk_bf16_f32 v179, v162, v163
    v_mfma_f32_32x32x16_bf16 v[148:163], v[184:187], v[32:35], 0
    v_exp_f32 v132, v132
    v_exp_f32 v133, v133
    v_exp_f32 v134, v134
    v_exp_f32 v135, v135
    v_exp_f32 v136, v136
    v_mfma_f32_32x32x16_bf16 v[148:163], v[196:199], v[64:67], v[148:163]
    v_exp_f32 v137, v137
    v_exp_f32 v138, v138
    v_exp_f32 v139, v139
    v_cvt_pk_bf16_f32 v164, v132, v133
    v_cvt_pk_bf16_f32 v165, v134, v135
    v_cvt_pk_bf16_f32 v166, v136, v137
    v_cvt_pk_bf16_f32 v167, v138, v139
    v_mfma_f32_32x32x16_bf16 v[84:99], v[216:219], v[176:179], v[84:99]
    v_exp_f32 v140, v140
    v_exp_f32 v141, v141
    v_exp_f32 v142, v142
    v_exp_f32 v143, v143
    v_exp_f32 v144, v144
    v_mfma_f32_32x32x16_bf16 v[100:115], v[212:215], v[164:167], v[100:115]
    v_exp_f32 v145, v145
    v_exp_f32 v146, v146
    v_exp_f32 v147, v147
    v_cvt_pk_bf16_f32 v168, v140, v141
    v_cvt_pk_bf16_f32 v169, v142, v143
    v_cvt_pk_bf16_f32 v170, v144, v145
    v_cvt_pk_bf16_f32 v171, v146, v147
    s_cmp_eq_u32 s51, 0
    s_cbranch_scc1 L_att_c7
L_att_r7:
    s_waitcnt vmcnt(4)
    s_cmp_lt_u32 s51, 7
    s_cselect_b32 s34, 0x4000000, 0
    v_mfma_f32_32x32x16_bf16 v[132:147], v[188:191], v[20:23], 0
    v_exp_f32 v148, v148
    buffer_load_dwordx4 v[180:183], v3, s[32:35], s52 offen sc1
    v_exp_f32 v149, v149
    buffer_load_dwordx4 v[184:187], v3, s[32:35], s52 offen offset:1024 sc1
    v_exp_f32 v150, v150
    buffer_load_dwordx2 v[196:197], v2, s[32:35], s52 offen offset:2048 sc1
    v_exp_f32 v151, v151
    s_add_u32 s52, s52, 2560
    v_exp_f32 v152, v152
    v_mfma_f32_32x32x16_bf16 v[132:147], v[200:203], v[36:39], v[132:147]
    v_exp_f32 v153, v153
    v_exp_f32 v154, v154
    v_exp_f32 v155, v155
    v_cvt_pk_bf16_f32 v172, v148, v149
    v_cvt_pk_bf16_f32 v173, v150, v151
    v_cvt_pk_bf16_f32 v174, v152, v153
    v_cvt_pk_bf16_f32 v175, v154, v155
    v_mfma_f32_32x32x16_bf16 v[100:115], v[216:219], v[168:171], v[100:115]
    v_exp_f32 v156, v156
    v_exp_f32 v157, v157
    v_exp_f32 v158, v158
    v_exp_f32 v159, v159
    v_exp_f32 v160, v160
    v_mfma_f32_32x32x16_bf16 v[116:131], v[212:215], v[172:175], v[116:131]
    v_exp_f32 v161, v161
    v_exp_f32 v162, v162
    v_exp_f32 v163, v163
    v_cvt_pk_bf16_f32 v176, v156, v157
    v_cvt_pk_bf16_f32 v177, v158, v159
    v_cvt_pk_bf16_f32 v178, v160, v161
    v_cvt_pk_bf16_f32 v179, v162, v163
    v_mfma_f32_32x32x16_bf16 v[148:163], v[188:191], v[24:27], 0
    v_exp_f32 v132, v132
    v_exp_f32 v133, v133
    v_exp_f32 v134, v134
    v_exp_f32 v135, v135
    v_exp_f32 v136, v136
    v_mfma_f32_32x32x16_bf16 v[148:163], v[200:203], v[44:47], v[148:163]
    v_exp_f32 v137, v137
    v_exp_f32 v138, v138
    v_exp_f32 v139, v139
    v_cvt_pk_bf16_f32 v164, v132, v133
    v_cvt_pk_bf16_f32 v165, v134, v135
    v_cvt_pk_bf16_f32 v166, v136, v137
    v_cvt_pk_bf16_f32 v167, v138, v139
    v_mfma_f32_32x32x16_bf16 v[116:131], v[216:219], v[176:179], v[116:131]
    v_exp_f32 v140, v140
    v_exp_f32 v141, v141
    v_exp_f32 v142, v142
    v_exp_f32 v143, v143
    v_exp_f32 v144, v144
    s_waitcnt vmcnt(3)
    v_mfma_f32_32x32x16_bf16 v[68:83], v[220:223], v[164:167], v[68:83]
    v_exp_f32 v145, v145
    v_exp_f32 v146, v146
    v_exp_f32 v147, v147
    v_cvt_pk_bf16_f32 v168, v140, v141
    v_cvt_pk_bf16_f32 v169, v142, v143
    v_cvt_pk_bf16_f32 v170, v144, v145
    v_cvt_pk_bf16_f32 v171, v146, v147
    s_cmp_lt_u32 s51, 7
    s_cselect_b32 s34, 0x4000000, 0
    v_mfma_f32_32x32x16_bf16 v[132:147], v[188:191], v[28:31], 0
    v_exp_f32 v148, v148
    buffer_load_dwordx4 v[204:207], v4, s[32:35], s55 offen offset:0 sc1
    v_exp_f32 v149, v149
    buffer_load_dwordx4 v[208:211], v4, s[32:35], s55 offen offset:2816 sc1
    v_exp_f32 v150, v150
    buffer_load_dwordx4 v[212:215], v5, s[32:35], s55 offen offset:0 sc1
    v_exp_f32 v151, v151
    buffer_load_dwordx4 v[216:219], v5, s[32:35], s55 offen offset:2816 sc1
    v_exp_f32 v152, v152
    s_add_u32 s55, s55, 11264
    v_mfma_f32_32x32x16_bf16 v[132:147], v[200:203], v[52:55], v[132:147]
    v_exp_f32 v153, v153
    v_exp_f32 v154, v154
    v_exp_f32 v155, v155
    v_cvt_pk_bf16_f32 v172, v148, v149
    v_cvt_pk_bf16_f32 v173, v150, v151
    v_cvt_pk_bf16_f32 v174, v152, v153
    v_cvt_pk_bf16_f32 v175, v154, v155
    v_mfma_f32_32x32x16_bf16 v[68:83], v[224:227], v[168:171], v[68:83]
    v_exp_f32 v156, v156
    v_exp_f32 v157, v157
    v_exp_f32 v158, v158
    v_exp_f32 v159, v159
    v_exp_f32 v160, v160
    v_mfma_f32_32x32x16_bf16 v[84:99], v[220:223], v[172:175], v[84:99]
    v_exp_f32 v161, v161
    v_exp_f32 v162, v162
    v_exp_f32 v163, v163
    v_cvt_pk_bf16_f32 v176, v156, v157
    v_cvt_pk_bf16_f32 v177, v158, v159
    v_cvt_pk_bf16_f32 v178, v160, v161
    v_cvt_pk_bf16_f32 v179, v162, v163
    v_mfma_f32_32x32x16_bf16 v[148:163], v[188:191], v[32:35], 0
    v_exp_f32 v132, v132
    v_exp_f32 v133, v133
    v_exp_f32 v134, v134
    v_exp_f32 v135, v135
    v_exp_f32 v136, v136
    v_mfma_f32_32x32x16_bf16 v[148:163], v[200:203], v[60:63], v[148:163]
    v_exp_f32 v137, v137
    v_exp_f32 v138, v138
    v_exp_f32 v139, v139
    v_cvt_pk_bf16_f32 v164, v132, v133
    v_cvt_pk_bf16_f32 v165, v134, v135
    v_cvt_pk_bf16_f32 v166, v136, v137
    v_cvt_pk_bf16_f32 v167, v138, v139
    v_mfma_f32_32x32x16_bf16 v[84:99], v[224:227], v[176:179], v[84:99]
    v_exp_f32 v140, v140
    v_exp_f32 v141, v141
    v_exp_f32 v142, v142
    v_exp_f32 v143, v143
    v_exp_f32 v144, v144
    v_mfma_f32_32x32x16_bf16 v[100:115], v[220:223], v[164:167], v[100:115]
    v_exp_f32 v145, v145
    v_exp_f32 v146, v146
    v_exp_f32 v147, v147
    v_cvt_pk_bf16_f32 v168, v140, v141
    v_cvt_pk_bf16_f32 v169, v142, v143
    v_cvt_pk_bf16_f32 v170, v144, v145
    v_cvt_pk_bf16_f32 v171, v146, v147
    v_mfma_f32_32x32x16_bf16 v[132:147], v[192:195], v[20:23], 0
    v_exp_f32 v148, v148
    v_exp_f32 v149, v149
    v_exp_f32 v150, v150
    v_exp_f32 v151, v151
    v_exp_f32 v152, v152
    v_mfma_f32_32x32x16_bf16 v[132:147], v[200:203], v[40:43], v[132:147]
    v_exp_f32 v153, v153
    v_exp_f32 v154, v154
    v_exp_f32 v155, v155
    v_cvt_pk_bf16_f32 v172, v148, v149
    v_cvt_pk_bf16_f32 v173, v150, v151
    v_cvt_pk_bf16_f32 v174, v152, v153
    v_cvt_pk_bf16_f32 v175, v154, v155
    v_mfma_f32_32x32x16_bf16 v[100:115], v[224:227], v[168:171], v[100:115]
    v_exp_f32 v156, v156
    v_exp_f32 v157, v157
    v_exp_f32 v158, v158
    v_exp_f32 v159, v159
    v_exp_f32 v160, v160
    v_mfma_f32_32x32x16_bf16 v[116:131], v[220:223], v[172:175], v[116:131]
    v_exp_f32 v161, v161
    v_exp_f32 v162, v162
    v_exp_f32 v163, v163
    v_cvt_pk_bf16_f32 v176, v156, v157
    v_cvt_pk_bf16_f32 v177, v158, v159
    v_cvt_pk_bf16_f32 v178, v160, v161
    v_cvt_pk_bf16_f32 v179, v162, v163
    v_mfma_f32_32x32x16_bf16 v[148:163], v[192:195], v[24:27], 0
    v_exp_f32 v132, v132
    v_exp_f32 v133, v133
    v_exp_f32 v134, v134
    v_exp_f32 v135, v135
    v_exp_f32 v136, v136
    v_mfma_f32_32x32x16_bf16 v[148:163], v[200:203], v[48:51], v[148:163]
    v_exp_f32 v137, v137
    v_exp_f32 v138, v138
    v_exp_f32 v139, v139
    v_cvt_pk_bf16_f32 v164, v132, v133
    v_cvt_pk_bf16_f32 v165, v134, v135
    v_cvt_pk_bf16_f32 v166, v136, v137
    v_cvt_pk_bf16_f32 v167, v138, v139
    v_mfma_f32_32x32x16_bf16 v[116:131], v[224:227], v[176:179], v[116:131]
    v_exp_f32 v140, v140
    v_exp_f32 v141, v141
    v_exp_f32 v142, v142
    v_exp_f32 v143, v143
    v_exp_f32 v144, v144
    v_mfma_f32_32x32x16_bf16 v[68:83], v[228:231], v[164:167], v[68:83]
    v_exp_f32 v145, v145
    v_exp_f32 v146, v146
    v_exp_f32 v147, v147
    v_cvt_pk_bf16_f32 v168, v140, v141
    v_cvt_pk_bf16_f32 v169, v142, v143
    v_cvt_pk_bf16_f32 v170, v144, v145
    v_cvt_pk_bf16_f32 v171, v146, v147
    v_mfma_f32_32x32x16_bf16 v[132:147], v[192:195], v[28:31], 0
    v_exp_f32 v148, v148
    v_exp_f32 v149, v149
    v_exp_f32 v150, v150
    v_exp_f32 v151, v151
    v_exp_f32 v152, v152
    v_mfma_f32_32x32x16_bf16 v[132:147], v[200:203], v[56:59], v[132:147]
    v_exp_f32 v153, v153
    v_exp_f32 v154, v154
    v_exp_f32 v155, v155
    v_cvt_pk_bf16_f32 v172, v148, v149
    v_cvt_pk_bf16_f32 v173, v150, v151
    v_cvt_pk_bf16_f32 v174, v152, v153
    v_cvt_pk_bf16_f32 v175, v154, v155
    v_mfma_f32_32x32x16_bf16 v[68:83], v[232:235], v[168:171], v[68:83]
    v_exp_f32 v156, v156
    v_exp_f32 v157, v157
    v_exp_f32 v158, v158
    v_exp_f32 v159, v159
    v_exp_f32 v160, v160
    v_mfma_f32_32x32x16_bf16 v[84:99], v[228:231], v[172:175], v[84:99]
    v_exp_f32 v161, v161
    v_exp_f32 v162, v162
    v_exp_f32 v163, v163
    v_cvt_pk_bf16_f32 v176, v156, v157
    v_cvt_pk_bf16_f32 v177, v158, v159
    v_cvt_pk_bf16_f32 v178, v160, v161
    v_cvt_pk_bf16_f32 v179, v162, v163
    v_mfma_f32_32x32x16_bf16 v[148:163], v[192:195], v[32:35], 0
    v_exp_f32 v132, v132
    v_exp_f32 v133, v133
    v_exp_f32 v134, v134
    v_exp_f32 v135, v135
    v_exp_f32 v136, v136
    v_mfma_f32_32x32x16_bf16 v[148:163], v[200:203], v[64:67], v[148:163]
    v_exp_f32 v137, v137
    v_exp_f32 v138, v138
    v_exp_f32 v139, v139
    v_cvt_pk_bf16_f32 v164, v132, v133
    v_cvt_pk_bf16_f32 v165, v134, v135
    v_cvt_pk_bf16_f32 v166, v136, v137
    v_cvt_pk_bf16_f32 v167, v138, v139
    v_mfma_f32_32x32x16_bf16 v[84:99], v[232:235], v[176:179], v[84:99]
    v_exp_f32 v140, v140
    v_exp_f32 v141, v141
    v_exp_f32 v142, v142
    v_exp_f32 v143, v143
    v_exp_f32 v144, v144
    v_mfma_f32_32x32x16_bf16 v[100:115], v[228:231], v[164:167], v[100:115]
    v_exp_f32 v145, v145
    v_exp_f32 v146, v146
    v_exp_f32 v147, v147
    v_cvt_pk_bf16_f32 v168, v140, v141
    v_cvt_pk_bf16_f32 v169, v142, v143
    v_cvt_pk_bf16_f32 v170, v144, v145
    v_cvt_pk_bf16_f32 v171, v146, v147
    s_waitcnt vmcnt(4)
    v_mfma_f32_32x32x16_bf16 v[132:147], v[180:183], v[20:23], 0
    v_exp_f32 v148, v148
    buffer_load_dwordx4 v[188:191], v3, s[32:35], s52 offen sc1
    v_exp_f32 v149, v149
    buffer_load_dwordx4 v[192:195], v3, s[32:35], s52 offen offset:1024 sc1
    s_branch L_ps_2_0
L_pw_a2_0:
    s_branch L_pw_a2_1
L_pw_b2_0:
    s_branch L_pw_b2_1
L_pw_c2_0:
    s_branch L_pw_c2_1
L_ps_2_0:
    v_exp_f32 v150, v150
    buffer_load_dwordx2 v[200:201], v2, s[32:35], s52 offen offset:2048 sc1
    v_exp_f32 v151, v151
    s_add_u32 s52, s52, 2560
    v_exp_f32 v152, v152
    v_mfma_f32_32x32x16_bf16 v[132:147], v[196:199], v[36:39], v[132:147]
    v_exp_f32 v153, v153
    v_exp_f32 v154, v154
    v_exp_f32 v155, v155
    v_cvt_pk_bf16_f32 v172, v148, v149
    v_cvt_pk_bf16_f32 v173, v150, v151
    v_cvt_pk_bf16_f32 v174, v152, v153
    v_cvt_pk_bf16_f32 v175, v154, v155
    v_mfma_f32_32x32x16_bf16 v[100:115], v[232:235], v[168:171], v[100:115]
    v_exp_f32 v156, v156
    v_exp_f32 v157, v157
    v_exp_f32 v158, v158
    v_exp_f32 v159, v159
    v_exp_f32 v160, v160
    v_mfma_f32_32x32x16_bf16 v[116:131], v[228:231], v[172:175], v[116:131]
    v_exp_f32 v161, v161
    v_exp_f32 v162, v162
    v_exp_f32 v163, v163
    v_cvt_pk_bf16_f32 v176, v156, v157
    v_cvt_pk_bf16_f32 v177, v158, v159
    v_cvt_pk_bf16_f32 v178, v160, v161
    v_cvt_pk_bf16_f32 v179, v162, v163
    s_add_u32 s51, s51, 1
    s_cmp_lt_u32 s51, 8
    s_cbranch_scc1 L_att_loop
    v_mfma_f32_32x32x16_bf16 v[116:131], v[232:235], v[176:179], v[116:131]
    s_mul_i32 s60, s46, 6144
    v_add_u32 v6, s60, v3
    s_xor_b32 s60, s46, 2
    s_mul_i32 s60, s60, 6144
    v_add_u32 v7, s60, v3
    s_cmp_ge_u32 s46, 2
    s_cbranch_scc1 L_att_hi
    ds_write_b128 v6, v[100:103] offset:0
    ds_write_b128 v6, v[104:107] offset:1024
    ds_write_b128 v6, v[108:111] offset:2048
    s_nop 1
    ds_write_b128 v6, v[116:119] offset:3072
    ds_write_b128 v6, v[120:123] offset:4096
    ds_write_b128 v6, v[124:127] offset:5120
    s_branch L_att_x
L_att_hi:
    ds_write_b128 v6, v[68:71] offset:0
    ds_write_b128 v6, v[72:75] offset:1024
    ds_write_b128 v6, v[76:79] offset:2048
    ds_write_b128 v6, v[84:87] offset:3072
    ds_write_b128 v6, v[88:91] offset:4096
    ds_write_b128 v6, v[92:95] offset:5120
    v_mov_b32 v68, v100
    v_mov_b32 v69, v101
    v_mov_b32 v70, v102
    v_mov_b32 v71, v103
    v_mov_b32 v72, v104
    v_mov_b32 v73, v105
    v_mov_b32 v74, v106
    v_mov_b32 v75, v107
    v_mov_b32 v76, v108
    v_mov_b32 v77, v109
    v_mov_b32 v78, v110
    v_mov_b32 v79, v111
    v_mov_b32 v84, v116
    v_mov_b32 v85, v117
    v_mov_b32 v86, v118
    v_mov_b32 v87, v119
    v_mov_b32 v88, v120
    v_mov_b32 v89, v121
    v_mov_b32 v90, v122
    v_mov_b32 v91, v123
    v_mov_b32 v92, v124
    v_mov_b32 v93, v125
    v_mov_b32 v94, v126
    v_mov_b32 v95, v127
    s_add_u32 s49, s49, 2
L_att_x:
    s_waitcnt lgkmcnt(0)
    s_barrier
    ds_read_b128 v[132:135], v7 offset:0
    ds_read_b128 v[136:139], v7 offset:1024
    ds_read_b128 v[140:143], v7 offset:2048
    ds_read_b128 v[148:151], v7 offset:3072
    ds_read_b128 v[152:155], v7 offset:4096
    ds_read_b128 v[156:159], v7 offset:5120
    s_mul_i32 s60, s49, 40960
    s_add_u32 s60, s60, 0x1800000
    s_lshl_b32 s61, s48, 10
    s_add_u32 s61, s61, s60
    s_lshr_b32 s62, s48, 2
    s_lshl_b32 s62, s62, 10
    s_add_u32 s62, s62, s60
    s_add_u32 s62, s62, 32768
    s_and_b32 s63, s48, 1
    s_lshl_b32 s63, s63, 9
    s_add_u32 s62, s62, s63
    s_and_b32 s63, s48, 2
    s_lshl_b32 s63, s63, 2
    s_add_u32 s62, s62, s63
    s_mov_b64 s[58:59], 0
    s_cmp_eq_u32 s64, 0
    s_cselect_b32 s34, 0x4000000, 0
    s_movk_i32 s63, 0x207
    s_mov_b32 s60, 0x7b800000
    s_waitcnt lgkmcnt(3)
    v_add_f32 v68, v68, v132
    v_add_f32 v69, v69, v133
    v_add_f32 v70, v70, v134
    v_add_f32 v71, v71, v135
    v_add_f32 v72, v72, v136
    v_add_f32 v73, v73, v137
    v_add_f32 v74, v74, v138
    v_add_f32 v75, v75, v139
    v_add_f32 v76, v76, v140
    v_add_f32 v77, v77, v141
    v_add_f32 v78, v78, v142
    v_add_f32 v79, v79, v143
    v_mov_b32 v6, v76
    v_mov_b32 v8, v76
    s_nop 1
    v_permlane32_swap_b32 v6, v8
    v_cmp_nge_f32 vcc, s60, v8
    v_rcp_f32 v6, v8
    s_or_b64 s[58:59], s[58:59], vcc
    v_cmp_nlt_f32 vcc, 0xd800000, v8
    v_mul_f32 v68, v68, v6
    s_or_b64 s[58:59], s[58:59], vcc
    v_mul_f32 v69, v69, v6
    v_mul_f32 v70, v70, v6
    v_mul_f32 v71, v71, v6
    v_mul_f32 v72, v72, v6
    v_mul_f32 v73, v73, v6
    v_mul_f32 v74, v74, v6
    v_mul_f32 v75, v75, v6
    v_mul_f32 v76, v76, v6
    v_mul_f32 v77, v77, v6
    v_mul_f32 v78, v78, v6
    v_mul_f32 v79, v79, v6
    v_cvt_pk_bf16_f32 v132, v68, v69
    v_cvt_pk_bf16_f32 v133, v70, v71
    v_cvt_pk_bf16_f32 v134, v72, v73
    v_cvt_pk_bf16_f32 v135, v74, v75
    v_cvt_pk_bf16_f32 v136, v76, v77
    v_cvt_pk_bf16_f32 v137, v78, v79
    buffer_store_dwordx4 v[132:135], v3, s[32:35], s61 offen sc1
    s_mov_b64 exec, s[56:57]
    buffer_store_dwordx2 v[136:137], v3, s[32:35], s62 offen sc1
    s_mov_b64 exec, -1
    s_add_u32 s61, s61, 40960
    s_add_u32 s62, s62, 40960
    s_waitcnt lgkmcnt(0)
    v_add_f32 v84, v84, v148
    v_add_f32 v85, v85, v149
    v_add_f32 v86, v86, v150
    v_add_f32 v87, v87, v151
    v_add_f32 v88, v88, v152
    v_add_f32 v89, v89, v153
    v_add_f32 v90, v90, v154
    v_add_f32 v91, v91, v155
    v_add_f32 v92, v92, v156
    v_add_f32 v93, v93, v157
    v_add_f32 v94, v94, v158
    v_add_f32 v95, v95, v159
    v_mov_b32 v6, v92
    v_mov_b32 v8, v92
    s_nop 1
    v_permlane32_swap_b32 v6, v8
    v_cmp_nge_f32 vcc, s60, v8
    v_rcp_f32 v6, v8
    s_or_b64 s[58:59], s[58:59], vcc
    v_cmp_nlt_f32 vcc, 0xd800000, v8
    v_mul_f32 v84, v84, v6
    s_or_b64 s[58:59], s[58:59], vcc
    v_mul_f32 v85, v85, v6
    v_mul_f32 v86, v86, v6
    v_mul_f32 v87, v87, v6
    v_mul_f32 v88, v88, v6
    v_mul_f32 v89, v89, v6
    v_mul_f32 v90, v90, v6
    v_mul_f32 v91, v91, v6
    v_mul_f32 v92, v92, v6
    v_mul_f32 v93, v93, v6
    v_mul_f32 v94, v94, v6
    v_mul_f32 v95, v95, v6
    v_cvt_pk_bf16_f32 v148, v84, v85
    v_cvt_pk_bf16_f32 v149, v86, v87
    v_cvt_pk_bf16_f32 v150, v88, v89
    v_cvt_pk_bf16_f32 v151, v90, v91
    v_cvt_pk_bf16_f32 v152, v92, v93
    v_cvt_pk_bf16_f32 v153, v94, v95
    buffer_store_dwordx4 v[148:151], v3, s[32:35], s61 offen sc1
    s_mov_b64 exec, s[56:57]
    buffer_store_dwordx2 v[152:153], v3, s[32:35], s62 offen sc1
    s_mov_b64 exec, -1
    v_pk_add_f32 v[68:69], v[68:69], v[70:71]
    v_pk_add_f32 v[72:73], v[72:73], v[74:75]
    v_pk_add_f32 v[76:77], v[76:77], v[78:79]
    v_pk_add_f32 v[68:69], v[68:69], v[72:73]
    v_pk_add_f32 v[68:69], v[68:69], v[76:77]
    v_add_f32 v6, v68, v69
    v_cmp_class_f32 vcc, v6, s63
    s_or_b64 s[58:59], s[58:59], vcc
    v_pk_add_f32 v[84:85], v[84:85], v[86:87]
    v_pk_add_f32 v[88:89], v[88:89], v[90:91]
    v_pk_add_f32 v[92:93], v[92:93], v[94:95]
    v_pk_add_f32 v[84:85], v[84:85], v[88:89]
    v_pk_add_f32 v[84:85], v[84:85], v[92:93]
    v_add_f32 v6, v84, v85
    v_cmp_class_f32 vcc, v6, s63
    s_or_b64 s[58:59], s[58:59], vcc
    s_cmp_lg_u32 s50, 0
    s_cselect_b64 s[58:59], 0, s[58:59]
    s_cmp_eq_u64 s[58:59], 0
    s_cbranch_scc1 L_att_pub
    v_mov_b32 v6, 66560
    v_mov_b32 v7, 1
    ds_write_b32 v6, v7
    s_branch L_att_np
L_att_pub:
    s_lshl_b32 s60, s49, 7
    s_lshl_b32 s61, s48, 3
    s_add_u32 s60, s60, s61
    s_add_u32 s60, s60, 0x1d14000
    v_mov_b32 v12, s44
    v_mov_b32 v13, s45
    v_mov_b32 v6, 0
    s_mov_b32 s64, 1
    s_waitcnt vmcnt(0)
    s_mov_b64 exec, 1
    buffer_store_dwordx2 v[12:13], v6, s[24:27], s60 offen sc1
    s_mov_b64 exec, -1
    s_cmp_lg_u32 s50, 0
    s_cbranch_scc1 L_end
L_att_np:
    s_waitcnt lgkmcnt(0)
    s_barrier
    v_mov_b32 v6, 66560
    ds_read_b32 v7, v6
    s_waitcnt lgkmcnt(0)
    v_readfirstlane_b32 s60, v7
    s_nop 3
    s_cmp_eq_u32 s60, 0
    s_cbranch_scc1 L_end
    s_mov_b32 s50, 1
    s_lshl_b32 s49, s54, 3
    s_and_b32 s60, s46, 1
    s_lshl_b32 s60, s60, 2
    s_add_u32 s49, s49, s60
    s_branch L_att_start
L_pw_a1_3:
    s_branch L_pw_a_ret
L_pw_b1_3:
    s_branch L_pw_b_ret
L_pw_c1_3:
    s_branch L_pw_c_ret
L_att_c3:
    buffer_load_dwordx4 v[12:15], v9, s[24:27], 0 offen sc1
    s_branch L_att_r3
L_att_c7:
    s_waitcnt vmcnt(0)
    v_cmp_ne_u64 vcc, s[44:45], v[12:13]
    v_cmp_ne_u64 s[62:63], s[44:45], v[14:15]
    s_nop 1
    s_or_b64 vcc, vcc, s[62:63]
    s_cbranch_scc0 L_att_r7
    s_mov_b32 s3, 0
    s_branch L_wait_12_a
L_wait_12:
    s_sleep 4
L_wait_12_a:
    buffer_load_dwordx4 v[12:15], v9, s[24:27], 0 offen sc1
    s_add_u32 s3, s3, 1
    s_cmp_gt_u32 s3, 40000
    s_cbranch_scc1 L_end
    s_waitcnt vmcnt(0)
    v_cmp_ne_u64 vcc, s[44:45], v[12:13]
    v_cmp_ne_u64 s[62:63], s[44:45], v[14:15]
    s_nop 1
    s_or_b64 vcc, vcc, s[62:63]
    s_cmp_lg_u64 vcc, 0
    s_cbranch_scc1 L_wait_12
    s_branch L_att_r7
L_att_start:
    s_mov_b32 s62, s53
    buffer_load_dwordx4 v[188:191], v3, s[24:27], s62 offen sc1
    buffer_load_dwordx4 v[192:195], v3, s[24:27], s62 offen offset:1024 sc1
    buffer_load_dwordx2 v[200:201], v2, s[24:27], s62 offen offset:2048 sc1
    s_lshl_b32 s60, s48, 16
    s_lshl_b32 s61, s49, 10
    s_add_u32 s60, s60, s61
    buffer_load_dwordx4 v[20:23], v3, s[24:27], s60 offen offset:0 sc1
    buffer_load_dwordx4 v[24:27], v3, s[24:27], s60 offen offset:1024 sc1
    buffer_load_dwordx4 v[28:31], v3, s[24:27], s60 offen offset:2048 sc1
    buffer_load_dwordx4 v[32:35], v3, s[24:27], s60 offen offset:3072 sc1
    s_lshl_b32 s60, s48, 14
    s_lshl_b32 s61, s49, 8
    s_add_u32 s60, s60, s61
    s_add_u32 s60, s60, 0x200000
    v_and_b32 v6, 0xff, v2
    buffer_load_dwordx2 v[36:37], v6, s[24:27], s60 offen offset:0 sc1
    buffer_load_dwordx2 v[44:45], v6, s[24:27], s60 offen offset:256 sc1
    buffer_load_dwordx2 v[52:53], v6, s[24:27], s60 offen offset:512 sc1
    buffer_load_dwordx2 v[60:61], v6, s[24:27], s60 offen offset:768 sc1
    s_lshr_b32 s60, s46, 1
    s_mul_i32 s60, s60, 40960
    s_add_u32 s52, s53, s60
    s_lshr_b32 s60, s46, 1
    s_mul_i32 s60, s60, 180224
    s_lshr_b32 s61, s48, 2
    s_mul_i32 s61, s61, 360448
    s_add_u32 s60, s60, s61
    s_add_u32 s55, s60, 0x800000
    buffer_load_dwordx4 v[180:183], v3, s[24:27], s52 offen sc1
    buffer_load_dwordx4 v[184:187], v3, s[24:27], s52 offen offset:1024 sc1
    buffer_load_dwordx2 v[196:197], v2, s[24:27], s52 offen offset:2048 sc1
    buffer_load_dwordx4 v[204:207], v4, s[24:27], s55 offen offset:0 sc1
    buffer_load_dwordx4 v[208:211], v4, s[24:27], s55 offen offset:2816 sc1
    buffer_load_dwordx4 v[212:215], v5, s[24:27], s55 offen offset:0 sc1
    buffer_load_dwordx4 v[216:219], v5, s[24:27], s55 offen offset:2816 sc1
    s_add_u32 s52, s52, 2560
    s_add_u32 s55, s55, 11264
    v_mov_b32 v16, 0xff800000
    v_mov_b32 v17, 0xff800000
    v_mov_b32 v18, 0xff800000
    v_mov_b32 v19, 0xff800000
    v_mov_b32 v38, 0
    v_mov_b32 v39, 0
    v_mov_b32 v42, 0
    v_mov_b32 v43, 0
    v_mov_b32 v46, 0
    v_mov_b32 v47, 0
    v_mov_b32 v50, 0
    v_mov_b32 v51, 0
    v_mov_b32 v54, 0
    v_mov_b32 v55, 0
    v_mov_b32 v58, 0
    v_mov_b32 v59, 0
    v_mov_b32 v62, 0
    v_mov_b32 v63, 0
    v_mov_b32 v66, 0
    v_mov_b32 v67, 0
    s_cmp_eq_u32 s50, 0
    s_cselect_b32 s51, 1, 32
    s_waitcnt vmcnt(7)
    v_cndmask_b32 v40, v36, 0, s[56:57]
    v_cndmask_b32 v36, 0, v36, s[56:57]
    v_cndmask_b32 v41, v37, 0, s[56:57]
    v_cndmask_b32 v37, 0, v37, s[56:57]
    v_cndmask_b32 v48, v44, 0, s[56:57]
    v_cndmask_b32 v44, 0, v44, s[56:57]
    v_cndmask_b32 v49, v45, 0, s[56:57]
    v_cndmask_b32 v45, 0, v45, s[56:57]
    v_cndmask_b32 v56, v52, 0, s[56:57]
    v_cndmask_b32 v52, 0, v52, s[56:57]
    v_cndmask_b32 v57, v53, 0, s[56:57]
    v_cndmask_b32 v53, 0, v53, s[56:57]
    v_cndmask_b32 v64, v60, 0, s[56:57]
    v_cndmask_b32 v60, 0, v60, s[56:57]
    v_cndmask_b32 v65, v61, 0, s[56:57]
    v_cndmask_b32 v61, 0, v61, s[56:57]
L_att_scan:
    v_mfma_f32_32x32x16_bf16 v[68:83], v[188:191], v[20:23], 0
    v_mfma_f32_32x32x16_bf16 v[68:83], v[200:203], v[36:39], v[68:83]
    v_mfma_f32_32x32x16_bf16 v[84:99], v[188:191], v[24:27], 0
    v_mfma_f32_32x32x16_bf16 v[84:99], v[200:203], v[44:47], v[84:99]
    s_nop 9
    v_max3_f32 v16, v68, v69, v16
    v_max3_f32 v16, v70, v71, v16
    v_max3_f32 v16, v72, v73, v16
    v_max3_f32 v16, v74, v75, v16
    v_max3_f32 v16, v76, v77, v16
    v_max3_f32 v16, v78, v79, v16
    v_max3_f32 v16, v80, v81, v16
    v_max3_f32 v16, v82, v83, v16
    v_mfma_f32_32x32x16_bf16 v[100:115], v[188:191], v[28:31], 0
    v_mfma_f32_32x32x16_bf16 v[100:115], v[200:203], v[52:55], v[100:115]
    v_max3_f32 v17, v84, v85, v17
    v_max3_f32 v17, v86, v87, v17
    v_max3_f32 v17, v88, v89, v17
    v_max3_f32 v17, v90, v91, v17
    v_max3_f32 v17, v92, v93, v17
    v_max3_f32 v17, v94, v95, v17
    v_max3_f32 v17, v96, v97, v17
    v_max3_f32 v17, v98, v99, v17
    v_mfma_f32_32x32x16_bf16 v[116:131], v[188:191], v[32:35], 0
    v_mfma_f32_32x32x16_bf16 v[116:131], v[200:203], v[60:63], v[116:131]
    s_nop 1
    v_max3_f32 v18, v100, v101, v18
    v_max3_f32 v18, v102, v103, v18
    v_max3_f32 v18, v104, v105, v18
    v_max3_f32 v18, v106, v107, v18
    v_max3_f32 v18, v108, v109, v18
    v_max3_f32 v18, v110, v111, v18
    v_max3_f32 v18, v112, v113, v18
    v_max3_f32 v18, v114, v115, v18
    s_nop 1
    v_max3_f32 v19, v116, v117, v19
    v_max3_f32 v19, v118, v119, v19
    v_max3_f32 v19, v120, v121, v19
    v_max3_f32 v19, v122, v123, v19
    v_max3_f32 v19, v124, v125, v19
    v_max3_f32 v19, v126, v127, v19
    v_max3_f32 v19, v128, v129, v19
    v_max3_f32 v19, v130, v131, v19
    v_mfma_f32_32x32x16_bf16 v[68:83], v[192:195], v[20:23], 0
    v_mfma_f32_32x32x16_bf16 v[68:83], v[200:203], v[40:43], v[68:83]
    v_mfma_f32_32x32x16_bf16 v[84:99], v[192:195], v[24:27], 0
    v_mfma_f32_32x32x16_bf16 v[84:99], v[200:203], v[48:51], v[84:99]
    v_mfma_f32_32x32x16_bf16 v[100:115], v[192:195], v[28:31], 0
    v_mfma_f32_32x32x16_bf16 v[100:115], v[200:203], v[56:59], v[100:115]
    v_mfma_f32_32x32x16_bf16 v[116:131], v[192:195], v[32:35], 0
    v_mfma_f32_32x32x16_bf16 v[116:131], v[200:203], v[64:67], v[116:131]
    s_sub_u32 s51, s51, 1
    s_add_u32 s62, s62, 2560
    s_cmp_eq_u32 s51, 0
    s_cselect_b32 s63, s52, s62
    buffer_load_dwordx4 v[188:191], v3, s[24:27], s63 offen sc1
    buffer_load_dwordx4 v[192:195], v3, s[24:27], s63 offen offset:1024 sc1
    buffer_load_dwordx2 v[200:201], v2, s[24:27], s63 offen offset:2048 sc1
    v_max3_f32 v16, v68, v69, v16
    v_max3_f32 v16, v70, v71, v16
    v_max3_f32 v16, v72, v73, v16
    v_max3_f32 v16, v74, v75, v16
    v_max3_f32 v16, v76, v77, v16
    v_max3_f32 v16, v78, v79, v16
    v_max3_f32 v16, v80, v81, v16
    v_max3_f32 v16, v82, v83, v16
    v_max3_f32 v17, v84, v85, v17
    v_max3_f32 v17, v86, v87, v17
    v_max3_f32 v17, v88, v89, v17
    v_max3_f32 v17, v90, v91, v17
    v_max3_f32 v17, v92, v93, v17
    v_max3_f32 v17, v94, v95, v17
    v_max3_f32 v17, v96, v97, v17
    v_max3_f32 v17, v98, v99, v17
    v_max3_f32 v18, v100, v101, v18
    v_max3_f32 v18, v102, v103, v18
    v_max3_f32 v18, v104, v105, v18
    v_max3_f32 v18, v106, v107, v18
    v_max3_f32 v18, v108, v109, v18
    v_max3_f32 v18, v110, v111, v18
    v_max3_f32 v18, v112, v113, v18
    v_max3_f32 v18, v114, v115, v18
    v_max3_f32 v19, v116, v117, v19
    v_max3_f32 v19, v118, v119, v19
    v_max3_f32 v19, v120, v121, v19
    v_max3_f32 v19, v122, v123, v19
    v_max3_f32 v19, v124, v125, v19
    v_max3_f32 v19, v126, v127, v19
    v_max3_f32 v19, v128, v129, v19
    v_max3_f32 v19, v130, v131, v19
    s_cmp_eq_u32 s51, 0
    s_cbranch_scc1 L_att_scan_done
    s_waitcnt vmcnt(0)
    s_branch L_att_scan
L_att_scan_done:
    s_add_u32 s52, s52, 2560
    s_cmp_eq_u32 s50, 0
    s_cselect_b32 s60, 0xc2b40000, 0
    v_mov_b32 v6, v16
    s_nop 1
    v_permlane32_swap_b32 v6, v16
    v_max_f32 v6, v6, v16
    v_sub_f32 v6, s60, v6
    v_cvt_pk_bf16_f32 v7, v6, v6
    v_and_b32 v7, 0xffff0000, v7
    v_sub_f32 v7, v6, v7
    v_cvt_pk_bf16_f32 v8, v7, v7
    v_and_b32 v8, 0xffff0000, v8
    v_sub_f32 v8, v7, v8
    v_cvt_pk_bf16_f32 v6, v6, v7
    v_cvt_pk_bf16_f32 v8, v8, 0
    v_cndmask_b32 v38, 0, v6, s[56:57]
    v_cndmask_b32 v39, 0, v8, s[56:57]
    v_cndmask_b32 v42, v6, 0, s[56:57]
    v_cndmask_b32 v43, v8, 0, s[56:57]
    v_mov_b32 v6, v17
    s_nop 1
    v_permlane32_swap_b32 v6, v17
    v_max_f32 v6, v6, v17
    v_sub_f32 v6, s60, v6
    v_cvt_pk_bf16_f32 v7, v6, v6
    v_and_b32 v7, 0xffff0000, v7
    v_sub_f32 v7, v6, v7
    v_cvt_pk_bf16_f32 v8, v7, v7
    v_and_b32 v8, 0xffff0000, v8
    v_sub_f32 v8, v7, v8
    v_cvt_pk_bf16_f32 v6, v6, v7
    v_cvt_pk_bf16_f32 v8, v8, 0
    v_cndmask_b32 v46, 0, v6, s[56:57]
    v_cndmask_b32 v47, 0, v8, s[56:57]
    v_cndmask_b32 v50, v6, 0, s[56:57]
    v_cndmask_b32 v51, v8, 0, s[56:57]
    v_mov_b32 v6, v18
    s_nop 1
    v_permlane32_swap_b32 v6, v18
    v_max_f32 v6, v6, v18
    v_sub_f32 v6, s60, v6
    v_cvt_pk_bf16_f32 v7, v6, v6
    v_and_b32 v7, 0xffff0000, v7
    v_sub_f32 v7, v6, v7
    v_cvt_pk_bf16_f32 v8, v7, v7
    v_and_b32 v8, 0xffff0000, v8
    v_sub_f32 v8, v7, v8
    v_cvt_pk_bf16_f32 v6, v6, v7
    v_cvt_pk_bf16_f32 v8, v8, 0
    v_cndmask_b32 v54, 0, v6, s[56:57]
    v_cndmask_b32 v55, 0, v8, s[56:57]
    v_cndmask_b32 v58, v6, 0, s[56:57]
    v_cndmask_b32 v59, v8, 0, s[56:57]
    v_mov_b32 v6, v19
    s_nop 1
    v_permlane32_swap_b32 v6, v19
    v_max_f32 v6, v6, v19
    v_sub_f32 v6, s60, v6
    v_cvt_pk_bf16_f32 v7, v6, v6
    v_and_b32 v7, 0xffff0000, v7
    v_sub_f32 v7, v6, v7
    v_cvt_pk_bf16_f32 v8, v7, v7
    v_and_b32 v8, 0xffff0000, v8
    v_sub_f32 v8, v7, v8
    v_cvt_pk_bf16_f32 v6, v6, v7
    v_cvt_pk_bf16_f32 v8, v8, 0
    v_cndmask_b32 v62, 0, v6, s[56:57]
    v_cndmask_b32 v63, 0, v8, s[56:57]
    v_cndmask_b32 v66, v6, 0, s[56:57]
    v_cndmask_b32 v67, v8, 0, s[56:57]
    s_waitcnt vmcnt(3)
    v_mfma_f32_32x32x16_bf16 v[132:147], v[180:183], v[20:23], 0
    v_mfma_f32_32x32x16_bf16 v[132:147], v[196:199], v[36:39], v[132:147]
    v_mov_b32 v68, 0
    v_mov_b32 v69, 0
    v_mov_b32 v70, 0
    v_mov_b32 v71, 0
    v_mov_b32 v72, 0
    v_mov_b32 v73, 0
    v_mov_b32 v74, 0
    v_mov_b32 v75, 0
    v_mov_b32 v76, 0
    v_mov_b32 v77, 0
    v_mov_b32 v78, 0
    v_mov_b32 v79, 0
    v_mov_b32 v80, 0
    v_mov_b32 v81, 0
    v_mov_b32 v82, 0
    v_mov_b32 v83, 0
    v_mov_b32 v84, 0
    v_mov_b32 v85, 0
    v_mov_b32 v86, 0
    v_mov_b32 v87, 0
    v_mov_b32 v88, 0
    v_mov_b32 v89, 0
    v_mov_b32 v90, 0
    v_mov_b32 v91, 0
    v_mov_b32 v92, 0
    v_mov_b32 v93, 0
    v_mov_b32 v94, 0
    v_mov_b32 v95, 0
    v_mov_b32 v96, 0
    v_mov_b32 v97, 0
    v_mov_b32 v98, 0
    v_mov_b32 v99, 0
    v_mov_b32 v100, 0
    v_mov_b32 v101, 0
    v_mov_b32 v102, 0
    v_mov_b32 v103, 0
    v_mov_b32 v104, 0
    v_mov_b32 v105, 0
    v_mov_b32 v106, 0
    v_mov_b32 v107, 0
    v_mov_b32 v108, 0
    v_mov_b32 v109, 0
    v_mov_b32 v110, 0
    v_mov_b32 v111, 0
    v_mov_b32 v112, 0
    v_mov_b32 v113, 0
    v_mov_b32 v114, 0
    v_mov_b32 v115, 0
    v_mov_b32 v116, 0
    v_mov_b32 v117, 0
    v_mov_b32 v118, 0
    v_mov_b32 v119, 0
    v_mov_b32 v120, 0
    v_mov_b32 v121, 0
    v_mov_b32 v122, 0
    v_mov_b32 v123, 0
    v_mov_b32 v124, 0
    v_mov_b32 v125, 0
    v_mov_b32 v126, 0
    v_mov_b32 v127, 0
    v_mov_b32 v128, 0
    v_mov_b32 v129, 0
    v_mov_b32 v130, 0
    v_mov_b32 v131, 0
    v_mov_b32 v176, 0
    v_mov_b32 v232, 0
    v_mov_b32 v177, 0
    v_mov_b32 v233, 0
    v_mov_b32 v178, 0
    v_mov_b32 v234, 0
    v_mov_b32 v179, 0
    v_mov_b32 v235, 0
    s_mov_b32 s51, 0
    s_mov_b32 s32, s22
    s_and_b32 s33, s23, 0xffff
    s_mov_b32 s34, 0x4000000
    s_mov_b32 s35, 0x00020000
    s_branch L_att_loop
    s_branch L_end
L_roleB:
    s_waitcnt lgkmcnt(0)
    s_mov_b32 s24, s22
    s_and_b32 s25, s23, 0xffff
    s_mov_b32 s26, 0x4000000
    s_mov_b32 s27, 0x00020000
    s_mov_b32 s28, s20
    s_and_b32 s29, s21, 0xffff
    s_mov_b32 s30, 0x100
    s_mov_b32 s31, 0x00020000
    s_mov_b32 s95, s44
    s_setprio 3
    s_mov_b32 s44, 0
    s_cmp_lt_u32 s47, 128
    s_cbranch_scc1 L_cs1_skip
    s_bfe_u32 s48, s47, 0x20001
    s_sub_u32 s49, s47, 128
    s_lshr_b32 s49, s49, 3
    s_lshl_b32 s49, s49, 1
    s_and_b32 s60, s47, 1
    s_add_u32 s49, s49, s60
    s_mul_i32 s60, s48, 15
    s_add_u32 s61, s60, 16
    s_lshr_b32 s61, s61, 1
    s_add_u32 s60, s60, 1
    s_lshr_b32 s60, s60, 1
    s_lshr_b32 s62, s49, 2
    s_add_u32 s60, s60, s62
    s_cmp_ge_u32 s60, s61
    s_cbranch_scc1 L_cs1_none
    s_and_b32 s49, s49, 3
    s_lshl_b32 s50, s60, 7
    s_mul_i32 s61, s49, 614400
    s_add_u32 s50, s50, s61
    s_lshl_b32 s51, s60, 11
    s_lshl_b32 s61, s49, 3
    s_add_u32 s51, s51, s61
    s_add_u32 s51, s51, 0x1c10000
    s_mov_b32 s32, s6
    s_and_b32 s33, s7, 0xffff
    s_mov_b32 s34, 0x258000
    s_mov_b32 s35, 0x00020000
    v_and_b32 v1, 63, v0
    v_lshrrev_b32 v2, 3, v1
    v_and_b32 v3, 7, v1
    v_mul_u32_u24 v2, 3840, v2
    v_lshl_add_u32 v3, v3, 4, v2
    s_mul_i32 s60, s46, 153600
    s_add_u32 s60, s60, s50
    buffer_load_dwordx4 v[16:19], v3, s[32:35], s60 offen
    s_add_u32 s60, s60, 30720
    buffer_load_dwordx4 v[20:23], v3, s[32:35], s60 offen
    s_add_u32 s60, s60, 30720
    buffer_load_dwordx4 v[24:27], v3, s[32:35], s60 offen
    s_add_u32 s60, s60, 30720
    buffer_load_dwordx4 v[28:31], v3, s[32:35], s60 offen
    s_add_u32 s60, s60, 30720
    buffer_load_dwordx4 v[32:35], v3, s[32:35], s60 offen
    s_add_u32 s60, s60, 30720
    s_cmp_eq_u32 s46, 0
    s_cbranch_scc1 L_pw_b0_0
    s_cmp_eq_u32 s46, 1
    s_cbranch_scc1 L_pw_b1_0
    s_cmp_eq_u32 s46, 2
    s_cbranch_scc1 L_pw_b2_0
    s_cmp_eq_u32 s46, 3
    s_cbranch_scc1 L_pw_b3_0
L_pw_b_ret:
    v_mov_b32 v240, 0
    v_mov_b32 v241, 0
    v_mov_b32 v242, 0
    v_mov_b32 v243, 0
    v_mov_b32 v244, 0
    v_mov_b32 v245, 0
    v_mov_b32 v246, 0
    v_mov_b32 v247, 0
    s_waitcnt vmcnt(4)
    v_lshlrev_b32 v6, 16, v16
    v_and_b32 v7, 0xffff0000, v16
    v_add_f32 v240, v240, v6
    v_add_f32 v241, v241, v7
    v_lshlrev_b32 v6, 16, v17
    v_and_b32 v7, 0xffff0000, v17
    v_add_f32 v242, v242, v6
    v_add_f32 v243, v243, v7
    v_lshlrev_b32 v6, 16, v18
    v_and_b32 v7, 0xffff0000, v18
    v_add_f32 v244, v244, v6
    v_add_f32 v245, v245, v7
    v_lshlrev_b32 v6, 16, v19
    v_and_b32 v7, 0xffff0000, v19
    v_add_f32 v246, v246, v6
    v_add_f32 v247, v247, v7
    s_waitcnt vmcnt(3)
    v_lshlrev_b32 v6, 16, v20
    v_and_b32 v7, 0xffff0000, v20
    v_add_f32 v240, v240, v6
    v_add_f32 v241, v241, v7
    v_lshlrev_b32 v6, 16, v21
    v_and_b32 v7, 0xffff0000, v21
    v_add_f32 v242, v242, v6
    v_add_f32 v243, v243, v7
    v_lshlrev_b32 v6, 16, v22
    v_and_b32 v7, 0xffff0000, v22
    v_add_f32 v244, v244, v6
    v_add_f32 v245, v245, v7
    v_lshlrev_b32 v6, 16, v23
    v_and_b32 v7, 0xffff0000, v23
    v_add_f32 v246, v246, v6
    v_add_f32 v247, v247, v7
    s_waitcnt vmcnt(2)
    v_lshlrev_b32 v6, 16, v24
    v_and_b32 v7, 0xffff0000, v24
    v_add_f32 v240, v240, v6
    v_add_f32 v241, v241, v7
    v_lshlrev_b32 v6, 16, v25
    v_and_b32 v7, 0xffff0000, v25
    v_add_f32 v242, v242, v6
    v_add_f32 v243, v243, v7
    v_lshlrev_b32 v6, 16, v26
    v_and_b32 v7, 0xffff0000, v26
    v_add_f32 v244, v244, v6
    v_add_f32 v245, v245, v7
    v_lshlrev_b32 v6, 16, v27
    v_and_b32 v7, 0xffff0000, v27
    v_add_f32 v246, v246, v6
    v_add_f32 v247, v247, v7
    s_waitcnt vmcnt(1)
    v_lshlrev_b32 v6, 16, v28
    v_and_b32 v7, 0xffff0000, v28
    v_add_f32 v240, v240, v6
    v_add_f32 v241, v241, v7
    v_lshlrev_b32 v6, 16, v29
    v_and_b32 v7, 0xffff0000, v29
    v_add_f32 v242, v242, v6
    v_add_f32 v243, v243, v7
    v_lshlrev_b32 v6, 16, v30
    v_and_b32 v7, 0xffff0000, v30
    v_add_f32 v244, v244, v6
    v_add_f32 v245, v245, v7
    v_lshlrev_b32 v6, 16, v31
    v_and_b32 v7, 0xffff0000, v31
    v_add_f32 v246, v246, v6
    v_add_f32 v247, v247, v7
    s_waitcnt vmcnt(0)
    v_lshlrev_b32 v6, 16, v32
    v_and_b32 v7, 0xffff0000, v32
    v_add_f32 v240, v240, v6
    v_add_f32 v241, v241, v7
    v_lshlrev_b32 v6, 16, v33
    v_and_b32 v7, 0xffff0000, v33
    v_add_f32 v242, v242, v6
    v_add_f32 v243, v243, v7
    v_lshlrev_b32 v6, 16, v34
    v_and_b32 v7, 0xffff0000, v34
    v_add_f32 v244, v244, v6
    v_add_f32 v245, v245, v7
    v_lshlrev_b32 v6, 16, v35
    v_and_b32 v7, 0xffff0000, v35
    v_add_f32 v246, v246, v6
    v_add_f32 v247, v247, v7
    v_mov_b32 v6, 0
    s_mov_b32 s3, 0
L_tag_14:
    buffer_load_dwordx2 v[8:9], v6, s[28:31], 0 offen offset:0 sc1
    s_add_u32 s3, s3, 1
    s_cmp_gt_u32 s3, 40000
    s_cbranch_scc1 L_end
    s_waitcnt vmcnt(0)
    v_readfirstlane_b32 s44, v8
    v_readfirstlane_b32 s45, v9
    s_nop 3
    s_cmp_eq_u32 s44, 0
    s_cbranch_scc1 L_tag_14
    v_lshlrev_b32 v4, 5, v0
    ds_write_b128 v4, v[240:243]
    ds_write_b128 v4, v[244:247] offset:16
    v_lshlrev_b32 v4, 2, v1
    s_lshl_b32 s60, s46, 11
    v_add_u32 v5, s60, v4
    s_waitcnt lgkmcnt(0)
    ds_read_b32 v16, v5 offset:0
    ds_read_b32 v17, v5 offset:256
    ds_read_b32 v18, v5 offset:512
    ds_read_b32 v19, v5 offset:768
    ds_read_b32 v20, v5 offset:1024
    ds_read_b32 v21, v5 offset:1280
    ds_read_b32 v22, v5 offset:1536
    ds_read_b32 v23, v5 offset:1792
    s_waitcnt lgkmcnt(0)
    v_add_f32 v16, v16, v20
    v_add_f32 v17, v17, v21
    v_add_f32 v18, v18, v22
    v_add_f32 v19, v19, v23
    v_add_f32 v16, v16, v18
    v_add_f32 v17, v17, v19
    v_add_f32 v16, v16, v17
    v_lshlrev_b32 v5, 2, v0
    ds_write_b32 v5, v16 offset:8192
    s_waitcnt lgkmcnt(0)
    s_barrier
    s_cmp_lg_u32 s46, 0
    s_cbranch_scc1 L_cs_a_done
    ds_read_b32 v16, v4 offset:8192
    ds_read_b32 v17, v4 offset:8448
    ds_read_b32 v18, v4 offset:8704
    ds_read_b32 v19, v4 offset:8960
    s_waitcnt lgkmcnt(0)
    v_add_f32 v16, v16, v17
    v_add_f32 v18, v18, v19
    v_add_f32 v16, v16, v18
    v_mov_b32 v17, s44
    v_lshlrev_b32 v4, 5, v1
    buffer_store_dwordx2 v[16:17], v4, s[24:27], s51 offen sc1
L_cs_a_done:
    s_barrier
    s_branch L_cs1_skip
L_cs1_none:
    s_cmp_eq_u32 s46, 0
    s_cbranch_scc1 L_pw_c0_0
    s_cmp_eq_u32 s46, 1
    s_cbranch_scc1 L_pw_c1_0
    s_cmp_eq_u32 s46, 2
    s_cbranch_scc1 L_pw_c2_0
    s_cmp_eq_u32 s46, 3
    s_cbranch_scc1 L_pw_c3_0
L_pw_c_ret:
L_cs1_skip:
    s_cmp_ge_u32 s47, 216
    s_cbranch_scc1 L_g2_skip
    s_mov_b32 s32, s4
    s_and_b32 s33, s5, 0xffff
    s_mov_b32 s34, 0x280000
    s_mov_b32 s35, 0x00020000
    s_cmp_ge_u32 s47, 128
    s_cbranch_scc1 L_g2_noln
    s_mov_b32 s32, s4
    s_and_b32 s33, s5, 0xffff
    s_mov_b32 s34, 0x280000
    s_mov_b32 s35, 0x00020000
    s_and_b32 s94, s47, 1
    s_lshl_b32 s94, s94, 6
    s_bfe_u32 s60, s47, 0x20001
    s_lshl_b32 s60, s60, 4
    s_add_u32 s94, s94, s60
    s_lshr_b32 s60, s47, 3
    s_add_u32 s94, s94, s60
    v_lshrrev_b32 v101, 4, v0
    v_and_b32 v102, 15, v0
    v_mul_u32_u24 v103, 1280, v101
    v_lshl_add_u32 v103, v102, 4, v103
    s_mul_i32 s60, s94, 20480
    buffer_load_dwordx4 v[116:119], v103, s[32:35], s60 offen offset:0
    buffer_load_dwordx4 v[120:123], v103, s[32:35], s60 offen offset:256
    buffer_load_dwordx4 v[124:127], v103, s[32:35], s60 offen offset:512
    buffer_load_dwordx4 v[128:131], v103, s[32:35], s60 offen offset:768
    buffer_load_dwordx4 v[132:135], v103, s[32:35], s60 offen offset:1024
    v_mov_b32 v107, 0
    buffer_load_dwordx2 v[182:183], v107, s[28:31], 0 offen sc1
    s_cmp_eq_u32 s46, 0
    s_cbranch_scc1 L_pw_a0_0
    s_cmp_eq_u32 s46, 1
    s_cbranch_scc1 L_pw_a1_0
    s_cmp_eq_u32 s46, 2
    s_cbranch_scc1 L_pw_a2_0
    s_cmp_eq_u32 s46, 3
    s_cbranch_scc1 L_pw_a3_0
L_pw_a_ret:
L_g2_noln:
    v_and_b32 v1, 63, v0
    s_mov_b32 s36, s12
    s_and_b32 s37, s13, 0xffff
    s_mov_b32 s38, 0x21c000
    s_mov_b32 s39, 0x00020000
    s_mov_b32 s40, s14
    s_and_b32 s41, s15, 0xffff
    s_mov_b32 s42, 0x21c000
    s_mov_b32 s43, 0x00020000
    s_bfe_u32 s60, s47, 0x20001
    s_mul_i32 s60, s60, 27
    s_lshr_b32 s61, s47, 3
    s_add_u32 s60, s60, s61
    s_lshr_b32 s49, s60, 2
    s_and_b32 s60, s60, 3
    s_and_b32 s61, s47, 1
    s_lshl_b32 s61, s61, 2
    s_add_u32 s59, s60, s61
    s_lshl_b32 s48, s59, 3
    s_lshl_b32 s61, s46, 1
    s_add_u32 s48, s48, s61
    s_mul_i32 s55, s48, 40960
    s_add_u32 s56, s55, 1280
    s_mul_i32 s57, s46, 27648
    s_lshl_b32 s61, s49, 7
    s_add_u32 s57, s57, s61
    s_add_u32 s58, s57, 2211840
    s_mul_i32 s60, s60, 5
    s_lshr_b32 s60, s60, 1
    s_mul_i32 s61, s49, 3
    s_add_u32 s60, s60, s61
    s_add_u32 s60, s60, 1
    s_mul_i32 s61, s60, 6554
    s_lshr_b32 s61, s61, 16
    s_mul_i32 s61, s61, 10
    s_sub_u32 s60, s60, s61
    s_lshl_b32 s61, s60, 7
    s_add_u32 s50, s55, s61
    s_mul_i32 s61, s60, 221184
    s_add_u32 s51, s57, s61
    s_lshl_b32 s53, s46, 10
    s_mul_i32 s52, s46, 12288
    s_add_u32 s52, s52, 32768
    v_lshrrev_b32 v12, 3, v1
    v_mul_u32_u24 v13, 1280, v12
    v_lshrrev_b32 v14, 4, v1
    v_xor_b32 v14, v14, v1
    v_and_b32 v14, 7, v14
    v_lshl_add_u32 v4, v14, 4, v13
    v_xor_b32 v5, 64, v4
    v_add_u32 v5, 10240, v5
    v_mul_u32_u24 v12, 3456, v12
    v_bfe_u32 v13, v1, 4, 1
    v_lshlrev_b32 v13, 1, v13
    s_and_b32 s61, s46, 1
    s_lshl_b32 s61, s61, 2
    v_or_b32 v13, s61, v13
    v_and_b32 v14, 7, v1
    v_xor_b32 v13, v13, v14
    v_lshl_add_u32 v2, v13, 4, v12
    v_and_b32 v12, 15, v1
    v_lshrrev_b32 v13, 1, v12
    v_lshrrev_b32 v14, 4, v1
    v_xor_b32 v13, v13, v14
    v_lshlrev_b32 v12, 7, v12
    v_lshl_add_u32 v12, v13, 4, v12
    v_add_u32 v6, s52, v12
    v_xor_b32 v7, 64, v6
    v_lshrrev_b32 v12, 4, v1
    v_bfe_u32 v13, v1, 2, 2
    v_lshl_add_u32 v14, v12, 3, v13
    v_lshlrev_b32 v14, 7, v14
    v_lshrrev_b32 v13, 1, v13
    v_and_b32 v12, 1, v12
    v_lshl_add_u32 v13, v12, 1, v13
    v_lshl_add_u32 v14, v13, 5, v14
    v_and_b32 v13, 3, v1
    v_lshl_add_u32 v8, v13, 3, v14
    v_xor_b32 v9, 32, v8
    v_xor_b32 v10, 64, v8
    v_xor_b32 v11, 96, v8
    s_cmp_ge_u32 s47, 128
    s_cbranch_scc1 L_g2_noln2
    v_mov_b32 v108, 0
    v_mov_b32 v109, 0
    v_mov_b32 v110, 0
    v_mov_b32 v111, 0
    s_waitcnt vmcnt(5)
    v_lshlrev_b32 v140, 16, v116
    v_and_b32 v141, 0xffff0000, v116
    v_add_f32 v108, v108, v140
    v_add_f32 v109, v109, v141
    v_lshlrev_b32 v142, 16, v117
    v_and_b32 v143, 0xffff0000, v117
    v_add_f32 v110, v110, v142
    v_add_f32 v111, v111, v143
    v_lshlrev_b32 v144, 16, v118
    v_and_b32 v145, 0xffff0000, v118
    v_add_f32 v108, v108, v144
    v_add_f32 v109, v109, v145
    v_lshlrev_b32 v146, 16, v119
    v_and_b32 v147, 0xffff0000, v119
    v_add_f32 v110, v110, v146
    v_add_f32 v111, v111, v147
    s_waitcnt vmcnt(4)
    v_lshlrev_b32 v148, 16, v120
    v_and_b32 v149, 0xffff0000, v120
    v_add_f32 v108, v108, v148
    v_add_f32 v109, v109, v149
    v_lshlrev_b32 v150, 16, v121
    v_and_b32 v151, 0xffff0000, v121
    v_add_f32 v110, v110, v150
    v_add_f32 v111, v111, v151
    v_lshlrev_b32 v152, 16, v122
    v_and_b32 v153, 0xffff0000, v122
    v_add_f32 v108, v108, v152
    v_add_f32 v109, v109, v153
    v_lshlrev_b32 v154, 16, v123
    v_and_b32 v155, 0xffff0000, v123
    v_add_f32 v110, v110, v154
    v_add_f32 v111, v111, v155
    s_waitcnt vmcnt(3)
    v_lshlrev_b32 v156, 16, v124
    v_and_b32 v157, 0xffff0000, v124
    v_add_f32 v108, v108, v156
    v_add_f32 v109, v109, v157
    v_lshlrev_b32 v158, 16, v125
    v_and_b32 v159, 0xffff0000, v125
    v_add_f32 v110, v110, v158
    v_add_f32 v111, v111, v159
    v_lshlrev_b32 v160, 16, v126
    v_and_b32 v161, 0xffff0000, v126
    v_add_f32 v108, v108, v160
    v_add_f32 v109, v109, v161
    v_lshlrev_b32 v162, 16, v127
    v_and_b32 v163, 0xffff0000, v127
    v_add_f32 v110, v110, v162
    v_add_f32 v111, v111, v163
    s_waitcnt vmcnt(2)
    v_lshlrev_b32 v164, 16, v128
    v_and_b32 v165, 0xffff0000, v128
    v_add_f32 v108, v108, v164
    v_add_f32 v109, v109, v165
    v_lshlrev_b32 v166, 16, v129
    v_and_b32 v167, 0xffff0000, v129
    v_add_f32 v110, v110, v166
    v_add_f32 v111, v111, v167
    v_lshlrev_b32 v168, 16, v130
    v_and_b32 v169, 0xffff0000, v130
    v_add_f32 v108, v108, v168
    v_add_f32 v109, v109, v169
    v_lshlrev_b32 v170, 16, v131
    v_and_b32 v171, 0xffff0000, v131
    v_add_f32 v110, v110, v170
    v_add_f32 v111, v111, v171
    s_waitcnt vmcnt(1)
    v_lshlrev_b32 v172, 16, v132
    v_and_b32 v173, 0xffff0000, v132
    v_add_f32 v108, v108, v172
    v_add_f32 v109, v109, v173
    v_lshlrev_b32 v174, 16, v133
    v_and_b32 v175, 0xffff0000, v133
    v_add_f32 v110, v110, v174
    v_add_f32 v111, v111, v175
    v_lshlrev_b32 v176, 16, v134
    v_and_b32 v177, 0xffff0000, v134
    v_add_f32 v108, v108, v176
    v_add_f32 v109, v109, v177
    v_lshlrev_b32 v178, 16, v135
    v_and_b32 v179, 0xffff0000, v135
    v_add_f32 v110, v110, v178
    v_add_f32 v111, v111, v179
    v_add_f32 v108, v108, v110
    v_add_f32 v109, v109, v111
    v_add_f32 v180, v108, v109
    s_nop 1
    v_add_f32_dpp v180, v180, v180 quad_perm:[1,0,3,2] row_mask:0xf bank_mask:0xf
    s_nop 1
    v_add_f32_dpp v180, v180, v180 quad_perm:[2,3,0,1] row_mask:0xf bank_mask:0xf
    s_nop 1
    v_add_f32_dpp v180, v180, v180 row_half_mirror row_mask:0xf bank_mask:0xf
    s_nop 1
    v_add_f32_dpp v180, v180, v180 row_mirror row_mask:0xf bank_mask:0xf
    v_mul_f32 v180, 0x3acccccd, v180
    v_sub_f32 v180, 0, v180
    v_mov_b32 v108, 0
    v_mov_b32 v109, 0
    v_mov_b32 v110, 0
    v_mov_b32 v111, 0
    v_add_f32 v184, v140, v180
    v_fmac_f32 v108, v184, v184
    v_add_f32 v185, v141, v180
    v_fmac_f32 v109, v185, v185
    v_add_f32 v186, v142, v180
    v_fmac_f32 v110, v186, v186
    v_add_f32 v187, v143, v180
    v_fmac_f32 v111, v187, v187
    v_add_f32 v184, v144, v180
    v_fmac_f32 v108, v184, v184
    v_add_f32 v185, v145, v180
    v_fmac_f32 v109, v185, v185
    v_add_f32 v186, v146, v180
    v_fmac_f32 v110, v186, v186
    v_add_f32 v187, v147, v180
    v_fmac_f32 v111, v187, v187
    v_add_f32 v184, v148, v180
    v_fmac_f32 v108, v184, v184
    v_add_f32 v185, v149, v180
    v_fmac_f32 v109, v185, v185
    v_add_f32 v186, v150, v180
    v_fmac_f32 v110, v186, v186
    v_add_f32 v187, v151, v180
    v_fmac_f32 v111, v187, v187
    v_add_f32 v184, v152, v180
    v_fmac_f32 v108, v184, v184
    v_add_f32 v185, v153, v180
    v_fmac_f32 v109, v185, v185
    v_add_f32 v186, v154, v180
    v_fmac_f32 v110, v186, v186
    v_add_f32 v187, v155, v180
    v_fmac_f32 v111, v187, v187
    v_add_f32 v184, v156, v180
    v_fmac_f32 v108, v184, v184
    v_add_f32 v185, v157, v180
    v_fmac_f32 v109, v185, v185
    v_add_f32 v186, v158, v180
    v_fmac_f32 v110, v186, v186
    v_add_f32 v187, v159, v180
    v_fmac_f32 v111, v187, v187
    v_add_f32 v184, v160, v180
    v_fmac_f32 v108, v184, v184
    v_add_f32 v185, v161, v180
    v_fmac_f32 v109, v185, v185
    v_add_f32 v186, v162, v180
    v_fmac_f32 v110, v186, v186
    v_add_f32 v187, v163, v180
    v_fmac_f32 v111, v187, v187
    v_add_f32 v184, v164, v180
    v_fmac_f32 v108, v184, v184
    v_add_f32 v185, v165, v180
    v_fmac_f32 v109, v185, v185
    v_add_f32 v186, v166, v180
    v_fmac_f32 v110, v186, v186
    v_add_f32 v187, v167, v180
    v_fmac_f32 v111, v187, v187
    v_add_f32 v184, v168, v180
    v_fmac_f32 v108, v184, v184
    v_add_f32 v185, v169, v180
    v_fmac_f32 v109, v185, v185
    v_add_f32 v186, v170, v180
    v_fmac_f32 v110, v186, v186
    v_add_f32 v187, v171, v180
    v_fmac_f32 v111, v187, v187
    v_add_f32 v184, v172, v180
    v_fmac_f32 v108, v184, v184
    v_add_f32 v185, v173, v180
    v_fmac_f32 v109, v185, v185
    v_add_f32 v186, v174, v180
    v_fmac_f32 v110, v186, v186
    v_add_f32 v187, v175, v180
    v_fmac_f32 v111, v187, v187
    v_add_f32 v184, v176, v180
    v_fmac_f32 v108, v184, v184
    v_add_f32 v185, v177, v180
    v_fmac_f32 v109, v185, v185
    v_add_f32 v186, v178, v180
    v_fmac_f32 v110, v186, v186
    v_add_f32 v187, v179, v180
    v_fmac_f32 v111, v187, v187
    v_add_f32 v108, v108, v110
    v_add_f32 v109, v109, v111
    v_add_f32 v181, v108, v109
    s_nop 1
    v_add_f32_dpp v181, v181, v181 quad_perm:[1,0,3,2] row_mask:0xf bank_mask:0xf
    s_nop 1
    v_add_f32_dpp v181, v181, v181 quad_perm:[2,3,0,1] row_mask:0xf bank_mask:0xf
    s_nop 1
    v_add_f32_dpp v181, v181, v181 row_half_mirror row_mask:0xf bank_mask:0xf
    s_nop 1
    v_add_f32_dpp v181, v181, v181 row_mirror row_mask:0xf bank_mask:0xf
    v_mul_f32 v181, 0x3acccccd, v181
    v_cvt_pk_bf16_f32 v180, v180, v180
    v_and_b32 v180, 0xffff0000, v180
    v_cvt_pk_bf16_f32 v181, v181, v181
    v_and_b32 v181, 0xffff0000, v181
    v_add_f32 v181, 0x3727c5ac, v181
    v_cvt_pk_bf16_f32 v181, v181, v181
    v_and_b32 v181, 0xffff0000, v181
    v_sqrt_f32 v181, v181
    s_nop 0
    v_cvt_pk_bf16_f32 v181, v181, v181
    v_and_b32 v181, 0xffff0000, v181
    v_rcp_f32 v181, v181
    s_waitcnt vmcnt(0)
    v_readfirstlane_b32 s44, v182
    v_readfirstlane_b32 s45, v183
    s_nop 3
    s_cmp_lg_u32 s44, 0
    s_cbranch_scc1 L_ln_tag
    v_mov_b32 v107, 0
    s_mov_b32 s3, 0
L_tag_15:
    buffer_load_dwordx2 v[182:183], v107, s[28:31], 0 offen offset:0 sc1
    s_add_u32 s3, s3, 1
    s_cmp_gt_u32 s3, 40000
    s_cbranch_scc1 L_end
    s_waitcnt vmcnt(0)
    v_readfirstlane_b32 s44, v182
    v_readfirstlane_b32 s45, v183
    s_nop 3
    s_cmp_eq_u32 s44, 0
    s_cbranch_scc1 L_tag_15
L_ln_tag:
    v_lshlrev_b32 v105, 4, v101
    s_lshl_b32 s60, s94, 8
    s_add_u32 s60, s60, 0x1c00000
    v_cmp_eq_u32 vcc, 0, v102
    s_and_saveexec_b64 s[62:63], vcc
    buffer_store_dwordx4 v[180:183], v105, s[24:27], s60 offen sc1
    s_mov_b64 exec, s[62:63]
L_g2_noln2:
    s_setprio 0
    s_cmp_lg_u32 s46, 1
    s_cbranch_scc1 L_tt_16
    v_mul_u32_u24 v12, 589824, v1
    buffer_load_dword v13, v12, s[24:27], 0 offen sc1
    s_mov_b32 s88, s18
    s_and_b32 s89, s19, 0xffff
    s_mov_b32 s90, 0x280000
    s_mov_b32 s91, 0x00020000
    v_mul_u32_u24 v12, 40960, v1
    buffer_load_dword v13, v12, s[88:91], 0 offen sc1
    s_waitcnt vmcnt(0)
L_tt_16:
    v_mov_b32 v120, 0
    v_mov_b32 v121, 0
    v_mov_b32 v122, 0
    v_mov_b32 v123, 0
    v_mov_b32 v124, 0
    v_mov_b32 v125, 0
    v_mov_b32 v126, 0
    v_mov_b32 v127, 0
    v_mov_b32 v128, 0
    v_mov_b32 v129, 0
    v_mov_b32 v130, 0
    v_mov_b32 v131, 0
    v_mov_b32 v132, 0
    v_mov_b32 v133, 0
    v_mov_b32 v134, 0
    v_mov_b32 v135, 0
    v_mov_b32 v136, 0
    v_mov_b32 v137, 0
    v_mov_b32 v138, 0
    v_mov_b32 v139, 0
    v_mov_b32 v140, 0
    v_mov_b32 v141, 0
    v_mov_b32 v142, 0
    v_mov_b32 v143, 0
    v_mov_b32 v144, 0
    v_mov_b32 v145, 0
    v_mov_b32 v146, 0
    v_mov_b32 v147, 0
    v_mov_b32 v148, 0
    v_mov_b32 v149, 0
    v_mov_b32 v150, 0
    v_mov_b32 v151, 0
    v_mov_b32 v152, 0
    v_mov_b32 v153, 0
    v_mov_b32 v154, 0
    v_mov_b32 v155, 0
    v_mov_b32 v156, 0
    v_mov_b32 v157, 0
    v_mov_b32 v158, 0
    v_mov_b32 v159, 0
    v_mov_b32 v160, 0
    v_mov_b32 v161, 0
    v_mov_b32 v162, 0
    v_mov_b32 v163, 0
    v_mov_b32 v164, 0
    v_mov_b32 v165, 0
    v_mov_b32 v166, 0
    v_mov_b32 v167, 0
    v_mov_b32 v168, 0
    v_mov_b32 v169, 0
    v_mov_b32 v170, 0
    v_mov_b32 v171, 0
    v_mov_b32 v172, 0
    v_mov_b32 v173, 0
    v_mov_b32 v174, 0
    v_mov_b32 v175, 0
    v_mov_b32 v176, 0
    v_mov_b32 v177, 0
    v_mov_b32 v178, 0
    v_mov_b32 v179, 0
    v_mov_b32 v180, 0
    v_mov_b32 v181, 0
    v_mov_b32 v182, 0
    v_mov_b32 v183, 0
    v_mov_b32 v184, 0
    v_mov_b32 v185, 0
    v_mov_b32 v186, 0
    v_mov_b32 v187, 0
    v_mov_b32 v188, 0
    v_mov_b32 v189, 0
    v_mov_b32 v190, 0
    v_mov_b32 v191, 0
    v_mov_b32 v192, 0
    v_mov_b32 v193, 0
    v_mov_b32 v194, 0
    v_mov_b32 v195, 0
    v_mov_b32 v196, 0
    v_mov_b32 v197, 0
    v_mov_b32 v198, 0
    v_mov_b32 v199, 0
    v_mov_b32 v200, 0
    v_mov_b32 v201, 0
    v_mov_b32 v202, 0
    v_mov_b32 v203, 0
    v_mov_b32 v204, 0
    v_mov_b32 v205, 0
    v_mov_b32 v206, 0
    v_mov_b32 v207, 0
    v_mov_b32 v208, 0
    v_mov_b32 v209, 0
    v_mov_b32 v210, 0
    v_mov_b32 v211, 0
    v_mov_b32 v212, 0
    v_mov_b32 v213, 0
    v_mov_b32 v214, 0
    v_mov_b32 v215, 0
    v_mov_b32 v216, 0
    v_mov_b32 v217, 0
    v_mov_b32 v218, 0
    v_mov_b32 v219, 0
    v_mov_b32 v220, 0
    v_mov_b32 v221, 0
    v_mov_b32 v222, 0
    v_mov_b32 v223, 0
    v_mov_b32 v224, 0
    v_mov_b32 v225, 0
    v_mov_b32 v226, 0
    v_mov_b32 v227, 0
    v_mov_b32 v228, 0
    v_mov_b32 v229, 0
    v_mov_b32 v230, 0
    v_mov_b32 v231, 0
    v_mov_b32 v232, 0
    v_mov_b32 v233, 0
    v_mov_b32 v234, 0
    v_mov_b32 v235, 0
    v_mov_b32 v236, 0
    v_mov_b32 v237, 0
    v_mov_b32 v238, 0
    v_mov_b32 v239, 0
    v_mov_b32 v240, 0
    v_mov_b32 v241, 0
    v_mov_b32 v242, 0
    v_mov_b32 v243, 0
    v_mov_b32 v244, 0
    v_mov_b32 v245, 0
    v_mov_b32 v246, 0
    v_mov_b32 v247, 0
    s_cmp_ge_u32 s47, 240
    s_cbranch_scc1 L_hint_18
    s_cmp_lg_u32 s46, 0
    s_cbranch_scc1 L_hint_18
    s_lshl_b32 s60, s47, 7
    s_add_u32 s60, s60, 0x1d04000
    v_mov_b32 v16, 0
    s_mov_b32 s3, 0
L_hint_17:
    s_sleep 4
    buffer_load_dword v17, v16, s[24:27], s60 offen sc1
    s_add_u32 s3, s3, 1
    s_cmp_gt_u32 s3, 60
    s_cbranch_scc1 L_hint_18
    s_waitcnt vmcnt(0)
    v_readfirstlane_b32 s61, v17
    s_nop 3
    s_sub_u32 s61, s61, s95
    s_cmp_gt_u32 s61, 1000
    s_cbranch_scc1 L_hint_17
L_hint_18:
    s_waitcnt vmcnt(0)
    s_barrier
    s_add_u32 s61, s50, 0
    s_add_u32 m0, s52, 0
    s_nop 0
    buffer_load_dwordx4 v4, s[32:35], s61 offen lds
    s_add_u32 m0, s52, 1024
    s_nop 0
    buffer_load_dwordx4 v5, s[32:35], s61 offen lds
    s_add_u32 s61, s50, 20480
    s_add_u32 m0, s52, 2048
    s_nop 0
    buffer_load_dwordx4 v4, s[32:35], s61 offen lds
    s_add_u32 m0, s52, 3072
    s_nop 0
    buffer_load_dwordx4 v5, s[32:35], s61 offen lds
    s_add_u32 s61, s50, 40960
    s_add_u32 m0, s52, 4096
    s_nop 0
    buffer_load_dwordx4 v4, s[32:35], s61 offen lds
    s_add_u32 m0, s52, 5120
    s_nop 0
    buffer_load_dwordx4 v5, s[32:35], s61 offen lds
    s_add_u32 s61, s50, 61440
    s_add_u32 m0, s52, 6144
    s_nop 0
    buffer_load_dwordx4 v4, s[32:35], s61 offen lds
    s_add_u32 m0, s52, 7168
    s_nop 0
    buffer_load_dwordx4 v5, s[32:35], s61 offen lds
    s_add_u32 s50, s50, 128
    s_cmp_eq_u32 s50, s56
    s_cselect_b32 s50, s55, s50
    s_add_u32 m0, s53, 0
    s_nop 0
    buffer_load_dwordx4 v2, s[36:39], s51 offen lds
    s_add_u32 m0, s53, 4096
    s_nop 0
    buffer_load_dwordx4 v2, s[40:43], s51 offen lds
    s_add_u32 s51, s51, 110592
    s_cmp_eq_u32 s51, s58
    s_cselect_b32 s51, s57, s51
    s_add_u32 s61, s50, 0
    s_add_u32 m0, s52, 8192
    s_nop 0
    buffer_load_dwordx4 v4, s[32:35], s61 offen lds
    s_add_u32 m0, s52, 9216
    s_nop 0
    buffer_load_dwordx4 v5, s[32:35], s61 offen lds
    s_add_u32 s61, s50, 20480
    s_add_u32 m0, s52, 10240
    s_nop 0
    buffer_load_dwordx4 v4, s[32:35], s61 offen lds
    s_add_u32 m0, s52, 11264
    s_nop 0
    buffer_load_dwordx4 v5, s[32:35], s61 offen lds
    s_add_u32 m0, s53, 8192
    s_nop 0
    buffer_load_dwordx4 v2, s[36:39], s51 offen lds
    s_add_u32 m0, s53, 12288
    s_nop 0
    buffer_load_dwordx4 v2, s[40:43], s51 offen lds
    s_add_u32 s51, s51, 110592
    s_cmp_eq_u32 s51, s58
    s_cselect_b32 s51, s57, s51
    s_add_u32 m0, s53, 16384
    s_nop 0
    buffer_load_dwordx4 v2, s[36:39], s51 offen lds
    s_add_u32 m0, s53, 20480
    s_nop 0
    buffer_load_dwordx4 v2, s[40:43], s51 offen lds
    s_add_u32 s51, s51, 110592
    s_cmp_eq_u32 s51, s58
    s_cselect_b32 s51, s57, s51
    s_add_u32 m0, s53, 24576
    s_nop 0
    buffer_load_dwordx4 v2, s[36:39], s51 offen lds
    s_add_u32 m0, s53, 28672
    s_nop 0
    buffer_load_dwordx4 v2, s[40:43], s51 offen lds
    s_add_u32 s51, s51, 110592
    s_cmp_eq_u32 s51, s58
    s_cselect_b32 s51, s57, s51
    s_setprio 0
    s_waitcnt vmcnt(10)
    s_barrier
    ds_read_b128 v[24:27], v6 offset:0
    ds_read_b128 v[28:31], v7 offset:0
    ds_read_b128 v[32:35], v6 offset:2048
    ds_read_b128 v[36:39], v7 offset:2048
    ds_read_b128 v[40:43], v6 offset:4096
    ds_read_b128 v[44:47], v7 offset:4096
    ds_read_b128 v[48:51], v6 offset:6144
    ds_read_b128 v[52:55], v7 offset:6144
    ds_read_b64_tr_b16 v[88:89], v8 offset:0
    ds_read_b64_tr_b16 v[90:91], v8 offset:512
    ds_read_b64_tr_b16 v[92:93], v9 offset:0
    ds_read_b64_tr_b16 v[94:95], v9 offset:512
    ds_read_b64_tr_b16 v[96:97], v10 offset:0
    ds_read_b64_tr_b16 v[98:99], v10 offset:512
    ds_read_b64_tr_b16 v[100:101], v11 offset:0
    ds_read_b64_tr_b16 v[102:103], v11 offset:512
    s_waitcnt lgkmcnt(8)
    s_add_u32 s61, s50, 40960
    s_add_u32 m0, s52, 0
    s_nop 0
    buffer_load_dwordx4 v4, s[32:35], s61 offen lds
    s_add_u32 m0, s52, 1024
    s_nop 0
    buffer_load_dwordx4 v5, s[32:35], s61 offen lds
    s_add_u32 s61, s50, 61440
    s_add_u32 m0, s52, 2048
    s_nop 0
    buffer_load_dwordx4 v4, s[32:35], s61 offen lds
    s_add_u32 m0, s52, 3072
    s_nop 0
    buffer_load_dwordx4 v5, s[32:35], s61 offen lds
    s_add_u32 s50, s50, 128
    s_cmp_eq_u32 s50, s56
    s_cselect_b32 s50, s55, s50
    v_mov_b32 v15, 0
    v_lshlrev_b32 v13, 4, v1
    v_mov_b32 v14, 0x7ffffff0
    v_cmp_gt_u32 vcc, 16, v1
    s_nop 1
    v_cndmask_b32 v14, v14, v13, vcc
    s_lshl_b32 s62, s48, 9
    s_add_u32 s62, s62, 0x1c00000
    s_lshl_b32 s63, s49, 11
    s_add_u32 s63, s63, 0x1c20000
    s_waitcnt lgkmcnt(0)
    v_mfma_f32_16x16x32_bf16 v[120:123], v[88:91], v[24:27], v[120:123]
    ds_read_b64_tr_b16 v[104:105], v8 offset:4096
    v_mfma_f32_16x16x32_bf16 v[152:155], v[88:91], v[32:35], v[152:155]
    ds_read_b64_tr_b16 v[106:107], v8 offset:4608
    v_mfma_f32_16x16x32_bf16 v[124:127], v[92:95], v[24:27], v[124:127]
    ds_read_b64_tr_b16 v[108:109], v9 offset:4096
    v_mfma_f32_16x16x32_bf16 v[156:159], v[92:95], v[32:35], v[156:159]
    ds_read_b64_tr_b16 v[110:111], v9 offset:4608
    v_mfma_f32_16x16x32_bf16 v[128:131], v[96:99], v[24:27], v[128:131]
    ds_read_b64_tr_b16 v[112:113], v10 offset:4096
    v_mfma_f32_16x16x32_bf16 v[160:163], v[96:99], v[32:35], v[160:163]
    ds_read_b64_tr_b16 v[114:115], v10 offset:4608
    v_mfma_f32_16x16x32_bf16 v[132:135], v[100:103], v[24:27], v[132:135]
    ds_read_b64_tr_b16 v[116:117], v11 offset:4096
    v_mfma_f32_16x16x32_bf16 v[164:167], v[100:103], v[32:35], v[164:167]
    ds_read_b64_tr_b16 v[118:119], v11 offset:4608
    v_mfma_f32_16x16x32_bf16 v[184:187], v[88:91], v[40:43], v[184:187]
    v_mfma_f32_16x16x32_bf16 v[216:219], v[88:91], v[48:51], v[216:219]
    s_add_u32 s61, s50, 0
    s_add_u32 m0, s52, 4096
    s_nop 0
    buffer_load_dwordx4 v4, s[32:35], s61 offen lds
    v_mfma_f32_16x16x32_bf16 v[188:191], v[92:95], v[40:43], v[188:191]
    v_mfma_f32_16x16x32_bf16 v[220:223], v[92:95], v[48:51], v[220:223]
    s_add_u32 m0, s52, 5120
    s_nop 0
    buffer_load_dwordx4 v5, s[32:35], s61 offen lds
    v_mfma_f32_16x16x32_bf16 v[192:195], v[96:99], v[40:43], v[192:195]
    v_mfma_f32_16x16x32_bf16 v[224:227], v[96:99], v[48:51], v[224:227]
    s_add_u32 s61, s50, 20480
    s_add_u32 m0, s52, 6144
    s_nop 0
    buffer_load_dwordx4 v4, s[32:35], s61 offen lds
    v_mfma_f32_16x16x32_bf16 v[196:199], v[100:103], v[40:43], v[196:199]
    v_mfma_f32_16x16x32_bf16 v[228:231], v[100:103], v[48:51], v[228:231]
    s_add_u32 m0, s52, 7168
    s_nop 0
    buffer_load_dwordx4 v5, s[32:35], s61 offen lds
    s_waitcnt vmcnt(12) lgkmcnt(0)
    s_barrier
    v_mfma_f32_16x16x32_bf16 v[136:139], v[104:107], v[24:27], v[136:139]
    ds_read_b64_tr_b16 v[88:89], v8 offset:8192
    s_branch L_ps_2_1
L_pw_a2_1:
    s_branch L_pw_a2_2
L_pw_b2_1:
    s_branch L_pw_b2_2
L_pw_c2_1:
    s_branch L_pw_c2_2
L_ps_2_1:
    v_mfma_f32_16x16x32_bf16 v[168:171], v[104:107], v[32:35], v[168:171]
    ds_read_b64_tr_b16 v[90:91], v8 offset:8704
    v_mfma_f32_16x16x32_bf16 v[200:203], v[104:107], v[40:43], v[200:203]
    ds_read_b64_tr_b16 v[92:93], v9 offset:8192
    v_mfma_f32_16x16x32_bf16 v[232:235], v[104:107], v[48:51], v[232:235]
    ds_read_b64_tr_b16 v[94:95], v9 offset:8704
    v_mfma_f32_16x16x32_bf16 v[140:143], v[108:111], v[24:27], v[140:143]
    ds_read_b64_tr_b16 v[96:97], v10 offset:8192
    v_mfma_f32_16x16x32_bf16 v[172:175], v[108:111], v[32:35], v[172:175]
    ds_read_b64_tr_b16 v[98:99], v10 offset:8704
    v_mfma_f32_16x16x32_bf16 v[204:207], v[108:111], v[40:43], v[204:207]
    ds_read_b64_tr_b16 v[100:101], v11 offset:8192
    v_mfma_f32_16x16x32_bf16 v[236:239], v[108:111], v[48:51], v[236:239]
    ds_read_b64_tr_b16 v[102:103], v11 offset:8704
    v_mfma_f32_16x16x32_bf16 v[144:147], v[112:115], v[24:27], v[144:147]
    ds_read_b128 v[56:59], v6 offset:8192
    v_mfma_f32_16x16x32_bf16 v[176:179], v[112:115], v[32:35], v[176:179]
    ds_read_b128 v[60:63], v7 offset:8192
    v_mfma_f32_16x16x32_bf16 v[208:211], v[112:115], v[40:43], v[208:211]
    ds_read_b128 v[64:67], v6 offset:10240
    v_mfma_f32_16x16x32_bf16 v[240:243], v[112:115], v[48:51], v[240:243]
    ds_read_b128 v[68:71], v7 offset:10240
    v_mfma_f32_16x16x32_bf16 v[148:151], v[116:119], v[24:27], v[148:151]
    v_mfma_f32_16x16x32_bf16 v[180:183], v[116:119], v[32:35], v[180:183]
    s_add_u32 m0, s53, 0
    s_nop 0
    buffer_load_dwordx4 v2, s[36:39], s51 offen lds
    v_mfma_f32_16x16x32_bf16 v[212:215], v[116:119], v[40:43], v[212:215]
    v_mfma_f32_16x16x32_bf16 v[244:247], v[116:119], v[48:51], v[244:247]
    s_add_u32 m0, s53, 4096
    s_nop 0
    buffer_load_dwordx4 v2, s[40:43], s51 offen lds
    s_add_u32 s51, s51, 110592
    s_cmp_eq_u32 s51, s58
    s_cselect_b32 s51, s57, s51
    s_waitcnt lgkmcnt(4)
    v_mfma_f32_16x16x32_bf16 v[120:123], v[88:91], v[28:31], v[120:123]
    ds_read_b64_tr_b16 v[104:105], v8 offset:12288
    v_mfma_f32_16x16x32_bf16 v[152:155], v[88:91], v[36:39], v[152:155]
    ds_read_b64_tr_b16 v[106:107], v8 offset:12800
    v_mfma_f32_16x16x32_bf16 v[124:127], v[92:95], v[28:31], v[124:127]
    ds_read_b64_tr_b16 v[108:109], v9 offset:12288
    v_mfma_f32_16x16x32_bf16 v[156:159], v[92:95], v[36:39], v[156:159]
    ds_read_b64_tr_b16 v[110:111], v9 offset:12800
    v_mfma_f32_16x16x32_bf16 v[128:131], v[96:99], v[28:31], v[128:131]
    ds_read_b64_tr_b16 v[112:113], v10 offset:12288
    v_mfma_f32_16x16x32_bf16 v[160:163], v[96:99], v[36:39], v[160:163]
    ds_read_b64_tr_b16 v[114:115], v10 offset:12800
    v_mfma_f32_16x16x32_bf16 v[132:135], v[100:103], v[28:31], v[132:135]
    ds_read_b64_tr_b16 v[116:117], v11 offset:12288
    v_mfma_f32_16x16x32_bf16 v[164:167], v[100:103], v[36:39], v[164:167]
    ds_read_b64_tr_b16 v[118:119], v11 offset:12800
    s_waitcnt lgkmcnt(8)
    v_mfma_f32_16x16x32_bf16 v[184:187], v[88:91], v[44:47], v[184:187]
    v_mfma_f32_16x16x32_bf16 v[216:219], v[88:91], v[52:55], v[216:219]
    s_add_u32 s61, s50, 40960
    s_add_u32 m0, s52, 8192
    s_nop 0
    buffer_load_dwordx4 v4, s[32:35], s61 offen lds
    v_mfma_f32_16x16x32_bf16 v[188:191], v[92:95], v[44:47], v[188:191]
    v_mfma_f32_16x16x32_bf16 v[220:223], v[92:95], v[52:55], v[220:223]
    s_add_u32 m0, s52, 9216
    s_nop 0
    buffer_load_dwordx4 v5, s[32:35], s61 offen lds
    v_mfma_f32_16x16x32_bf16 v[192:195], v[96:99], v[44:47], v[192:195]
    v_mfma_f32_16x16x32_bf16 v[224:227], v[96:99], v[52:55], v[224:227]
    s_add_u32 s61, s50, 61440
    s_add_u32 m0, s52, 10240
    s_nop 0
    buffer_load_dwordx4 v4, s[32:35], s61 offen lds
    v_mfma_f32_16x16x32_bf16 v[196:199], v[100:103], v[44:47], v[196:199]
    v_mfma_f32_16x16x32_bf16 v[228:231], v[100:103], v[52:55], v[228:231]
    s_add_u32 m0, s52, 11264
    s_nop 0
    buffer_load_dwordx4 v5, s[32:35], s61 offen lds
    s_add_u32 s50, s50, 128
    s_cmp_eq_u32 s50, s56
    s_cselect_b32 s50, s55, s50
    s_waitcnt vmcnt(10) lgkmcnt(0)
    s_barrier
    v_mfma_f32_16x16x32_bf16 v[136:139], v[104:107], v[28:31], v[136:139]
    ds_read_b64_tr_b16 v[88:89], v8 offset:16384
    v_mfma_f32_16x16x32_bf16 v[168:171], v[104:107], v[36:39], v[168:171]
    ds_read_b64_tr_b16 v[90:91], v8 offset:16896
    v_mfma_f32_16x16x32_bf16 v[200:203], v[104:107], v[44:47], v[200:203]
    ds_read_b64_tr_b16 v[92:93], v9 offset:16384
    v_mfma_f32_16x16x32_bf16 v[232:235], v[104:107], v[52:55], v[232:235]
    ds_read_b64_tr_b16 v[94:95], v9 offset:16896
    v_mfma_f32_16x16x32_bf16 v[140:143], v[108:111], v[28:31], v[140:143]
    ds_read_b64_tr_b16 v[96:97], v10 offset:16384
    v_mfma_f32_16x16x32_bf16 v[172:175], v[108:111], v[36:39], v[172:175]
    ds_read_b64_tr_b16 v[98:99], v10 offset:16896
    v_mfma_f32_16x16x32_bf16 v[204:207], v[108:111], v[44:47], v[204:207]
    ds_read_b64_tr_b16 v[100:101], v11 offset:16384
    v_mfma_f32_16x16x32_bf16 v[236:239], v[108:111], v[52:55], v[236:239]
    ds_read_b64_tr_b16 v[102:103], v11 offset:16896
    v_mfma_f32_16x16x32_bf16 v[144:147], v[112:115], v[28:31], v[144:147]
    ds_read_b128 v[72:75], v6 offset:0
    v_mfma_f32_16x16x32_bf16 v[176:179], v[112:115], v[36:39], v[176:179]
    ds_read_b128 v[76:79], v7 offset:0
    v_mfma_f32_16x16x32_bf16 v[208:211], v[112:115], v[44:47], v[208:211]
    ds_read_b128 v[80:83], v6 offset:2048
    v_mfma_f32_16x16x32_bf16 v[240:243], v[112:115], v[52:55], v[240:243]
    ds_read_b128 v[84:87], v7 offset:2048
    v_mfma_f32_16x16x32_bf16 v[148:151], v[116:119], v[28:31], v[148:151]
    v_mfma_f32_16x16x32_bf16 v[180:183], v[116:119], v[36:39], v[180:183]
    s_add_u32 m0, s53, 8192
    s_nop 0
    buffer_load_dwordx4 v2, s[36:39], s51 offen lds
    v_mfma_f32_16x16x32_bf16 v[212:215], v[116:119], v[44:47], v[212:215]
    v_mfma_f32_16x16x32_bf16 v[244:247], v[116:119], v[52:55], v[244:247]
    s_add_u32 m0, s53, 12288
    s_nop 0
    buffer_load_dwordx4 v2, s[40:43], s51 offen lds
    s_add_u32 s51, s51, 110592
    s_cmp_eq_u32 s51, s58
    s_cselect_b32 s51, s57, s51
    s_waitcnt lgkmcnt(4)
    v_mfma_f32_16x16x32_bf16 v[120:123], v[88:91], v[56:59], v[120:123]
    ds_read_b64_tr_b16 v[104:105], v8 offset:20480
    v_mfma_f32_16x16x32_bf16 v[152:155], v[88:91], v[64:67], v[152:155]
    ds_read_b64_tr_b16 v[106:107], v8 offset:20992
    v_mfma_f32_16x16x32_bf16 v[124:127], v[92:95], v[56:59], v[124:127]
    ds_read_b64_tr_b16 v[108:109], v9 offset:20480
    v_mfma_f32_16x16x32_bf16 v[156:159], v[92:95], v[64:67], v[156:159]
    ds_read_b64_tr_b16 v[110:111], v9 offset:20992
    v_mfma_f32_16x16x32_bf16 v[128:131], v[96:99], v[56:59], v[128:131]
    ds_read_b64_tr_b16 v[112:113], v10 offset:20480
    v_mfma_f32_16x16x32_bf16 v[160:163], v[96:99], v[64:67], v[160:163]
    ds_read_b64_tr_b16 v[114:115], v10 offset:20992
    v_mfma_f32_16x16x32_bf16 v[132:135], v[100:103], v[56:59], v[132:135]
    ds_read_b64_tr_b16 v[116:117], v11 offset:20480
    v_mfma_f32_16x16x32_bf16 v[164:167], v[100:103], v[64:67], v[164:167]
    ds_read_b64_tr_b16 v[118:119], v11 offset:20992
    s_waitcnt lgkmcnt(8)
    v_mfma_f32_16x16x32_bf16 v[184:187], v[88:91], v[72:75], v[184:187]
    v_mfma_f32_16x16x32_bf16 v[216:219], v[88:91], v[80:83], v[216:219]
    s_add_u32 s61, s50, 0
    s_add_u32 m0, s52, 0
    s_nop 0
    buffer_load_dwordx4 v4, s[32:35], s61 offen lds
    v_mfma_f32_16x16x32_bf16 v[188:191], v[92:95], v[72:75], v[188:191]
    v_mfma_f32_16x16x32_bf16 v[220:223], v[92:95], v[80:83], v[220:223]
    s_add_u32 m0, s52, 1024
    s_nop 0
    buffer_load_dwordx4 v5, s[32:35], s61 offen lds
    v_mfma_f32_16x16x32_bf16 v[192:195], v[96:99], v[72:75], v[192:195]
    v_mfma_f32_16x16x32_bf16 v[224:227], v[96:99], v[80:83], v[224:227]
    s_add_u32 s61, s50, 20480
    s_add_u32 m0, s52, 2048
    s_nop 0
    buffer_load_dwordx4 v4, s[32:35], s61 offen lds
    v_mfma_f32_16x16x32_bf16 v[196:199], v[100:103], v[72:75], v[196:199]
    v_mfma_f32_16x16x32_bf16 v[228:231], v[100:103], v[80:83], v[228:231]
    s_add_u32 m0, s52, 3072
    s_nop 0
    buffer_load_dwordx4 v5, s[32:35], s61 offen lds
    s_waitcnt vmcnt(12) lgkmcnt(0)
    s_barrier
    v_mfma_f32_16x16x32_bf16 v[136:139], v[104:107], v[56:59], v[136:139]
    ds_read_b64_tr_b16 v[88:89], v8 offset:24576
    v_mfma_f32_16x16x32_bf16 v[168:171], v[104:107], v[64:67], v[168:171]
    ds_read_b64_tr_b16 v[90:91], v8 offset:25088
    v_mfma_f32_16x16x32_bf16 v[200:203], v[104:107], v[72:75], v[200:203]
    ds_read_b64_tr_b16 v[92:93], v9 offset:24576
    v_mfma_f32_16x16x32_bf16 v[232:235], v[104:107], v[80:83], v[232:235]
    ds_read_b64_tr_b16 v[94:95], v9 offset:25088
    v_mfma_f32_16x16x32_bf16 v[140:143], v[108:111], v[56:59], v[140:143]
    ds_read_b64_tr_b16 v[96:97], v10 offset:24576
    v_mfma_f32_16x16x32_bf16 v[172:175], v[108:111], v[64:67], v[172:175]
    ds_read_b64_tr_b16 v[98:99], v10 offset:25088
    v_mfma_f32_16x16x32_bf16 v[204:207], v[108:111], v[72:75], v[204:207]
    ds_read_b64_tr_b16 v[100:101], v11 offset:24576
    v_mfma_f32_16x16x32_bf16 v[236:239], v[108:111], v[80:83], v[236:239]
    ds_read_b64_tr_b16 v[102:103], v11 offset:25088
    v_mfma_f32_16x16x32_bf16 v[144:147], v[112:115], v[56:59], v[144:147]
    ds_read_b128 v[24:27], v6 offset:4096
    v_mfma_f32_16x16x32_bf16 v[176:179], v[112:115], v[64:67], v[176:179]
    ds_read_b128 v[28:31], v7 offset:4096
    v_mfma_f32_16x16x32_bf16 v[208:211], v[112:115], v[72:75], v[208:211]
    ds_read_b128 v[32:35], v6 offset:6144
    v_mfma_f32_16x16x32_bf16 v[240:243], v[112:115], v[80:83], v[240:243]
    ds_read_b128 v[36:39], v7 offset:6144
    v_mfma_f32_16x16x32_bf16 v[148:151], v[116:119], v[56:59], v[148:151]
    v_mfma_f32_16x16x32_bf16 v[180:183], v[116:119], v[64:67], v[180:183]
    s_add_u32 m0, s53, 16384
    s_nop 0
    buffer_load_dwordx4 v2, s[36:39], s51 offen lds
    v_mfma_f32_16x16x32_bf16 v[212:215], v[116:119], v[72:75], v[212:215]
    v_mfma_f32_16x16x32_bf16 v[244:247], v[116:119], v[80:83], v[244:247]
    s_add_u32 m0, s53, 20480
    s_nop 0
    buffer_load_dwordx4 v2, s[40:43], s51 offen lds
    s_add_u32 s51, s51, 110592
    s_cmp_eq_u32 s51, s58
    s_cselect_b32 s51, s57, s51
    s_waitcnt lgkmcnt(4)
    v_mfma_f32_16x16x32_bf16 v[120:123], v[88:91], v[60:63], v[120:123]
    ds_read_b64_tr_b16 v[104:105], v8 offset:28672
    v_mfma_f32_16x16x32_bf16 v[152:155], v[88:91], v[68:71], v[152:155]
    ds_read_b64_tr_b16 v[106:107], v8 offset:29184
    v_mfma_f32_16x16x32_bf16 v[124:127], v[92:95], v[60:63], v[124:127]
    ds_read_b64_tr_b16 v[108:109], v9 offset:28672
    v_mfma_f32_16x16x32_bf16 v[156:159], v[92:95], v[68:71], v[156:159]
    ds_read_b64_tr_b16 v[110:111], v9 offset:29184
    v_mfma_f32_16x16x32_bf16 v[128:131], v[96:99], v[60:63], v[128:131]
    ds_read_b64_tr_b16 v[112:113], v10 offset:28672
    v_mfma_f32_16x16x32_bf16 v[160:163], v[96:99], v[68:71], v[160:163]
    ds_read_b64_tr_b16 v[114:115], v10 offset:29184
    v_mfma_f32_16x16x32_bf16 v[132:135], v[100:103], v[60:63], v[132:135]
    ds_read_b64_tr_b16 v[116:117], v11 offset:28672
    v_mfma_f32_16x16x32_bf16 v[164:167], v[100:103], v[68:71], v[164:167]
    ds_read_b64_tr_b16 v[118:119], v11 offset:29184
    s_waitcnt lgkmcnt(8)
    v_mfma_f32_16x16x32_bf16 v[184:187], v[88:91], v[76:79], v[184:187]
    v_mfma_f32_16x16x32_bf16 v[216:219], v[88:91], v[84:87], v[216:219]
    s_add_u32 s61, s50, 40960
    s_add_u32 m0, s52, 4096
    s_nop 0
    buffer_load_dwordx4 v4, s[32:35], s61 offen lds
    v_mfma_f32_16x16x32_bf16 v[188:191], v[92:95], v[76:79], v[188:191]
    v_mfma_f32_16x16x32_bf16 v[220:223], v[92:95], v[84:87], v[220:223]
    s_add_u32 m0, s52, 5120
    s_nop 0
    buffer_load_dwordx4 v5, s[32:35], s61 offen lds
    v_mfma_f32_16x16x32_bf16 v[192:195], v[96:99], v[76:79], v[192:195]
    v_mfma_f32_16x16x32_bf16 v[224:227], v[96:99], v[84:87], v[224:227]
    s_add_u32 s61, s50, 61440
    s_add_u32 m0, s52, 6144
    s_nop 0
    buffer_load_dwordx4 v4, s[32:35], s61 offen lds
    v_mfma_f32_16x16x32_bf16 v[196:199], v[100:103], v[76:79], v[196:199]
    v_mfma_f32_16x16x32_bf16 v[228:231], v[100:103], v[84:87], v[228:231]
    s_add_u32 m0, s52, 7168
    s_nop 0
    buffer_load_dwordx4 v5, s[32:35], s61 offen lds
    s_add_u32 s50, s50, 128
    s_cmp_eq_u32 s50, s56
    s_cselect_b32 s50, s55, s50
    s_waitcnt vmcnt(12) lgkmcnt(0)
    s_barrier
    v_mfma_f32_16x16x32_bf16 v[136:139], v[104:107], v[60:63], v[136:139]
    ds_read_b64_tr_b16 v[88:89], v8 offset:0
    v_mfma_f32_16x16x32_bf16 v[168:171], v[104:107], v[68:71], v[168:171]
    ds_read_b64_tr_b16 v[90:91], v8 offset:512
    v_mfma_f32_16x16x32_bf16 v[200:203], v[104:107], v[76:79], v[200:203]
    ds_read_b64_tr_b16 v[92:93], v9 offset:0
    v_mfma_f32_16x16x32_bf16 v[232:235], v[104:107], v[84:87], v[232:235]
    ds_read_b64_tr_b16 v[94:95], v9 offset:512
    v_mfma_f32_16x16x32_bf16 v[140:143], v[108:111], v[60:63], v[140:143]
    ds_read_b64_tr_b16 v[96:97], v10 offset:0
    v_mfma_f32_16x16x32_bf16 v[172:175], v[108:111], v[68:71], v[172:175]
    ds_read_b64_tr_b16 v[98:99], v10 offset:512
    v_mfma_f32_16x16x32_bf16 v[204:207], v[108:111], v[76:79], v[204:207]
    ds_read_b64_tr_b16 v[100:101], v11 offset:0
    v_mfma_f32_16x16x32_bf16 v[236:239], v[108:111], v[84:87], v[236:239]
    ds_read_b64_tr_b16 v[102:103], v11 offset:512
    v_mfma_f32_16x16x32_bf16 v[144:147], v[112:115], v[60:63], v[144:147]
    ds_read_b128 v[40:43], v6 offset:8192
    v_mfma_f32_16x16x32_bf16 v[176:179], v[112:115], v[68:71], v[176:179]
    ds_read_b128 v[44:47], v7 offset:8192
    v_mfma_f32_16x16x32_bf16 v[208:211], v[112:115], v[76:79], v[208:211]
    ds_read_b128 v[48:51], v6 offset:10240
    v_mfma_f32_16x16x32_bf16 v[240:243], v[112:115], v[84:87], v[240:243]
    ds_read_b128 v[52:55], v7 offset:10240
    v_mfma_f32_16x16x32_bf16 v[148:151], v[116:119], v[60:63], v[148:151]
    v_mfma_f32_16x16x32_bf16 v[180:183], v[116:119], v[68:71], v[180:183]
    s_add_u32 m0, s53, 24576
    s_nop 0
    buffer_load_dwordx4 v2, s[36:39], s51 offen lds
    v_mfma_f32_16x16x32_bf16 v[212:215], v[116:119], v[76:79], v[212:215]
    v_mfma_f32_16x16x32_bf16 v[244:247], v[116:119], v[84:87], v[244:247]
    s_add_u32 m0, s53, 28672
    s_nop 0
    buffer_load_dwordx4 v2, s[40:43], s51 offen lds
    s_add_u32 s51, s51, 110592
    s_cmp_eq_u32 s51, s58
    s_cselect_b32 s51, s57, s51
    s_waitcnt lgkmcnt(4)
    v_mfma_f32_16x16x32_bf16 v[120:123], v[88:91], v[24:27], v[120:123]
    ds_read_b64_tr_b16 v[104:105], v8 offset:4096
    v_mfma_f32_16x16x32_bf16 v[152:155], v[88:91], v[32:35], v[152:155]
    ds_read_b64_tr_b16 v[106:107], v8 offset:4608
    v_mfma_f32_16x16x32_bf16 v[124:127], v[92:95], v[24:27], v[124:127]
    ds_read_b64_tr_b16 v[108:109], v9 offset:4096
    v_mfma_f32_16x16x32_bf16 v[156:159], v[92:95], v[32:35], v[156:159]
    ds_read_b64_tr_b16 v[110:111], v9 offset:4608
    v_mfma_f32_16x16x32_bf16 v[128:131], v[96:99], v[24:27], v[128:131]
    ds_read_b64_tr_b16 v[112:113], v10 offset:4096
    v_mfma_f32_16x16x32_bf16 v[160:163], v[96:99], v[32:35], v[160:163]
    ds_read_b64_tr_b16 v[114:115], v10 offset:4608
    v_mfma_f32_16x16x32_bf16 v[132:135], v[100:103], v[24:27], v[132:135]
    ds_read_b64_tr_b16 v[116:117], v11 offset:4096
    v_mfma_f32_16x16x32_bf16 v[164:167], v[100:103], v[32:35], v[164:167]
    ds_read_b64_tr_b16 v[118:119], v11 offset:4608
    s_waitcnt lgkmcnt(8)
    v_mfma_f32_16x16x32_bf16 v[184:187], v[88:91], v[40:43], v[184:187]
    v_mfma_f32_16x16x32_bf16 v[216:219], v[88:91], v[48:51], v[216:219]
    s_add_u32 s61, s50, 0
    s_add_u32 m0, s52, 8192
    s_nop 0
    buffer_load_dwordx4 v4, s[32:35], s61 offen lds
    v_mfma_f32_16x16x32_bf16 v[188:191], v[92:95], v[40:43], v[188:191]
    v_mfma_f32_16x16x32_bf16 v[220:223], v[92:95], v[48:51], v[220:223]
    s_add_u32 m0, s52, 9216
    s_nop 0
    buffer_load_dwordx4 v5, s[32:35], s61 offen lds
    v_mfma_f32_16x16x32_bf16 v[192:195], v[96:99], v[40:43], v[192:195]
    v_mfma_f32_16x16x32_bf16 v[224:227], v[96:99], v[48:51], v[224:227]
    s_add_u32 s61, s50, 20480
    s_add_u32 m0, s52, 10240
    s_nop 0
    buffer_load_dwordx4 v4, s[32:35], s61 offen lds
    v_mfma_f32_16x16x32_bf16 v[196:199], v[100:103], v[40:43], v[196:199]
    v_mfma_f32_16x16x32_bf16 v[228:231], v[100:103], v[48:51], v[228:231]
    s_add_u32 m0, s52, 11264
    s_nop 0
    buffer_load_dwordx4 v5, s[32:35], s61 offen lds
    s_waitcnt vmcnt(12) lgkmcnt(0)
    s_barrier
    v_mfma_f32_16x16x32_bf16 v[136:139], v[104:107], v[24:27], v[136:139]
    ds_read_b64_tr_b16 v[88:89], v8 offset:8192
    v_mfma_f32_16x16x32_bf16 v[168:171], v[104:107], v[32:35], v[168:171]
    ds_read_b64_tr_b16 v[90:91], v8 offset:8704
    v_mfma_f32_16x16x32_bf16 v[200:203], v[104:107], v[40:43], v[200:203]
    ds_read_b64_tr_b16 v[92:93], v9 offset:8192
    v_mfma_f32_16x16x32_bf16 v[232:235], v[104:107], v[48:51], v[232:235]
    ds_read_b64_tr_b16 v[94:95], v9 offset:8704
    v_mfma_f32_16x16x32_bf16 v[140:143], v[108:111], v[24:27], v[140:143]
    ds_read_b64_tr_b16 v[96:97], v10 offset:8192
    v_mfma_f32_16x16x32_bf16 v[172:175], v[108:111], v[32:35], v[172:175]
    ds_read_b64_tr_b16 v[98:99], v10 offset:8704
    v_mfma_f32_16x16x32_bf16 v[204:207], v[108:111], v[40:43], v[204:207]
    ds_read_b64_tr_b16 v[100:101], v11 offset:8192
    v_mfma_f32_16x16x32_bf16 v[236:239], v[108:111], v[48:51], v[236:239]
    ds_read_b64_tr_b16 v[102:103], v11 offset:8704
    v_mfma_f32_16x16x32_bf16 v[144:147], v[112:115], v[24:27], v[144:147]
    ds_read_b128 v[56:59], v6 offset:0
    v_mfma_f32_16x16x32_bf16 v[176:179], v[112:115], v[32:35], v[176:179]
    ds_read_b128 v[60:63], v7 offset:0
    v_mfma_f32_16x16x32_bf16 v[208:211], v[112:115], v[40:43], v[208:211]
    ds_read_b128 v[64:67], v6 offset:2048
    v_mfma_f32_16x16x32_bf16 v[240:243], v[112:115], v[48:51], v[240:243]
    ds_read_b128 v[68:71], v7 offset:2048
    v_mfma_f32_16x16x32_bf16 v[148:151], v[116:119], v[24:27], v[148:151]
    v_mfma_f32_16x16x32_bf16 v[180:183], v[116:119], v[32:35], v[180:183]
    s_add_u32 m0, s53, 0
    s_nop 0
    buffer_load_dwordx4 v2, s[36:39], s51 offen lds
    v_mfma_f32_16x16x32_bf16 v[212:215], v[116:119], v[40:43], v[212:215]
    v_mfma_f32_16x16x32_bf16 v[244:247], v[116:119], v[48:51], v[244:247]
    s_add_u32 m0, s53, 4096
    s_nop 0
    buffer_load_dwordx4 v2, s[40:43], s51 offen lds
    s_add_u32 s51, s51, 110592
    s_cmp_eq_u32 s51, s58
    s_cselect_b32 s51, s57, s51
    s_waitcnt lgkmcnt(4)
    v_mfma_f32_16x16x32_bf16 v[120:123], v[88:91], v[28:31], v[120:123]
    ds_read_b64_tr_b16 v[104:105], v8 offset:12288
    v_mfma_f32_16x16x32_bf16 v[152:155], v[88:91], v[36:39], v[152:155]
    ds_read_b64_tr_b16 v[106:107], v8 offset:12800
    v_mfma_f32_16x16x32_bf16 v[124:127], v[92:95], v[28:31], v[124:127]
    ds_read_b64_tr_b16 v[108:109], v9 offset:12288
    v_mfma_f32_16x16x32_bf16 v[156:159], v[92:95], v[36:39], v[156:159]
    ds_read_b64_tr_b16 v[110:111], v9 offset:12800
    v_mfma_f32_16x16x32_bf16 v[128:131], v[96:99], v[28:31], v[128:131]
    ds_read_b64_tr_b16 v[112:113], v10 offset:12288
    v_mfma_f32_16x16x32_bf16 v[160:163], v[96:99], v[36:39], v[160:163]
    ds_read_b64_tr_b16 v[114:115], v10 offset:12800
    v_mfma_f32_16x16x32_bf16 v[132:135], v[100:103], v[28:31], v[132:135]
    ds_read_b64_tr_b16 v[116:117], v11 offset:12288
    v_mfma_f32_16x16x32_bf16 v[164:167], v[100:103], v[36:39], v[164:167]
    ds_read_b64_tr_b16 v[118:119], v11 offset:12800
    s_waitcnt lgkmcnt(8)
    v_mfma_f32_16x16x32_bf16 v[184:187], v[88:91], v[44:47], v[184:187]
    v_mfma_f32_16x16x32_bf16 v[216:219], v[88:91], v[52:55], v[216:219]
    s_add_u32 s61, s50, 40960
    s_add_u32 m0, s52, 0
    s_nop 0
    buffer_load_dwordx4 v4, s[32:35], s61 offen lds
    v_mfma_f32_16x16x32_bf16 v[188:191], v[92:95], v[44:47], v[188:191]
    v_mfma_f32_16x16x32_bf16 v[220:223], v[92:95], v[52:55], v[220:223]
    s_add_u32 m0, s52, 1024
    s_nop 0
    buffer_load_dwordx4 v5, s[32:35], s61 offen lds
    v_mfma_f32_16x16x32_bf16 v[192:195], v[96:99], v[44:47], v[192:195]
    v_mfma_f32_16x16x32_bf16 v[224:227], v[96:99], v[52:55], v[224:227]
    s_add_u32 s61, s50, 61440
    s_add_u32 m0, s52, 2048
    s_nop 0
    buffer_load_dwordx4 v4, s[32:35], s61 offen lds
    v_mfma_f32_16x16x32_bf16 v[196:199], v[100:103], v[44:47], v[196:199]
    v_mfma_f32_16x16x32_bf16 v[228:231], v[100:103], v[52:55], v[228:231]
    s_add_u32 m0, s52, 3072
    s_nop 0
    buffer_load_dwordx4 v5, s[32:35], s61 offen lds
    s_add_u32 s50, s50, 128
    s_cmp_eq_u32 s50, s56
    s_cselect_b32 s50, s55, s50
    s_waitcnt vmcnt(12) lgkmcnt(0)
    s_barrier
    v_mfma_f32_16x16x32_bf16 v[136:139], v[104:107], v[28:31], v[136:139]
    ds_read_b64_tr_b16 v[88:89], v8 offset:16384
    v_mfma_f32_16x16x32_bf16 v[168:171], v[104:107], v[36:39], v[168:171]
    ds_read_b64_tr_b16 v[90:91], v8 offset:16896
    v_mfma_f32_16x16x32_bf16 v[200:203], v[104:107], v[44:47], v[200:203]
    ds_read_b64_tr_b16 v[92:93], v9 offset:16384
    v_mfma_f32_16x16x32_bf16 v[232:235], v[104:107], v[52:55], v[232:235]
    ds_read_b64_tr_b16 v[94:95], v9 offset:16896
    v_mfma_f32_16x16x32_bf16 v[140:143], v[108:111], v[28:31], v[140:143]
    ds_read_b64_tr_b16 v[96:97], v10 offset:16384
    v_mfma_f32_16x16x32_bf16 v[172:175], v[108:111], v[36:39], v[172:175]
    ds_read_b64_tr_b16 v[98:99], v10 offset:16896
    v_mfma_f32_16x16x32_bf16 v[204:207], v[108:111], v[44:47], v[204:207]
    ds_read_b64_tr_b16 v[100:101], v11 offset:16384
    v_mfma_f32_16x16x32_bf16 v[236:239], v[108:111], v[52:55], v[236:239]
    ds_read_b64_tr_b16 v[102:103], v11 offset:16896
    v_mfma_f32_16x16x32_bf16 v[144:147], v[112:115], v[28:31], v[144:147]
    ds_read_b128 v[72:75], v6 offset:4096
    v_mfma_f32_16x16x32_bf16 v[176:179], v[112:115], v[36:39], v[176:179]
    ds_read_b128 v[76:79], v7 offset:4096
    v_mfma_f32_16x16x32_bf16 v[208:211], v[112:115], v[44:47], v[208:211]
    ds_read_b128 v[80:83], v6 offset:6144
    v_mfma_f32_16x16x32_bf16 v[240:243], v[112:115], v[52:55], v[240:243]
    ds_read_b128 v[84:87], v7 offset:6144
    v_mfma_f32_16x16x32_bf16 v[148:151], v[116:119], v[28:31], v[148:151]
    v_mfma_f32_16x16x32_bf16 v[180:183], v[116:119], v[36:39], v[180:183]
    s_add_u32 m0, s53, 8192
    s_nop 0
    buffer_load_dwordx4 v2, s[36:39], s51 offen lds
    v_mfma_f32_16x16x32_bf16 v[212:215], v[116:119], v[44:47], v[212:215]
    v_mfma_f32_16x16x32_bf16 v[244:247], v[116:119], v[52:55], v[244:247]
    s_add_u32 m0, s53, 12288
    s_nop 0
    buffer_load_dwordx4 v2, s[40:43], s51 offen lds
    s_add_u32 s51, s51, 110592
    s_cmp_eq_u32 s51, s58
    s_cselect_b32 s51, s57, s51
    s_waitcnt lgkmcnt(4)
    v_mfma_f32_16x16x32_bf16 v[120:123], v[88:91], v[56:59], v[120:123]
    ds_read_b64_tr_b16 v[104:105], v8 offset:20480
    v_mfma_f32_16x16x32_bf16 v[152:155], v[88:91], v[64:67], v[152:155]
    ds_read_b64_tr_b16 v[106:107], v8 offset:20992
    v_mfma_f32_16x16x32_bf16 v[124:127], v[92:95], v[56:59], v[124:127]
    ds_read_b64_tr_b16 v[108:109], v9 offset:20480
    v_mfma_f32_16x16x32_bf16 v[156:159], v[92:95], v[64:67], v[156:159]
    ds_read_b64_tr_b16 v[110:111], v9 offset:20992
    v_mfma_f32_16x16x32_bf16 v[128:131], v[96:99], v[56:59], v[128:131]
    ds_read_b64_tr_b16 v[112:113], v10 offset:20480
    v_mfma_f32_16x16x32_bf16 v[160:163], v[96:99], v[64:67], v[160:163]
    ds_read_b64_tr_b16 v[114:115], v10 offset:20992
    v_mfma_f32_16x16x32_bf16 v[132:135], v[100:103], v[56:59], v[132:135]
    ds_read_b64_tr_b16 v[116:117], v11 offset:20480
    v_mfma_f32_16x16x32_bf16 v[164:167], v[100:103], v[64:67], v[164:167]
    ds_read_b64_tr_b16 v[118:119], v11 offset:20992
    s_waitcnt lgkmcnt(8)
    v_mfma_f32_16x16x32_bf16 v[184:187], v[88:91], v[72:75], v[184:187]
    v_mfma_f32_16x16x32_bf16 v[216:219], v[88:91], v[80:83], v[216:219]
    s_add_u32 s61, s50, 0
    s_add_u32 m0, s52, 4096
    s_nop 0
    buffer_load_dwordx4 v4, s[32:35], s61 offen lds
    v_mfma_f32_16x16x32_bf16 v[188:191], v[92:95], v[72:75], v[188:191]
    v_mfma_f32_16x16x32_bf16 v[220:223], v[92:95], v[80:83], v[220:223]
    s_add_u32 m0, s52, 5120
    s_nop 0
    buffer_load_dwordx4 v5, s[32:35], s61 offen lds
    v_mfma_f32_16x16x32_bf16 v[192:195], v[96:99], v[72:75], v[192:195]
    v_mfma_f32_16x16x32_bf16 v[224:227], v[96:99], v[80:83], v[224:227]
    s_add_u32 s61, s50, 20480
    s_add_u32 m0, s52, 6144
    s_nop 0
    buffer_load_dwordx4 v4, s[32:35], s61 offen lds
    v_mfma_f32_16x16x32_bf16 v[196:199], v[100:103], v[72:75], v[196:199]
    v_mfma_f32_16x16x32_bf16 v[228:231], v[100:103], v[80:83], v[228:231]
    s_add_u32 m0, s52, 7168
    s_nop 0
    buffer_load_dwordx4 v5, s[32:35], s61 offen lds
    s_waitcnt vmcnt(12) lgkmcnt(0)
    s_barrier
    v_mfma_f32_16x16x32_bf16 v[136:139], v[104:107], v[56:59], v[136:139]
    ds_read_b64_tr_b16 v[88:89], v8 offset:24576
    v_mfma_f32_16x16x32_bf16 v[168:171], v[104:107], v[64:67], v[168:171]
    ds_read_b64_tr_b16 v[90:91], v8 offset:25088
    v_mfma_f32_16x16x32_bf16 v[200:203], v[104:107], v[72:75], v[200:203]
    ds_read_b64_tr_b16 v[92:93], v9 offset:24576
    v_mfma_f32_16x16x32_bf16 v[232:235], v[104:107], v[80:83], v[232:235]
    ds_read_b64_tr_b16 v[94:95], v9 offset:25088
    v_mfma_f32_16x16x32_bf16 v[140:143], v[108:111], v[56:59], v[140:143]
    ds_read_b64_tr_b16 v[96:97], v10 offset:24576
    v_mfma_f32_16x16x32_bf16 v[172:175], v[108:111], v[64:67], v[172:175]
    ds_read_b64_tr_b16 v[98:99], v10 offset:25088
    v_mfma_f32_16x16x32_bf16 v[204:207], v[108:111], v[72:75], v[204:207]
    ds_read_b64_tr_b16 v[100:101], v11 offset:24576
    v_mfma_f32_16x16x32_bf16 v[236:239], v[108:111], v[80:83], v[236:239]
    ds_read_b64_tr_b16 v[102:103], v11 offset:25088
    v_mfma_f32_16x16x32_bf16 v[144:147], v[112:115], v[56:59], v[144:147]
    ds_read_b128 v[24:27], v6 offset:8192
    v_mfma_f32_16x16x32_bf16 v[176:179], v[112:115], v[64:67], v[176:179]
    ds_read_b128 v[28:31], v7 offset:8192
    v_mfma_f32_16x16x32_bf16 v[208:211], v[112:115], v[72:75], v[208:211]
    ds_read_b128 v[32:35], v6 offset:10240
    v_mfma_f32_16x16x32_bf16 v[240:243], v[112:115], v[80:83], v[240:243]
    ds_read_b128 v[36:39], v7 offset:10240
    v_mfma_f32_16x16x32_bf16 v[148:151], v[116:119], v[56:59], v[148:151]
    v_mfma_f32_16x16x32_bf16 v[180:183], v[116:119], v[64:67], v[180:183]
    s_add_u32 m0, s53, 16384
    s_nop 0
    buffer_load_dwordx4 v2, s[36:39], s51 offen lds
    v_mfma_f32_16x16x32_bf16 v[212:215], v[116:119], v[72:75], v[212:215]
    v_mfma_f32_16x16x32_bf16 v[244:247], v[116:119], v[80:83], v[244:247]
    s_add_u32 m0, s53, 20480
    s_nop 0
    buffer_load_dwordx4 v2, s[40:43], s51 offen lds
    s_add_u32 s51, s51, 110592
    s_cmp_eq_u32 s51, s58
    s_cselect_b32 s51, s57, s51
    s_waitcnt lgkmcnt(4)
    v_mfma_f32_16x16x32_bf16 v[120:123], v[88:91], v[60:63], v[120:123]
    ds_read_b64_tr_b16 v[104:105], v8 offset:28672
    v_mfma_f32_16x16x32_bf16 v[152:155], v[88:91], v[68:71], v[152:155]
    ds_read_b64_tr_b16 v[106:107], v8 offset:29184
    v_mfma_f32_16x16x32_bf16 v[124:127], v[92:95], v[60:63], v[124:127]
    ds_read_b64_tr_b16 v[108:109], v9 offset:28672
    v_mfma_f32_16x16x32_bf16 v[156:159], v[92:95], v[68:71], v[156:159]
    ds_read_b64_tr_b16 v[110:111], v9 offset:29184
    v_mfma_f32_16x16x32_bf16 v[128:131], v[96:99], v[60:63], v[128:131]
    ds_read_b64_tr_b16 v[112:113], v10 offset:28672
    v_mfma_f32_16x16x32_bf16 v[160:163], v[96:99], v[68:71], v[160:163]
    ds_read_b64_tr_b16 v[114:115], v10 offset:29184
    v_mfma_f32_16x16x32_bf16 v[132:135], v[100:103], v[60:63], v[132:135]
    ds_read_b64_tr_b16 v[116:117], v11 offset:28672
    v_mfma_f32_16x16x32_bf16 v[164:167], v[100:103], v[68:71], v[164:167]
    ds_read_b64_tr_b16 v[118:119], v11 offset:29184
    s_waitcnt lgkmcnt(8)
    v_mfma_f32_16x16x32_bf16 v[184:187], v[88:91], v[76:79], v[184:187]
    v_mfma_f32_16x16x32_bf16 v[216:219], v[88:91], v[84:87], v[216:219]
    s_add_u32 s61, s50, 40960
    s_add_u32 m0, s52, 8192
    s_nop 0
    buffer_load_dwordx4 v4, s[32:35], s61 offen lds
    v_mfma_f32_16x16x32_bf16 v[188:191], v[92:95], v[76:79], v[188:191]
    v_mfma_f32_16x16x32_bf16 v[220:223], v[92:95], v[84:87], v[220:223]
    s_add_u32 m0, s52, 9216
    s_nop 0
    buffer_load_dwordx4 v5, s[32:35], s61 offen lds
    v_mfma_f32_16x16x32_bf16 v[192:195], v[96:99], v[76:79], v[192:195]
    v_mfma_f32_16x16x32_bf16 v[224:227], v[96:99], v[84:87], v[224:227]
    s_add_u32 s61, s50, 61440
    s_add_u32 m0, s52, 10240
    s_nop 0
    buffer_load_dwordx4 v4, s[32:35], s61 offen lds
    v_mfma_f32_16x16x32_bf16 v[196:199], v[100:103], v[76:79], v[196:199]
    v_mfma_f32_16x16x32_bf16 v[228:231], v[100:103], v[84:87], v[228:231]
    s_add_u32 m0, s52, 11264
    s_nop 0
    buffer_load_dwordx4 v5, s[32:35], s61 offen lds
    s_branch L_ps_2_2
L_pw_a2_2:
    s_branch L_pw_a2_3
L_pw_b2_2:
    s_branch L_pw_b2_3
L_pw_c2_2:
    s_branch L_pw_c2_3
L_ps_2_2:
    s_add_u32 s50, s50, 128
    s_cmp_eq_u32 s50, s56
    s_cselect_b32 s50, s55, s50
    s_waitcnt vmcnt(12) lgkmcnt(0)
    s_barrier
    v_mfma_f32_16x16x32_bf16 v[136:139], v[104:107], v[60:63], v[136:139]
    ds_read_b64_tr_b16 v[88:89], v8 offset:0
    v_mfma_f32_16x16x32_bf16 v[168:171], v[104:107], v[68:71], v[168:171]
    ds_read_b64_tr_b16 v[90:91], v8 offset:512
    v_mfma_f32_16x16x32_bf16 v[200:203], v[104:107], v[76:79], v[200:203]
    ds_read_b64_tr_b16 v[92:93], v9 offset:0
    v_mfma_f32_16x16x32_bf16 v[232:235], v[104:107], v[84:87], v[232:235]
    ds_read_b64_tr_b16 v[94:95], v9 offset:512
    v_mfma_f32_16x16x32_bf16 v[140:143], v[108:111], v[60:63], v[140:143]
    ds_read_b64_tr_b16 v[96:97], v10 offset:0
    v_mfma_f32_16x16x32_bf16 v[172:175], v[108:111], v[68:71], v[172:175]
    ds_read_b64_tr_b16 v[98:99], v10 offset:512
    v_mfma_f32_16x16x32_bf16 v[204:207], v[108:111], v[76:79], v[204:207]
    ds_read_b64_tr_b16 v[100:101], v11 offset:0
    v_mfma_f32_16x16x32_bf16 v[236:239], v[108:111], v[84:87], v[236:239]
    ds_read_b64_tr_b16 v[102:103], v11 offset:512
    v_mfma_f32_16x16x32_bf16 v[144:147], v[112:115], v[60:63], v[144:147]
    ds_read_b128 v[40:43], v6 offset:0
    v_mfma_f32_16x16x32_bf16 v[176:179], v[112:115], v[68:71], v[176:179]
    ds_read_b128 v[44:47], v7 offset:0
    v_mfma_f32_16x16x32_bf16 v[208:211], v[112:115], v[76:79], v[208:211]
    ds_read_b128 v[48:51], v6 offset:2048
    v_mfma_f32_16x16x32_bf16 v[240:243], v[112:115], v[84:87], v[240:243]
    ds_read_b128 v[52:55], v7 offset:2048
    v_mfma_f32_16x16x32_bf16 v[148:151], v[116:119], v[60:63], v[148:151]
    v_mfma_f32_16x16x32_bf16 v[180:183], v[116:119], v[68:71], v[180:183]
    s_add_u32 m0, s53, 24576
    s_nop 0
    buffer_load_dwordx4 v2, s[36:39], s51 offen lds
    v_mfma_f32_16x16x32_bf16 v[212:215], v[116:119], v[76:79], v[212:215]
    v_mfma_f32_16x16x32_bf16 v[244:247], v[116:119], v[84:87], v[244:247]
    s_add_u32 m0, s53, 28672
    s_nop 0
    buffer_load_dwordx4 v2, s[40:43], s51 offen lds
    s_add_u32 s51, s51, 110592
    s_cmp_eq_u32 s51, s58
    s_cselect_b32 s51, s57, s51
    s_waitcnt lgkmcnt(4)
    v_mfma_f32_16x16x32_bf16 v[120:123], v[88:91], v[24:27], v[120:123]
    ds_read_b64_tr_b16 v[104:105], v8 offset:4096
    v_mfma_f32_16x16x32_bf16 v[152:155], v[88:91], v[32:35], v[152:155]
    ds_read_b64_tr_b16 v[106:107], v8 offset:4608
    v_mfma_f32_16x16x32_bf16 v[124:127], v[92:95], v[24:27], v[124:127]
    ds_read_b64_tr_b16 v[108:109], v9 offset:4096
    v_mfma_f32_16x16x32_bf16 v[156:159], v[92:95], v[32:35], v[156:159]
    ds_read_b64_tr_b16 v[110:111], v9 offset:4608
    v_mfma_f32_16x16x32_bf16 v[128:131], v[96:99], v[24:27], v[128:131]
    ds_read_b64_tr_b16 v[112:113], v10 offset:4096
    v_mfma_f32_16x16x32_bf16 v[160:163], v[96:99], v[32:35], v[160:163]
    ds_read_b64_tr_b16 v[114:115], v10 offset:4608
    v_mfma_f32_16x16x32_bf16 v[132:135], v[100:103], v[24:27], v[132:135]
    ds_read_b64_tr_b16 v[116:117], v11 offset:4096
    v_mfma_f32_16x16x32_bf16 v[164:167], v[100:103], v[32:35], v[164:167]
    ds_read_b64_tr_b16 v[118:119], v11 offset:4608
    s_waitcnt lgkmcnt(8)
    v_mfma_f32_16x16x32_bf16 v[184:187], v[88:91], v[40:43], v[184:187]
    v_mfma_f32_16x16x32_bf16 v[216:219], v[88:91], v[48:51], v[216:219]
    s_add_u32 s61, s50, 0
    s_add_u32 m0, s52, 0
    s_nop 0
    buffer_load_dwordx4 v4, s[32:35], s61 offen lds
    v_mfma_f32_16x16x32_bf16 v[188:191], v[92:95], v[40:43], v[188:191]
    v_mfma_f32_16x16x32_bf16 v[220:223], v[92:95], v[48:51], v[220:223]
    s_add_u32 m0, s52, 1024
    s_nop 0
    buffer_load_dwordx4 v5, s[32:35], s61 offen lds
    v_mfma_f32_16x16x32_bf16 v[192:195], v[96:99], v[40:43], v[192:195]
    v_mfma_f32_16x16x32_bf16 v[224:227], v[96:99], v[48:51], v[224:227]
    s_add_u32 s61, s50, 20480
    s_add_u32 m0, s52, 2048
    s_nop 0
    buffer_load_dwordx4 v4, s[32:35], s61 offen lds
    v_mfma_f32_16x16x32_bf16 v[196:199], v[100:103], v[40:43], v[196:199]
    v_mfma_f32_16x16x32_bf16 v[228:231], v[100:103], v[48:51], v[228:231]
    s_add_u32 m0, s52, 3072
    s_nop 0
    buffer_load_dwordx4 v5, s[32:35], s61 offen lds
    s_waitcnt vmcnt(12) lgkmcnt(0)
    s_barrier
    v_mfma_f32_16x16x32_bf16 v[136:139], v[104:107], v[24:27], v[136:139]
    ds_read_b64_tr_b16 v[88:89], v8 offset:8192
    v_mfma_f32_16x16x32_bf16 v[168:171], v[104:107], v[32:35], v[168:171]
    ds_read_b64_tr_b16 v[90:91], v8 offset:8704
    v_mfma_f32_16x16x32_bf16 v[200:203], v[104:107], v[40:43], v[200:203]
    ds_read_b64_tr_b16 v[92:93], v9 offset:8192
    v_mfma_f32_16x16x32_bf16 v[232:235], v[104:107], v[48:51], v[232:235]
    ds_read_b64_tr_b16 v[94:95], v9 offset:8704
    v_mfma_f32_16x16x32_bf16 v[140:143], v[108:111], v[24:27], v[140:143]
    ds_read_b64_tr_b16 v[96:97], v10 offset:8192
    v_mfma_f32_16x16x32_bf16 v[172:175], v[108:111], v[32:35], v[172:175]
    ds_read_b64_tr_b16 v[98:99], v10 offset:8704
    v_mfma_f32_16x16x32_bf16 v[204:207], v[108:111], v[40:43], v[204:207]
    ds_read_b64_tr_b16 v[100:101], v11 offset:8192
    v_mfma_f32_16x16x32_bf16 v[236:239], v[108:111], v[48:51], v[236:239]
    ds_read_b64_tr_b16 v[102:103], v11 offset:8704
    v_mfma_f32_16x16x32_bf16 v[144:147], v[112:115], v[24:27], v[144:147]
    ds_read_b128 v[56:59], v6 offset:4096
    v_mfma_f32_16x16x32_bf16 v[176:179], v[112:115], v[32:35], v[176:179]
    ds_read_b128 v[60:63], v7 offset:4096
    v_mfma_f32_16x16x32_bf16 v[208:211], v[112:115], v[40:43], v[208:211]
    ds_read_b128 v[64:67], v6 offset:6144
    v_mfma_f32_16x16x32_bf16 v[240:243], v[112:115], v[48:51], v[240:243]
    ds_read_b128 v[68:71], v7 offset:6144
    v_mfma_f32_16x16x32_bf16 v[148:151], v[116:119], v[24:27], v[148:151]
    v_mfma_f32_16x16x32_bf16 v[180:183], v[116:119], v[32:35], v[180:183]
    s_add_u32 m0, s53, 0
    s_nop 0
    buffer_load_dwordx4 v2, s[36:39], s51 offen lds
    v_mfma_f32_16x16x32_bf16 v[212:215], v[116:119], v[40:43], v[212:215]
    v_mfma_f32_16x16x32_bf16 v[244:247], v[116:119], v[48:51], v[244:247]
    s_add_u32 m0, s53, 4096
    s_nop 0
    buffer_load_dwordx4 v2, s[40:43], s51 offen lds
    s_add_u32 s51, s51, 110592
    s_cmp_eq_u32 s51, s58
    s_cselect_b32 s51, s57, s51
    s_waitcnt lgkmcnt(4)
    v_mfma_f32_16x16x32_bf16 v[120:123], v[88:91], v[28:31], v[120:123]
    ds_read_b64_tr_b16 v[104:105], v8 offset:12288
    v_mfma_f32_16x16x32_bf16 v[152:155], v[88:91], v[36:39], v[152:155]
    ds_read_b64_tr_b16 v[106:107], v8 offset:12800
    v_mfma_f32_16x16x32_bf16 v[124:127], v[92:95], v[28:31], v[124:127]
    ds_read_b64_tr_b16 v[108:109], v9 offset:12288
    v_mfma_f32_16x16x32_bf16 v[156:159], v[92:95], v[36:39], v[156:159]
    ds_read_b64_tr_b16 v[110:111], v9 offset:12800
    v_mfma_f32_16x16x32_bf16 v[128:131], v[96:99], v[28:31], v[128:131]
    ds_read_b64_tr_b16 v[112:113], v10 offset:12288
    v_mfma_f32_16x16x32_bf16 v[160:163], v[96:99], v[36:39], v[160:163]
    ds_read_b64_tr_b16 v[114:115], v10 offset:12800
    v_mfma_f32_16x16x32_bf16 v[132:135], v[100:103], v[28:31], v[132:135]
    ds_read_b64_tr_b16 v[116:117], v11 offset:12288
    v_mfma_f32_16x16x32_bf16 v[164:167], v[100:103], v[36:39], v[164:167]
    ds_read_b64_tr_b16 v[118:119], v11 offset:12800
    s_waitcnt lgkmcnt(8)
    v_mfma_f32_16x16x32_bf16 v[184:187], v[88:91], v[44:47], v[184:187]
    v_mfma_f32_16x16x32_bf16 v[216:219], v[88:91], v[52:55], v[216:219]
    s_add_u32 s61, s50, 40960
    s_add_u32 m0, s52, 4096
    s_nop 0
    buffer_load_dwordx4 v4, s[32:35], s61 offen lds
    v_mfma_f32_16x16x32_bf16 v[188:191], v[92:95], v[44:47], v[188:191]
    v_mfma_f32_16x16x32_bf16 v[220:223], v[92:95], v[52:55], v[220:223]
    s_add_u32 m0, s52, 5120
    s_nop 0
    buffer_load_dwordx4 v5, s[32:35], s61 offen lds
    v_mfma_f32_16x16x32_bf16 v[192:195], v[96:99], v[44:47], v[192:195]
    v_mfma_f32_16x16x32_bf16 v[224:227], v[96:99], v[52:55], v[224:227]
    s_add_u32 s61, s50, 61440
    s_add_u32 m0, s52, 6144
    s_nop 0
    buffer_load_dwordx4 v4, s[32:35], s61 offen lds
    v_mfma_f32_16x16x32_bf16 v[196:199], v[100:103], v[44:47], v[196:199]
    v_mfma_f32_16x16x32_bf16 v[228:231], v[100:103], v[52:55], v[228:231]
    s_add_u32 m0, s52, 7168
    s_nop 0
    buffer_load_dwordx4 v5, s[32:35], s61 offen lds
    s_add_u32 s50, s50, 128
    s_cmp_eq_u32 s50, s56
    s_cselect_b32 s50, s55, s50
    s_waitcnt vmcnt(12) lgkmcnt(0)
    s_barrier
    v_mfma_f32_16x16x32_bf16 v[136:139], v[104:107], v[28:31], v[136:139]
    ds_read_b64_tr_b16 v[88:89], v8 offset:16384
    v_mfma_f32_16x16x32_bf16 v[168:171], v[104:107], v[36:39], v[168:171]
    ds_read_b64_tr_b16 v[90:91], v8 offset:16896
    v_mfma_f32_16x16x32_bf16 v[200:203], v[104:107], v[44:47], v[200:203]
    ds_read_b64_tr_b16 v[92:93], v9 offset:16384
    v_mfma_f32_16x16x32_bf16 v[232:235], v[104:107], v[52:55], v[232:235]
    ds_read_b64_tr_b16 v[94:95], v9 offset:16896
    v_mfma_f32_16x16x32_bf16 v[140:143], v[108:111], v[28:31], v[140:143]
    ds_read_b64_tr_b16 v[96:97], v10 offset:16384
    v_mfma_f32_16x16x32_bf16 v[172:175], v[108:111], v[36:39], v[172:175]
    ds_read_b64_tr_b16 v[98:99], v10 offset:16896
    v_mfma_f32_16x16x32_bf16 v[204:207], v[108:111], v[44:47], v[204:207]
    ds_read_b64_tr_b16 v[100:101], v11 offset:16384
    v_mfma_f32_16x16x32_bf16 v[236:239], v[108:111], v[52:55], v[236:239]
    ds_read_b64_tr_b16 v[102:103], v11 offset:16896
    v_mfma_f32_16x16x32_bf16 v[144:147], v[112:115], v[28:31], v[144:147]
    ds_read_b128 v[72:75], v6 offset:8192
    v_mfma_f32_16x16x32_bf16 v[176:179], v[112:115], v[36:39], v[176:179]
    ds_read_b128 v[76:79], v7 offset:8192
    v_mfma_f32_16x16x32_bf16 v[208:211], v[112:115], v[44:47], v[208:211]
    ds_read_b128 v[80:83], v6 offset:10240
    v_mfma_f32_16x16x32_bf16 v[240:243], v[112:115], v[52:55], v[240:243]
    ds_read_b128 v[84:87], v7 offset:10240
    v_mfma_f32_16x16x32_bf16 v[148:151], v[116:119], v[28:31], v[148:151]
    v_mfma_f32_16x16x32_bf16 v[180:183], v[116:119], v[36:39], v[180:183]
    s_add_u32 m0, s53, 8192
    s_nop 0
    buffer_load_dwordx4 v2, s[36:39], s51 offen lds
    v_mfma_f32_16x16x32_bf16 v[212:215], v[116:119], v[44:47], v[212:215]
    v_mfma_f32_16x16x32_bf16 v[244:247], v[116:119], v[52:55], v[244:247]
    s_add_u32 m0, s53, 12288
    s_nop 0
    buffer_load_dwordx4 v2, s[40:43], s51 offen lds
    s_add_u32 s51, s51, 110592
    s_cmp_eq_u32 s51, s58
    s_cselect_b32 s51, s57, s51
    s_waitcnt lgkmcnt(4)
    v_mfma_f32_16x16x32_bf16 v[120:123], v[88:91], v[56:59], v[120:123]
    ds_read_b64_tr_b16 v[104:105], v8 offset:20480
    v_mfma_f32_16x16x32_bf16 v[152:155], v[88:91], v[64:67], v[152:155]
    ds_read_b64_tr_b16 v[106:107], v8 offset:20992
    v_mfma_f32_16x16x32_bf16 v[124:127], v[92:95], v[56:59], v[124:127]
    ds_read_b64_tr_b16 v[108:109], v9 offset:20480
    v_mfma_f32_16x16x32_bf16 v[156:159], v[92:95], v[64:67], v[156:159]
    ds_read_b64_tr_b16 v[110:111], v9 offset:20992
    v_mfma_f32_16x16x32_bf16 v[128:131], v[96:99], v[56:59], v[128:131]
    ds_read_b64_tr_b16 v[112:113], v10 offset:20480
    v_mfma_f32_16x16x32_bf16 v[160:163], v[96:99], v[64:67], v[160:163]
    ds_read_b64_tr_b16 v[114:115], v10 offset:20992
    v_mfma_f32_16x16x32_bf16 v[132:135], v[100:103], v[56:59], v[132:135]
    ds_read_b64_tr_b16 v[116:117], v11 offset:20480
    v_mfma_f32_16x16x32_bf16 v[164:167], v[100:103], v[64:67], v[164:167]
    ds_read_b64_tr_b16 v[118:119], v11 offset:20992
    s_waitcnt lgkmcnt(8)
    v_mfma_f32_16x16x32_bf16 v[184:187], v[88:91], v[72:75], v[184:187]
    v_mfma_f32_16x16x32_bf16 v[216:219], v[88:91], v[80:83], v[216:219]
    s_add_u32 s61, s50, 0
    s_add_u32 m0, s52, 8192
    s_nop 0
    buffer_load_dwordx4 v4, s[32:35], s61 offen lds
    v_mfma_f32_16x16x32_bf16 v[188:191], v[92:95], v[72:75], v[188:191]
    v_mfma_f32_16x16x32_bf16 v[220:223], v[92:95], v[80:83], v[220:223]
    s_add_u32 m0, s52, 9216
    s_nop 0
    buffer_load_dwordx4 v5, s[32:35], s61 offen lds
    v_mfma_f32_16x16x32_bf16 v[192:195], v[96:99], v[72:75], v[192:195]
    v_mfma_f32_16x16x32_bf16 v[224:227], v[96:99], v[80:83], v[224:227]
    s_add_u32 s61, s50, 20480
    s_add_u32 m0, s52, 10240
    s_nop 0
    buffer_load_dwordx4 v4, s[32:35], s61 offen lds
    v_mfma_f32_16x16x32_bf16 v[196:199], v[100:103], v[72:75], v[196:199]
    v_mfma_f32_16x16x32_bf16 v[228:231], v[100:103], v[80:83], v[228:231]
    s_add_u32 m0, s52, 11264
    s_nop 0
    buffer_load_dwordx4 v5, s[32:35], s61 offen lds
    s_waitcnt vmcnt(12) lgkmcnt(0)
    s_barrier
    v_mfma_f32_16x16x32_bf16 v[136:139], v[104:107], v[56:59], v[136:139]
    ds_read_b64_tr_b16 v[88:89], v8 offset:24576
    v_mfma_f32_16x16x32_bf16 v[168:171], v[104:107], v[64:67], v[168:171]
    ds_read_b64_tr_b16 v[90:91], v8 offset:25088
    v_mfma_f32_16x16x32_bf16 v[200:203], v[104:107], v[72:75], v[200:203]
    ds_read_b64_tr_b16 v[92:93], v9 offset:24576
    v_mfma_f32_16x16x32_bf16 v[232:235], v[104:107], v[80:83], v[232:235]
    ds_read_b64_tr_b16 v[94:95], v9 offset:25088
    v_mfma_f32_16x16x32_bf16 v[140:143], v[108:111], v[56:59], v[140:143]
    ds_read_b64_tr_b16 v[96:97], v10 offset:24576
    v_mfma_f32_16x16x32_bf16 v[172:175], v[108:111], v[64:67], v[172:175]
    ds_read_b64_tr_b16 v[98:99], v10 offset:25088
    v_mfma_f32_16x16x32_bf16 v[204:207], v[108:111], v[72:75], v[204:207]
    ds_read_b64_tr_b16 v[100:101], v11 offset:24576
    v_mfma_f32_16x16x32_bf16 v[236:239], v[108:111], v[80:83], v[236:239]
    ds_read_b64_tr_b16 v[102:103], v11 offset:25088
    v_mfma_f32_16x16x32_bf16 v[144:147], v[112:115], v[56:59], v[144:147]
    ds_read_b128 v[24:27], v6 offset:0
    v_mfma_f32_16x16x32_bf16 v[176:179], v[112:115], v[64:67], v[176:179]
    ds_read_b128 v[28:31], v7 offset:0
    v_mfma_f32_16x16x32_bf16 v[208:211], v[112:115], v[72:75], v[208:211]
    ds_read_b128 v[32:35], v6 offset:2048
    v_mfma_f32_16x16x32_bf16 v[240:243], v[112:115], v[80:83], v[240:243]
    ds_read_b128 v[36:39], v7 offset:2048
    v_mfma_f32_16x16x32_bf16 v[148:151], v[116:119], v[56:59], v[148:151]
    v_mfma_f32_16x16x32_bf16 v[180:183], v[116:119], v[64:67], v[180:183]
    s_add_u32 m0, s53, 16384
    s_nop 0
    buffer_load_dwordx4 v2, s[36:39], s51 offen lds
    v_mfma_f32_16x16x32_bf16 v[212:215], v[116:119], v[72:75], v[212:215]
    v_mfma_f32_16x16x32_bf16 v[244:247], v[116:119], v[80:83], v[244:247]
    s_add_u32 m0, s53, 20480
    s_nop 0
    buffer_load_dwordx4 v2, s[40:43], s51 offen lds
    s_add_u32 s51, s51, 110592
    s_cmp_eq_u32 s51, s58
    s_cselect_b32 s51, s57, s51
    s_waitcnt lgkmcnt(4)
    v_mfma_f32_16x16x32_bf16 v[120:123], v[88:91], v[60:63], v[120:123]
    ds_read_b64_tr_b16 v[104:105], v8 offset:28672
    v_mfma_f32_16x16x32_bf16 v[152:155], v[88:91], v[68:71], v[152:155]
    ds_read_b64_tr_b16 v[106:107], v8 offset:29184
    v_mfma_f32_16x16x32_bf16 v[124:127], v[92:95], v[60:63], v[124:127]
    ds_read_b64_tr_b16 v[108:109], v9 offset:28672
    v_mfma_f32_16x16x32_bf16 v[156:159], v[92:95], v[68:71], v[156:159]
    ds_read_b64_tr_b16 v[110:111], v9 offset:29184
    v_mfma_f32_16x16x32_bf16 v[128:131], v[96:99], v[60:63], v[128:131]
    ds_read_b64_tr_b16 v[112:113], v10 offset:28672
    v_mfma_f32_16x16x32_bf16 v[160:163], v[96:99], v[68:71], v[160:163]
    ds_read_b64_tr_b16 v[114:115], v10 offset:29184
    v_mfma_f32_16x16x32_bf16 v[132:135], v[100:103], v[60:63], v[132:135]
    ds_read_b64_tr_b16 v[116:117], v11 offset:28672
    v_mfma_f32_16x16x32_bf16 v[164:167], v[100:103], v[68:71], v[164:167]
    ds_read_b64_tr_b16 v[118:119], v11 offset:29184
    s_waitcnt lgkmcnt(8)
    v_mfma_f32_16x16x32_bf16 v[184:187], v[88:91], v[76:79], v[184:187]
    v_mfma_f32_16x16x32_bf16 v[216:219], v[88:91], v[84:87], v[216:219]
    s_add_u32 s61, s50, 40960
    s_add_u32 m0, s52, 0
    s_nop 0
    buffer_load_dwordx4 v4, s[32:35], s61 offen lds
    v_mfma_f32_16x16x32_bf16 v[188:191], v[92:95], v[76:79], v[188:191]
    v_mfma_f32_16x16x32_bf16 v[220:223], v[92:95], v[84:87], v[220:223]
    s_add_u32 m0, s52, 1024
    s_nop 0
    buffer_load_dwordx4 v5, s[32:35], s61 offen lds
    v_mfma_f32_16x16x32_bf16 v[192:195], v[96:99], v[76:79], v[192:195]
    v_mfma_f32_16x16x32_bf16 v[224:227], v[96:99], v[84:87], v[224:227]
    s_add_u32 s61, s50, 61440
    s_add_u32 m0, s52, 2048
    s_nop 0
    buffer_load_dwordx4 v4, s[32:35], s61 offen lds
    v_mfma_f32_16x16x32_bf16 v[196:199], v[100:103], v[76:79], v[196:199]
    v_mfma_f32_16x16x32_bf16 v[228:231], v[100:103], v[84:87], v[228:231]
    s_add_u32 m0, s52, 3072
    s_nop 0
    buffer_load_dwordx4 v5, s[32:35], s61 offen lds
    s_add_u32 s50, s50, 128
    s_cmp_eq_u32 s50, s56
    s_cselect_b32 s50, s55, s50
    s_waitcnt vmcnt(12) lgkmcnt(0)
    s_barrier
    v_mfma_f32_16x16x32_bf16 v[136:139], v[104:107], v[60:63], v[136:139]
    ds_read_b64_tr_b16 v[88:89], v8 offset:0
    v_mfma_f32_16x16x32_bf16 v[168:171], v[104:107], v[68:71], v[168:171]
    ds_read_b64_tr_b16 v[90:91], v8 offset:512
    v_mfma_f32_16x16x32_bf16 v[200:203], v[104:107], v[76:79], v[200:203]
    ds_read_b64_tr_b16 v[92:93], v9 offset:0
    v_mfma_f32_16x16x32_bf16 v[232:235], v[104:107], v[84:87], v[232:235]
    ds_read_b64_tr_b16 v[94:95], v9 offset:512
    v_mfma_f32_16x16x32_bf16 v[140:143], v[108:111], v[60:63], v[140:143]
    ds_read_b64_tr_b16 v[96:97], v10 offset:0
    v_mfma_f32_16x16x32_bf16 v[172:175], v[108:111], v[68:71], v[172:175]
    ds_read_b64_tr_b16 v[98:99], v10 offset:512
    v_mfma_f32_16x16x32_bf16 v[204:207], v[108:111], v[76:79], v[204:207]
    ds_read_b64_tr_b16 v[100:101], v11 offset:0
    v_mfma_f32_16x16x32_bf16 v[236:239], v[108:111], v[84:87], v[236:239]
    ds_read_b64_tr_b16 v[102:103], v11 offset:512
    v_mfma_f32_16x16x32_bf16 v[144:147], v[112:115], v[60:63], v[144:147]
    ds_read_b128 v[40:43], v6 offset:4096
    v_mfma_f32_16x16x32_bf16 v[176:179], v[112:115], v[68:71], v[176:179]
    ds_read_b128 v[44:47], v7 offset:4096
    v_mfma_f32_16x16x32_bf16 v[208:211], v[112:115], v[76:79], v[208:211]
    ds_read_b128 v[48:51], v6 offset:6144
    v_mfma_f32_16x16x32_bf16 v[240:243], v[112:115], v[84:87], v[240:243]
    ds_read_b128 v[52:55], v7 offset:6144
    v_mfma_f32_16x16x32_bf16 v[148:151], v[116:119], v[60:63], v[148:151]
    v_mfma_f32_16x16x32_bf16 v[180:183], v[116:119], v[68:71], v[180:183]
    s_add_u32 m0, s53, 24576
    s_nop 0
    buffer_load_dwordx4 v2, s[36:39], s51 offen lds
    v_mfma_f32_16x16x32_bf16 v[212:215], v[116:119], v[76:79], v[212:215]
    v_mfma_f32_16x16x32_bf16 v[244:247], v[116:119], v[84:87], v[244:247]
    s_add_u32 m0, s53, 28672
    s_nop 0
    buffer_load_dwordx4 v2, s[40:43], s51 offen lds
    s_add_u32 s51, s51, 110592
    s_cmp_eq_u32 s51, s58
    s_cselect_b32 s51, s57, s51
    s_waitcnt lgkmcnt(4)
    v_mfma_f32_16x16x32_bf16 v[120:123], v[88:91], v[24:27], v[120:123]
    ds_read_b64_tr_b16 v[104:105], v8 offset:4096
    v_mfma_f32_16x16x32_bf16 v[152:155], v[88:91], v[32:35], v[152:155]
    ds_read_b64_tr_b16 v[106:107], v8 offset:4608
    v_mfma_f32_16x16x32_bf16 v[124:127], v[92:95], v[24:27], v[124:127]
    ds_read_b64_tr_b16 v[108:109], v9 offset:4096
    v_mfma_f32_16x16x32_bf16 v[156:159], v[92:95], v[32:35], v[156:159]
    ds_read_b64_tr_b16 v[110:111], v9 offset:4608
    v_mfma_f32_16x16x32_bf16 v[128:131], v[96:99], v[24:27], v[128:131]
    ds_read_b64_tr_b16 v[112:113], v10 offset:4096
    v_mfma_f32_16x16x32_bf16 v[160:163], v[96:99], v[32:35], v[160:163]
    ds_read_b64_tr_b16 v[114:115], v10 offset:4608
    v_mfma_f32_16x16x32_bf16 v[132:135], v[100:103], v[24:27], v[132:135]
    ds_read_b64_tr_b16 v[116:117], v11 offset:4096
    v_mfma_f32_16x16x32_bf16 v[164:167], v[100:103], v[32:35], v[164:167]
    ds_read_b64_tr_b16 v[118:119], v11 offset:4608
    s_waitcnt lgkmcnt(8)
    v_mfma_f32_16x16x32_bf16 v[184:187], v[88:91], v[40:43], v[184:187]
    v_mfma_f32_16x16x32_bf16 v[216:219], v[88:91], v[48:51], v[216:219]
    s_add_u32 s61, s50, 0
    s_add_u32 m0, s52, 4096
    s_nop 0
    buffer_load_dwordx4 v4, s[32:35], s61 offen lds
    v_mfma_f32_16x16x32_bf16 v[188:191], v[92:95], v[40:43], v[188:191]
    v_mfma_f32_16x16x32_bf16 v[220:223], v[92:95], v[48:51], v[220:223]
    s_add_u32 m0, s52, 5120
    s_nop 0
    buffer_load_dwordx4 v5, s[32:35], s61 offen lds
    v_mfma_f32_16x16x32_bf16 v[192:195], v[96:99], v[40:43], v[192:195]
    v_mfma_f32_16x16x32_bf16 v[224:227], v[96:99], v[48:51], v[224:227]
    s_add_u32 s61, s50, 20480
    s_add_u32 m0, s52, 6144
    s_nop 0
    buffer_load_dwordx4 v4, s[32:35], s61 offen lds
    v_mfma_f32_16x16x32_bf16 v[196:199], v[100:103], v[40:43], v[196:199]
    v_mfma_f32_16x16x32_bf16 v[228:231], v[100:103], v[48:51], v[228:231]
    s_add_u32 m0, s52, 7168
    s_nop 0
    buffer_load_dwordx4 v5, s[32:35], s61 offen lds
    s_waitcnt vmcnt(12) lgkmcnt(0)
    s_barrier
    v_mfma_f32_16x16x32_bf16 v[136:139], v[104:107], v[24:27], v[136:139]
    ds_read_b64_tr_b16 v[88:89], v8 offset:8192
    v_mfma_f32_16x16x32_bf16 v[168:171], v[104:107], v[32:35], v[168:171]
    ds_read_b64_tr_b16 v[90:91], v8 offset:8704
    v_mfma_f32_16x16x32_bf16 v[200:203], v[104:107], v[40:43], v[200:203]
    ds_read_b64_tr_b16 v[92:93], v9 offset:8192
    v_mfma_f32_16x16x32_bf16 v[232:235], v[104:107], v[48:51], v[232:235]
    ds_read_b64_tr_b16 v[94:95], v9 offset:8704
    v_mfma_f32_16x16x32_bf16 v[140:143], v[108:111], v[24:27], v[140:143]
    ds_read_b64_tr_b16 v[96:97], v10 offset:8192
    v_mfma_f32_16x16x32_bf16 v[172:175], v[108:111], v[32:35], v[172:175]
    ds_read_b64_tr_b16 v[98:99], v10 offset:8704
    v_mfma_f32_16x16x32_bf16 v[204:207], v[108:111], v[40:43], v[204:207]
    ds_read_b64_tr_b16 v[100:101], v11 offset:8192
    v_mfma_f32_16x16x32_bf16 v[236:239], v[108:111], v[48:51], v[236:239]
    ds_read_b64_tr_b16 v[102:103], v11 offset:8704
    v_mfma_f32_16x16x32_bf16 v[144:147], v[112:115], v[24:27], v[144:147]
    ds_read_b128 v[56:59], v6 offset:8192
    v_mfma_f32_16x16x32_bf16 v[176:179], v[112:115], v[32:35], v[176:179]
    ds_read_b128 v[60:63], v7 offset:8192
    v_mfma_f32_16x16x32_bf16 v[208:211], v[112:115], v[40:43], v[208:211]
    ds_read_b128 v[64:67], v6 offset:10240
    v_mfma_f32_16x16x32_bf16 v[240:243], v[112:115], v[48:51], v[240:243]
    ds_read_b128 v[68:71], v7 offset:10240
    v_mfma_f32_16x16x32_bf16 v[148:151], v[116:119], v[24:27], v[148:151]
    v_mfma_f32_16x16x32_bf16 v[180:183], v[116:119], v[32:35], v[180:183]
    s_add_u32 m0, s53, 0
    s_nop 0
    buffer_load_dwordx4 v2, s[36:39], s51 offen lds
    v_mfma_f32_16x16x32_bf16 v[212:215], v[116:119], v[40:43], v[212:215]
    v_mfma_f32_16x16x32_bf16 v[244:247], v[116:119], v[48:51], v[244:247]
    s_add_u32 m0, s53, 4096
    s_nop 0
    buffer_load_dwordx4 v2, s[40:43], s51 offen lds
    s_add_u32 s51, s51, 110592
    s_cmp_eq_u32 s51, s58
    s_cselect_b32 s51, s57, s51
    s_waitcnt lgkmcnt(4)
    v_mfma_f32_16x16x32_bf16 v[120:123], v[88:91], v[28:31], v[120:123]
    ds_read_b64_tr_b16 v[104:105], v8 offset:12288
    v_mfma_f32_16x16x32_bf16 v[152:155], v[88:91], v[36:39], v[152:155]
    ds_read_b64_tr_b16 v[106:107], v8 offset:12800
    v_mfma_f32_16x16x32_bf16 v[124:127], v[92:95], v[28:31], v[124:127]
    ds_read_b64_tr_b16 v[108:109], v9 offset:12288
    v_mfma_f32_16x16x32_bf16 v[156:159], v[92:95], v[36:39], v[156:159]
    ds_read_b64_tr_b16 v[110:111], v9 offset:12800
    v_mfma_f32_16x16x32_bf16 v[128:131], v[96:99], v[28:31], v[128:131]
    ds_read_b64_tr_b16 v[112:113], v10 offset:12288
    v_mfma_f32_16x16x32_bf16 v[160:163], v[96:99], v[36:39], v[160:163]
    ds_read_b64_tr_b16 v[114:115], v10 offset:12800
    v_mfma_f32_16x16x32_bf16 v[132:135], v[100:103], v[28:31], v[132:135]
    ds_read_b64_tr_b16 v[116:117], v11 offset:12288
    v_mfma_f32_16x16x32_bf16 v[164:167], v[100:103], v[36:39], v[164:167]
    ds_read_b64_tr_b16 v[118:119], v11 offset:12800
    s_waitcnt lgkmcnt(8)
    v_mfma_f32_16x16x32_bf16 v[184:187], v[88:91], v[44:47], v[184:187]
    v_mfma_f32_16x16x32_bf16 v[216:219], v[88:91], v[52:55], v[216:219]
    s_add_u32 s61, s50, 40960
    s_add_u32 m0, s52, 8192
    s_nop 0
    buffer_load_dwordx4 v4, s[32:35], s61 offen lds
    v_mfma_f32_16x16x32_bf16 v[188:191], v[92:95], v[44:47], v[188:191]
    v_mfma_f32_16x16x32_bf16 v[220:223], v[92:95], v[52:55], v[220:223]
    s_add_u32 m0, s52, 9216
    s_nop 0
    buffer_load_dwordx4 v5, s[32:35], s61 offen lds
    v_mfma_f32_16x16x32_bf16 v[192:195], v[96:99], v[44:47], v[192:195]
    v_mfma_f32_16x16x32_bf16 v[224:227], v[96:99], v[52:55], v[224:227]
    s_add_u32 s61, s50, 61440
    s_add_u32 m0, s52, 10240
    s_nop 0
    buffer_load_dwordx4 v4, s[32:35], s61 offen lds
    v_mfma_f32_16x16x32_bf16 v[196:199], v[100:103], v[44:47], v[196:199]
    v_mfma_f32_16x16x32_bf16 v[228:231], v[100:103], v[52:55], v[228:231]
    s_add_u32 m0, s52, 11264
    s_nop 0
    buffer_load_dwordx4 v5, s[32:35], s61 offen lds
    s_add_u32 s50, s50, 128
    s_cmp_eq_u32 s50, s56
    s_cselect_b32 s50, s55, s50
    s_waitcnt vmcnt(12) lgkmcnt(0)
    s_barrier
    v_mfma_f32_16x16x32_bf16 v[136:139], v[104:107], v[28:31], v[136:139]
    ds_read_b64_tr_b16 v[88:89], v8 offset:16384
    v_mfma_f32_16x16x32_bf16 v[168:171], v[104:107], v[36:39], v[168:171]
    ds_read_b64_tr_b16 v[90:91], v8 offset:16896
    v_mfma_f32_16x16x32_bf16 v[200:203], v[104:107], v[44:47], v[200:203]
    ds_read_b64_tr_b16 v[92:93], v9 offset:16384
    v_mfma_f32_16x16x32_bf16 v[232:235], v[104:107], v[52:55], v[232:235]
    ds_read_b64_tr_b16 v[94:95], v9 offset:16896
    v_mfma_f32_16x16x32_bf16 v[140:143], v[108:111], v[28:31], v[140:143]
    ds_read_b64_tr_b16 v[96:97], v10 offset:16384
    v_mfma_f32_16x16x32_bf16 v[172:175], v[108:111], v[36:39], v[172:175]
    ds_read_b64_tr_b16 v[98:99], v10 offset:16896
    v_mfma_f32_16x16x32_bf16 v[204:207], v[108:111], v[44:47], v[204:207]
    ds_read_b64_tr_b16 v[100:101], v11 offset:16384
    v_mfma_f32_16x16x32_bf16 v[236:239], v[108:111], v[52:55], v[236:239]
    ds_read_b64_tr_b16 v[102:103], v11 offset:16896
    v_mfma_f32_16x16x32_bf16 v[144:147], v[112:115], v[28:31], v[144:147]
    ds_read_b128 v[72:75], v6 offset:0
    v_mfma_f32_16x16x32_bf16 v[176:179], v[112:115], v[36:39], v[176:179]
    ds_read_b128 v[76:79], v7 offset:0
    v_mfma_f32_16x16x32_bf16 v[208:211], v[112:115], v[44:47], v[208:211]
    ds_read_b128 v[80:83], v6 offset:2048
    v_mfma_f32_16x16x32_bf16 v[240:243], v[112:115], v[52:55], v[240:243]
    ds_read_b128 v[84:87], v7 offset:2048
    v_mfma_f32_16x16x32_bf16 v[148:151], v[116:119], v[28:31], v[148:151]
    v_mfma_f32_16x16x32_bf16 v[180:183], v[116:119], v[36:39], v[180:183]
    s_add_u32 m0, s53, 8192
    s_nop 0
    buffer_load_dwordx4 v2, s[36:39], s51 offen lds
    v_mfma_f32_16x16x32_bf16 v[212:215], v[116:119], v[44:47], v[212:215]
    v_mfma_f32_16x16x32_bf16 v[244:247], v[116:119], v[52:55], v[244:247]
    s_add_u32 m0, s53, 12288
    s_nop 0
    buffer_load_dwordx4 v2, s[40:43], s51 offen lds
    s_add_u32 s51, s51, 110592
    s_cmp_eq_u32 s51, s58
    s_cselect_b32 s51, s57, s51
    s_waitcnt lgkmcnt(4)
    v_mfma_f32_16x16x32_bf16 v[120:123], v[88:91], v[56:59], v[120:123]
    ds_read_b64_tr_b16 v[104:105], v8 offset:20480
    v_mfma_f32_16x16x32_bf16 v[152:155], v[88:91], v[64:67], v[152:155]
    ds_read_b64_tr_b16 v[106:107], v8 offset:20992
    v_mfma_f32_16x16x32_bf16 v[124:127], v[92:95], v[56:59], v[124:127]
    ds_read_b64_tr_b16 v[108:109], v9 offset:20480
    v_mfma_f32_16x16x32_bf16 v[156:159], v[92:95], v[64:67], v[156:159]
    ds_read_b64_tr_b16 v[110:111], v9 offset:20992
    v_mfma_f32_16x16x32_bf16 v[128:131], v[96:99], v[56:59], v[128:131]
    ds_read_b64_tr_b16 v[112:113], v10 offset:20480
    v_mfma_f32_16x16x32_bf16 v[160:163], v[96:99], v[64:67], v[160:163]
    ds_read_b64_tr_b16 v[114:115], v10 offset:20992
    v_mfma_f32_16x16x32_bf16 v[132:135], v[100:103], v[56:59], v[132:135]
    ds_read_b64_tr_b16 v[116:117], v11 offset:20480
    v_mfma_f32_16x16x32_bf16 v[164:167], v[100:103], v[64:67], v[164:167]
    ds_read_b64_tr_b16 v[118:119], v11 offset:20992
    s_waitcnt lgkmcnt(8)
    v_mfma_f32_16x16x32_bf16 v[184:187], v[88:91], v[72:75], v[184:187]
    v_mfma_f32_16x16x32_bf16 v[216:219], v[88:91], v[80:83], v[216:219]
    s_add_u32 s61, s50, 0
    s_add_u32 m0, s52, 0
    s_nop 0
    buffer_load_dwordx4 v4, s[32:35], s61 offen lds
    v_mfma_f32_16x16x32_bf16 v[188:191], v[92:95], v[72:75], v[188:191]
    v_mfma_f32_16x16x32_bf16 v[220:223], v[92:95], v[80:83], v[220:223]
    s_add_u32 m0, s52, 1024
    s_nop 0
    buffer_load_dwordx4 v5, s[32:35], s61 offen lds
    v_mfma_f32_16x16x32_bf16 v[192:195], v[96:99], v[72:75], v[192:195]
    v_mfma_f32_16x16x32_bf16 v[224:227], v[96:99], v[80:83], v[224:227]
    s_add_u32 s61, s50, 20480
    s_add_u32 m0, s52, 2048
    s_nop 0
    buffer_load_dwordx4 v4, s[32:35], s61 offen lds
    s_branch L_ps_2_3
L_pw_a2_3:
    s_branch L_pw_a_ret
L_pw_b2_3:
    s_branch L_pw_b_ret
L_pw_c2_3:
    s_branch L_pw_c_ret
L_ps_2_3:
    v_mfma_f32_16x16x32_bf16 v[196:199], v[100:103], v[72:75], v[196:199]
    v_mfma_f32_16x16x32_bf16 v[228:231], v[100:103], v[80:83], v[228:231]
    s_add_u32 m0, s52, 3072
    s_nop 0
    buffer_load_dwordx4 v5, s[32:35], s61 offen lds
    s_waitcnt vmcnt(12) lgkmcnt(0)
    s_barrier
    v_mfma_f32_16x16x32_bf16 v[136:139], v[104:107], v[56:59], v[136:139]
    ds_read_b64_tr_b16 v[88:89], v8 offset:24576
    v_mfma_f32_16x16x32_bf16 v[168:171], v[104:107], v[64:67], v[168:171]
    ds_read_b64_tr_b16 v[90:91], v8 offset:25088
    v_mfma_f32_16x16x32_bf16 v[200:203], v[104:107], v[72:75], v[200:203]
    ds_read_b64_tr_b16 v[92:93], v9 offset:24576
    v_mfma_f32_16x16x32_bf16 v[232:235], v[104:107], v[80:83], v[232:235]
    ds_read_b64_tr_b16 v[94:95], v9 offset:25088
    v_mfma_f32_16x16x32_bf16 v[140:143], v[108:111], v[56:59], v[140:143]
    ds_read_b64_tr_b16 v[96:97], v10 offset:24576
    v_mfma_f32_16x16x32_bf16 v[172:175], v[108:111], v[64:67], v[172:175]
    ds_read_b64_tr_b16 v[98:99], v10 offset:25088
    v_mfma_f32_16x16x32_bf16 v[204:207], v[108:111], v[72:75], v[204:207]
    ds_read_b64_tr_b16 v[100:101], v11 offset:24576
    v_mfma_f32_16x16x32_bf16 v[236:239], v[108:111], v[80:83], v[236:239]
    ds_read_b64_tr_b16 v[102:103], v11 offset:25088
    v_mfma_f32_16x16x32_bf16 v[144:147], v[112:115], v[56:59], v[144:147]
    ds_read_b128 v[24:27], v6 offset:4096
    v_mfma_f32_16x16x32_bf16 v[176:179], v[112:115], v[64:67], v[176:179]
    ds_read_b128 v[28:31], v7 offset:4096
    v_mfma_f32_16x16x32_bf16 v[208:211], v[112:115], v[72:75], v[208:211]
    ds_read_b128 v[32:35], v6 offset:6144
    v_mfma_f32_16x16x32_bf16 v[240:243], v[112:115], v[80:83], v[240:243]
    ds_read_b128 v[36:39], v7 offset:6144
    v_mfma_f32_16x16x32_bf16 v[148:151], v[116:119], v[56:59], v[148:151]
    v_mfma_f32_16x16x32_bf16 v[180:183], v[116:119], v[64:67], v[180:183]
    s_add_u32 m0, s53, 16384
    s_nop 0
    buffer_load_dwordx4 v2, s[36:39], s51 offen lds
    v_mfma_f32_16x16x32_bf16 v[212:215], v[116:119], v[72:75], v[212:215]
    v_mfma_f32_16x16x32_bf16 v[244:247], v[116:119], v[80:83], v[244:247]
    s_add_u32 m0, s53, 20480
    s_nop 0
    buffer_load_dwordx4 v2, s[40:43], s51 offen lds
    s_add_u32 s51, s51, 110592
    s_cmp_eq_u32 s51, s58
    s_cselect_b32 s51, s57, s51
    s_waitcnt lgkmcnt(4)
    v_mfma_f32_16x16x32_bf16 v[120:123], v[88:91], v[60:63], v[120:123]
    ds_read_b64_tr_b16 v[104:105], v8 offset:28672
    v_mfma_f32_16x16x32_bf16 v[152:155], v[88:91], v[68:71], v[152:155]
    ds_read_b64_tr_b16 v[106:107], v8 offset:29184
    v_mfma_f32_16x16x32_bf16 v[124:127], v[92:95], v[60:63], v[124:127]
    ds_read_b64_tr_b16 v[108:109], v9 offset:28672
    v_mfma_f32_16x16x32_bf16 v[156:159], v[92:95], v[68:71], v[156:159]
    ds_read_b64_tr_b16 v[110:111], v9 offset:29184
    v_mfma_f32_16x16x32_bf16 v[128:131], v[96:99], v[60:63], v[128:131]
    ds_read_b64_tr_b16 v[112:113], v10 offset:28672
    v_mfma_f32_16x16x32_bf16 v[160:163], v[96:99], v[68:71], v[160:163]
    ds_read_b64_tr_b16 v[114:115], v10 offset:29184
    v_mfma_f32_16x16x32_bf16 v[132:135], v[100:103], v[60:63], v[132:135]
    ds_read_b64_tr_b16 v[116:117], v11 offset:28672
    v_mfma_f32_16x16x32_bf16 v[164:167], v[100:103], v[68:71], v[164:167]
    ds_read_b64_tr_b16 v[118:119], v11 offset:29184
    s_waitcnt lgkmcnt(8)
    v_mfma_f32_16x16x32_bf16 v[184:187], v[88:91], v[76:79], v[184:187]
    v_mfma_f32_16x16x32_bf16 v[216:219], v[88:91], v[84:87], v[216:219]
    s_add_u32 s61, s50, 40960
    s_add_u32 m0, s52, 4096
    s_nop 0
    buffer_load_dwordx4 v4, s[32:35], s61 offen lds
    v_mfma_f32_16x16x32_bf16 v[188:191], v[92:95], v[76:79], v[188:191]
    v_mfma_f32_16x16x32_bf16 v[220:223], v[92:95], v[84:87], v[220:223]
    s_add_u32 m0, s52, 5120
    s_nop 0
    buffer_load_dwordx4 v5, s[32:35], s61 offen lds
    v_mfma_f32_16x16x32_bf16 v[192:195], v[96:99], v[76:79], v[192:195]
    v_mfma_f32_16x16x32_bf16 v[224:227], v[96:99], v[84:87], v[224:227]
    s_add_u32 s61, s50, 61440
    s_add_u32 m0, s52, 6144
    s_nop 0
    buffer_load_dwordx4 v4, s[32:35], s61 offen lds
    v_mfma_f32_16x16x32_bf16 v[196:199], v[100:103], v[76:79], v[196:199]
    v_mfma_f32_16x16x32_bf16 v[228:231], v[100:103], v[84:87], v[228:231]
    s_add_u32 m0, s52, 7168
    s_nop 0
    buffer_load_dwordx4 v5, s[32:35], s61 offen lds
    s_add_u32 s50, s50, 128
    s_cmp_eq_u32 s50, s56
    s_cselect_b32 s50, s55, s50
    s_waitcnt vmcnt(12) lgkmcnt(0)
    s_barrier
    v_mfma_f32_16x16x32_bf16 v[136:139], v[104:107], v[60:63], v[136:139]
    ds_read_b64_tr_b16 v[88:89], v8 offset:0
    v_mfma_f32_16x16x32_bf16 v[168:171], v[104:107], v[68:71], v[168:171]
    ds_read_b64_tr_b16 v[90:91], v8 offset:512
    v_mfma_f32_16x16x32_bf16 v[200:203], v[104:107], v[76:79], v[200:203]
    ds_read_b64_tr_b16 v[92:93], v9 offset:0
    v_mfma_f32_16x16x32_bf16 v[232:235], v[104:107], v[84:87], v[232:235]
    ds_read_b64_tr_b16 v[94:95], v9 offset:512
    v_mfma_f32_16x16x32_bf16 v[140:143], v[108:111], v[60:63], v[140:143]
    ds_read_b64_tr_b16 v[96:97], v10 offset:0
    v_mfma_f32_16x16x32_bf16 v[172:175], v[108:111], v[68:71], v[172:175]
    ds_read_b64_tr_b16 v[98:99], v10 offset:512
    v_mfma_f32_16x16x32_bf16 v[204:207], v[108:111], v[76:79], v[204:207]
    ds_read_b64_tr_b16 v[100:101], v11 offset:0
    v_mfma_f32_16x16x32_bf16 v[236:239], v[108:111], v[84:87], v[236:239]
    ds_read_b64_tr_b16 v[102:103], v11 offset:512
    v_mfma_f32_16x16x32_bf16 v[144:147], v[112:115], v[60:63], v[144:147]
    ds_read_b128 v[40:43], v6 offset:8192
    v_mfma_f32_16x16x32_bf16 v[176:179], v[112:115], v[68:71], v[176:179]
    ds_read_b128 v[44:47], v7 offset:8192
    v_mfma_f32_16x16x32_bf16 v[208:211], v[112:115], v[76:79], v[208:211]
    ds_read_b128 v[48:51], v6 offset:10240
    v_mfma_f32_16x16x32_bf16 v[240:243], v[112:115], v[84:87], v[240:243]
    ds_read_b128 v[52:55], v7 offset:10240
    v_mfma_f32_16x16x32_bf16 v[148:151], v[116:119], v[60:63], v[148:151]
    v_mfma_f32_16x16x32_bf16 v[180:183], v[116:119], v[68:71], v[180:183]
    s_add_u32 m0, s53, 24576
    s_nop 0
    buffer_load_dwordx4 v2, s[36:39], s51 offen lds
    v_mfma_f32_16x16x32_bf16 v[212:215], v[116:119], v[76:79], v[212:215]
    v_mfma_f32_16x16x32_bf16 v[244:247], v[116:119], v[84:87], v[244:247]
    s_add_u32 m0, s53, 28672
    s_nop 0
    buffer_load_dwordx4 v2, s[40:43], s51 offen lds
    s_add_u32 s51, s51, 110592
    s_cmp_eq_u32 s51, s58
    s_cselect_b32 s51, s57, s51
    s_waitcnt lgkmcnt(4)
    v_mfma_f32_16x16x32_bf16 v[120:123], v[88:91], v[24:27], v[120:123]
    ds_read_b64_tr_b16 v[104:105], v8 offset:4096
    v_mfma_f32_16x16x32_bf16 v[152:155], v[88:91], v[32:35], v[152:155]
    ds_read_b64_tr_b16 v[106:107], v8 offset:4608
    v_mfma_f32_16x16x32_bf16 v[124:127], v[92:95], v[24:27], v[124:127]
    ds_read_b64_tr_b16 v[108:109], v9 offset:4096
    v_mfma_f32_16x16x32_bf16 v[156:159], v[92:95], v[32:35], v[156:159]
    ds_read_b64_tr_b16 v[110:111], v9 offset:4608
    v_mfma_f32_16x16x32_bf16 v[128:131], v[96:99], v[24:27], v[128:131]
    ds_read_b64_tr_b16 v[112:113], v10 offset:4096
    v_mfma_f32_16x16x32_bf16 v[160:163], v[96:99], v[32:35], v[160:163]
    ds_read_b64_tr_b16 v[114:115], v10 offset:4608
    v_mfma_f32_16x16x32_bf16 v[132:135], v[100:103], v[24:27], v[132:135]
    ds_read_b64_tr_b16 v[116:117], v11 offset:4096
    v_mfma_f32_16x16x32_bf16 v[164:167], v[100:103], v[32:35], v[164:167]
    ds_read_b64_tr_b16 v[118:119], v11 offset:4608
    s_waitcnt lgkmcnt(8)
    v_mfma_f32_16x16x32_bf16 v[184:187], v[88:91], v[40:43], v[184:187]
    v_mfma_f32_16x16x32_bf16 v[216:219], v[88:91], v[48:51], v[216:219]
    v_mfma_f32_16x16x32_bf16 v[188:191], v[92:95], v[40:43], v[188:191]
    v_mfma_f32_16x16x32_bf16 v[220:223], v[92:95], v[48:51], v[220:223]
    v_mfma_f32_16x16x32_bf16 v[192:195], v[96:99], v[40:43], v[192:195]
    v_mfma_f32_16x16x32_bf16 v[224:227], v[96:99], v[48:51], v[224:227]
    v_mfma_f32_16x16x32_bf16 v[196:199], v[100:103], v[40:43], v[196:199]
    v_mfma_f32_16x16x32_bf16 v[228:231], v[100:103], v[48:51], v[228:231]
    s_waitcnt vmcnt(8) lgkmcnt(0)
    s_barrier
    v_mfma_f32_16x16x32_bf16 v[136:139], v[104:107], v[24:27], v[136:139]
    ds_read_b64_tr_b16 v[88:89], v8 offset:8192
    v_mfma_f32_16x16x32_bf16 v[168:171], v[104:107], v[32:35], v[168:171]
    ds_read_b64_tr_b16 v[90:91], v8 offset:8704
    v_mfma_f32_16x16x32_bf16 v[200:203], v[104:107], v[40:43], v[200:203]
    ds_read_b64_tr_b16 v[92:93], v9 offset:8192
    v_mfma_f32_16x16x32_bf16 v[232:235], v[104:107], v[48:51], v[232:235]
    ds_read_b64_tr_b16 v[94:95], v9 offset:8704
    v_mfma_f32_16x16x32_bf16 v[140:143], v[108:111], v[24:27], v[140:143]
    ds_read_b64_tr_b16 v[96:97], v10 offset:8192
    v_mfma_f32_16x16x32_bf16 v[172:175], v[108:111], v[32:35], v[172:175]
    ds_read_b64_tr_b16 v[98:99], v10 offset:8704
    v_mfma_f32_16x16x32_bf16 v[204:207], v[108:111], v[40:43], v[204:207]
    ds_read_b64_tr_b16 v[100:101], v11 offset:8192
    v_mfma_f32_16x16x32_bf16 v[236:239], v[108:111], v[48:51], v[236:239]
    ds_read_b64_tr_b16 v[102:103], v11 offset:8704
    v_mfma_f32_16x16x32_bf16 v[144:147], v[112:115], v[24:27], v[144:147]
    ds_read_b128 v[56:59], v6 offset:0
    v_mfma_f32_16x16x32_bf16 v[176:179], v[112:115], v[32:35], v[176:179]
    ds_read_b128 v[60:63], v7 offset:0
    v_mfma_f32_16x16x32_bf16 v[208:211], v[112:115], v[40:43], v[208:211]
    ds_read_b128 v[64:67], v6 offset:2048
    v_mfma_f32_16x16x32_bf16 v[240:243], v[112:115], v[48:51], v[240:243]
    ds_read_b128 v[68:71], v7 offset:2048
    v_mfma_f32_16x16x32_bf16 v[148:151], v[116:119], v[24:27], v[148:151]
    v_mfma_f32_16x16x32_bf16 v[180:183], v[116:119], v[32:35], v[180:183]
    v_mfma_f32_16x16x32_bf16 v[212:215], v[116:119], v[40:43], v[212:215]
    v_mfma_f32_16x16x32_bf16 v[244:247], v[116:119], v[48:51], v[244:247]
    s_waitcnt lgkmcnt(4)
    v_mfma_f32_16x16x32_bf16 v[120:123], v[88:91], v[28:31], v[120:123]
    ds_read_b64_tr_b16 v[104:105], v8 offset:12288
    v_mfma_f32_16x16x32_bf16 v[152:155], v[88:91], v[36:39], v[152:155]
    ds_read_b64_tr_b16 v[106:107], v8 offset:12800
    v_mfma_f32_16x16x32_bf16 v[124:127], v[92:95], v[28:31], v[124:127]
    ds_read_b64_tr_b16 v[108:109], v9 offset:12288
    v_mfma_f32_16x16x32_bf16 v[156:159], v[92:95], v[36:39], v[156:159]
    ds_read_b64_tr_b16 v[110:111], v9 offset:12800
    v_mfma_f32_16x16x32_bf16 v[128:131], v[96:99], v[28:31], v[128:131]
    ds_read_b64_tr_b16 v[112:113], v10 offset:12288
    v_mfma_f32_16x16x32_bf16 v[160:163], v[96:99], v[36:39], v[160:163]
    ds_read_b64_tr_b16 v[114:115], v10 offset:12800
    v_mfma_f32_16x16x32_bf16 v[132:135], v[100:103], v[28:31], v[132:135]
    ds_read_b64_tr_b16 v[116:117], v11 offset:12288
    v_mfma_f32_16x16x32_bf16 v[164:167], v[100:103], v[36:39], v[164:167]
    ds_read_b64_tr_b16 v[118:119], v11 offset:12800
    s_waitcnt lgkmcnt(8)
    v_mfma_f32_16x16x32_bf16 v[184:187], v[88:91], v[44:47], v[184:187]
    v_mfma_f32_16x16x32_bf16 v[216:219], v[88:91], v[52:55], v[216:219]
    v_mfma_f32_16x16x32_bf16 v[188:191], v[92:95], v[44:47], v[188:191]
    v_mfma_f32_16x16x32_bf16 v[220:223], v[92:95], v[52:55], v[220:223]
    v_mfma_f32_16x16x32_bf16 v[192:195], v[96:99], v[44:47], v[192:195]
    v_mfma_f32_16x16x32_bf16 v[224:227], v[96:99], v[52:55], v[224:227]
    v_mfma_f32_16x16x32_bf16 v[196:199], v[100:103], v[44:47], v[196:199]
    v_mfma_f32_16x16x32_bf16 v[228:231], v[100:103], v[52:55], v[228:231]
    s_waitcnt vmcnt(2) lgkmcnt(0)
    s_barrier
    v_mfma_f32_16x16x32_bf16 v[136:139], v[104:107], v[28:31], v[136:139]
    ds_read_b64_tr_b16 v[88:89], v8 offset:16384
    v_mfma_f32_16x16x32_bf16 v[168:171], v[104:107], v[36:39], v[168:171]
    ds_read_b64_tr_b16 v[90:91], v8 offset:16896
    v_mfma_f32_16x16x32_bf16 v[200:203], v[104:107], v[44:47], v[200:203]
    ds_read_b64_tr_b16 v[92:93], v9 offset:16384
    v_mfma_f32_16x16x32_bf16 v[232:235], v[104:107], v[52:55], v[232:235]
    ds_read_b64_tr_b16 v[94:95], v9 offset:16896
    v_mfma_f32_16x16x32_bf16 v[140:143], v[108:111], v[28:31], v[140:143]
    ds_read_b64_tr_b16 v[96:97], v10 offset:16384
    v_mfma_f32_16x16x32_bf16 v[172:175], v[108:111], v[36:39], v[172:175]
    ds_read_b64_tr_b16 v[98:99], v10 offset:16896
    v_mfma_f32_16x16x32_bf16 v[204:207], v[108:111], v[44:47], v[204:207]
    ds_read_b64_tr_b16 v[100:101], v11 offset:16384
    v_mfma_f32_16x16x32_bf16 v[236:239], v[108:111], v[52:55], v[236:239]
    ds_read_b64_tr_b16 v[102:103], v11 offset:16896
    v_mfma_f32_16x16x32_bf16 v[144:147], v[112:115], v[28:31], v[144:147]
    ds_read_b128 v[72:75], v6 offset:4096
    v_mfma_f32_16x16x32_bf16 v[176:179], v[112:115], v[36:39], v[176:179]
    ds_read_b128 v[76:79], v7 offset:4096
    v_mfma_f32_16x16x32_bf16 v[208:211], v[112:115], v[44:47], v[208:211]
    ds_read_b128 v[80:83], v6 offset:6144
    v_mfma_f32_16x16x32_bf16 v[240:243], v[112:115], v[52:55], v[240:243]
    ds_read_b128 v[84:87], v7 offset:6144
    v_mfma_f32_16x16x32_bf16 v[148:151], v[116:119], v[28:31], v[148:151]
    v_mfma_f32_16x16x32_bf16 v[180:183], v[116:119], v[36:39], v[180:183]
    v_mfma_f32_16x16x32_bf16 v[212:215], v[116:119], v[44:47], v[212:215]
    v_mfma_f32_16x16x32_bf16 v[244:247], v[116:119], v[52:55], v[244:247]
    s_waitcnt lgkmcnt(4)
    v_mfma_f32_16x16x32_bf16 v[120:123], v[88:91], v[56:59], v[120:123]
    ds_read_b64_tr_b16 v[104:105], v8 offset:20480
    v_mfma_f32_16x16x32_bf16 v[152:155], v[88:91], v[64:67], v[152:155]
    ds_read_b64_tr_b16 v[106:107], v8 offset:20992
    v_mfma_f32_16x16x32_bf16 v[124:127], v[92:95], v[56:59], v[124:127]
    ds_read_b64_tr_b16 v[108:109], v9 offset:20480
    v_mfma_f32_16x16x32_bf16 v[156:159], v[92:95], v[64:67], v[156:159]
    ds_read_b64_tr_b16 v[110:111], v9 offset:20992
    v_mfma_f32_16x16x32_bf16 v[128:131], v[96:99], v[56:59], v[128:131]
    ds_read_b64_tr_b16 v[112:113], v10 offset:20480
    v_mfma_f32_16x16x32_bf16 v[160:163], v[96:99], v[64:67], v[160:163]
    ds_read_b64_tr_b16 v[114:115], v10 offset:20992
    v_mfma_f32_16x16x32_bf16 v[132:135], v[100:103], v[56:59], v[132:135]
    ds_read_b64_tr_b16 v[116:117], v11 offset:20480
    v_mfma_f32_16x16x32_bf16 v[164:167], v[100:103], v[64:67], v[164:167]
    ds_read_b64_tr_b16 v[118:119], v11 offset:20992
    s_waitcnt lgkmcnt(8)
    v_mfma_f32_16x16x32_bf16 v[184:187], v[88:91], v[72:75], v[184:187]
    buffer_load_dwordx2 v[16:17], v15, s[28:31], 0 offen offset:128 sc1
    v_mfma_f32_16x16x32_bf16 v[216:219], v[88:91], v[80:83], v[216:219]
    buffer_load_dwordx4 v[20:23], v13, s[24:27], s62 offen sc1
    v_mfma_f32_16x16x32_bf16 v[188:191], v[92:95], v[72:75], v[188:191]
    buffer_load_dwordx4 v[24:27], v14, s[24:27], s63 offen offset:0 sc1
    v_mfma_f32_16x16x32_bf16 v[220:223], v[92:95], v[80:83], v[220:223]
    buffer_load_dwordx4 v[28:31], v14, s[24:27], s63 offen offset:256 sc1
    buffer_load_dwordx4 v[32:35], v14, s[24:27], s63 offen offset:512 sc1
    v_mfma_f32_16x16x32_bf16 v[192:195], v[96:99], v[72:75], v[192:195]
    buffer_load_dwordx4 v[36:39], v14, s[24:27], s63 offen offset:768 sc1
    v_mfma_f32_16x16x32_bf16 v[224:227], v[96:99], v[80:83], v[224:227]
    buffer_load_dwordx4 v[40:43], v14, s[24:27], s63 offen offset:1024 sc1
    v_mfma_f32_16x16x32_bf16 v[196:199], v[100:103], v[72:75], v[196:199]
    buffer_load_dwordx4 v[44:47], v14, s[24:27], s63 offen offset:1280 sc1
    v_mfma_f32_16x16x32_bf16 v[228:231], v[100:103], v[80:83], v[228:231]
    buffer_load_dwordx4 v[48:51], v14, s[24:27], s63 offen offset:1536 sc1
    buffer_load_dwordx4 v[52:55], v14, s[24:27], s63 offen offset:1792 sc1
    s_waitcnt vmcnt(10) lgkmcnt(0)
    s_barrier
    v_mfma_f32_16x16x32_bf16 v[136:139], v[104:107], v[56:59], v[136:139]
    ds_read_b64_tr_b16 v[88:89], v8 offset:24576
    v_mfma_f32_16x16x32_bf16 v[168:171], v[104:107], v[64:67], v[168:171]
    ds_read_b64_tr_b16 v[90:91], v8 offset:25088
    v_mfma_f32_16x16x32_bf16 v[200:203], v[104:107], v[72:75], v[200:203]
    ds_read_b64_tr_b16 v[92:93], v9 offset:24576
    v_mfma_f32_16x16x32_bf16 v[232:235], v[104:107], v[80:83], v[232:235]
    ds_read_b64_tr_b16 v[94:95], v9 offset:25088
    v_mfma_f32_16x16x32_bf16 v[140:143], v[108:111], v[56:59], v[140:143]
    ds_read_b64_tr_b16 v[96:97], v10 offset:24576
    v_mfma_f32_16x16x32_bf16 v[172:175], v[108:111], v[64:67], v[172:175]
    ds_read_b64_tr_b16 v[98:99], v10 offset:25088
    v_mfma_f32_16x16x32_bf16 v[204:207], v[108:111], v[72:75], v[204:207]
    ds_read_b64_tr_b16 v[100:101], v11 offset:24576
    v_mfma_f32_16x16x32_bf16 v[236:239], v[108:111], v[80:83], v[236:239]
    ds_read_b64_tr_b16 v[102:103], v11 offset:25088
    v_mfma_f32_16x16x32_bf16 v[144:147], v[112:115], v[56:59], v[144:147]
    v_mfma_f32_16x16x32_bf16 v[176:179], v[112:115], v[64:67], v[176:179]
    v_mfma_f32_16x16x32_bf16 v[208:211], v[112:115], v[72:75], v[208:211]
    v_mfma_f32_16x16x32_bf16 v[240:243], v[112:115], v[80:83], v[240:243]
    v_mfma_f32_16x16x32_bf16 v[148:151], v[116:119], v[56:59], v[148:151]
    v_mfma_f32_16x16x32_bf16 v[180:183], v[116:119], v[64:67], v[180:183]
    v_mfma_f32_16x16x32_bf16 v[212:215], v[116:119], v[72:75], v[212:215]
    v_mfma_f32_16x16x32_bf16 v[244:247], v[116:119], v[80:83], v[244:247]
    s_waitcnt lgkmcnt(0)
    v_mfma_f32_16x16x32_bf16 v[120:123], v[88:91], v[60:63], v[120:123]
    ds_read_b64_tr_b16 v[104:105], v8 offset:28672
    v_mfma_f32_16x16x32_bf16 v[152:155], v[88:91], v[68:71], v[152:155]
    ds_read_b64_tr_b16 v[106:107], v8 offset:29184
    v_mfma_f32_16x16x32_bf16 v[124:127], v[92:95], v[60:63], v[124:127]
    ds_read_b64_tr_b16 v[108:109], v9 offset:28672
    v_mfma_f32_16x16x32_bf16 v[156:159], v[92:95], v[68:71], v[156:159]
    ds_read_b64_tr_b16 v[110:111], v9 offset:29184
    v_mfma_f32_16x16x32_bf16 v[128:131], v[96:99], v[60:63], v[128:131]
    ds_read_b64_tr_b16 v[112:113], v10 offset:28672
    v_mfma_f32_16x16x32_bf16 v[160:163], v[96:99], v[68:71], v[160:163]
    ds_read_b64_tr_b16 v[114:115], v10 offset:29184
    v_mfma_f32_16x16x32_bf16 v[132:135], v[100:103], v[60:63], v[132:135]
    ds_read_b64_tr_b16 v[116:117], v11 offset:28672
    v_mfma_f32_16x16x32_bf16 v[164:167], v[100:103], v[68:71], v[164:167]
    ds_read_b64_tr_b16 v[118:119], v11 offset:29184
    v_mfma_f32_16x16x32_bf16 v[184:187], v[88:91], v[76:79], v[184:187]
    v_mfma_f32_16x16x32_bf16 v[216:219], v[88:91], v[84:87], v[216:219]
    v_mfma_f32_16x16x32_bf16 v[188:191], v[92:95], v[76:79], v[188:191]
    v_mfma_f32_16x16x32_bf16 v[220:223], v[92:95], v[84:87], v[220:223]
    v_mfma_f32_16x16x32_bf16 v[192:195], v[96:99], v[76:79], v[192:195]
    v_mfma_f32_16x16x32_bf16 v[224:227], v[96:99], v[84:87], v[224:227]
    v_mfma_f32_16x16x32_bf16 v[196:199], v[100:103], v[76:79], v[196:199]
    v_mfma_f32_16x16x32_bf16 v[228:231], v[100:103], v[84:87], v[228:231]
    s_setprio 3
    s_mov_b32 s3, 0
L_g2gr_19:
    s_waitcnt vmcnt(0) lgkmcnt(0)
    v_readfirstlane_b32 s44, v16
    v_readfirstlane_b32 s45, v17
    v_xor_b32 v12, v16, v26
    v_xor_b32 v18, v17, v27
    v_or_b32 v12, v12, v18
    v_xor_b32 v18, v16, v30
    v_xor_b32 v19, v17, v31
    v_or3_b32 v12, v12, v18, v19
    v_xor_b32 v18, v16, v34
    v_xor_b32 v19, v17, v35
    v_or3_b32 v12, v12, v18, v19
    v_xor_b32 v18, v16, v38
    v_xor_b32 v19, v17, v39
    v_or3_b32 v12, v12, v18, v19
    v_xor_b32 v18, v16, v42
    v_xor_b32 v19, v17, v43
    v_or3_b32 v12, v12, v18, v19
    v_xor_b32 v18, v16, v46
    v_xor_b32 v19, v17, v47
    v_or3_b32 v12, v12, v18, v19
    v_xor_b32 v18, v16, v50
    v_xor_b32 v19, v17, v51
    v_or3_b32 v12, v12, v18, v19
    v_xor_b32 v18, v16, v54
    v_xor_b32 v19, v17, v55
    v_or3_b32 v12, v12, v18, v19
    v_cmp_ne_u32 s[60:61], 0, v12
    v_cmp_ne_u64 vcc, v[16:17], v[22:23]
    s_and_b32 s60, s60, 0xffff
    s_or_b32 s60, s60, vcc_lo
    s_or_b32 s60, s60, vcc_hi
    s_cmp_eq_u32 s44, 0
    s_cselect_b32 s60, 1, s60
    s_cmp_eq_u32 s60, 0
    s_cbranch_scc1 L_g2ok_20
    buffer_load_dwordx2 v[16:17], v15, s[28:31], 0 offen offset:128 sc1
    buffer_load_dwordx4 v[20:23], v13, s[24:27], s62 offen sc1
    buffer_load_dwordx4 v[24:27], v14, s[24:27], s63 offen offset:0 sc1
    buffer_load_dwordx4 v[28:31], v14, s[24:27], s63 offen offset:256 sc1
    buffer_load_dwordx4 v[32:35], v14, s[24:27], s63 offen offset:512 sc1
    buffer_load_dwordx4 v[36:39], v14, s[24:27], s63 offen offset:768 sc1
    buffer_load_dwordx4 v[40:43], v14, s[24:27], s63 offen offset:1024 sc1
    buffer_load_dwordx4 v[44:47], v14, s[24:27], s63 offen offset:1280 sc1
    buffer_load_dwordx4 v[48:51], v14, s[24:27], s63 offen offset:1536 sc1
    buffer_load_dwordx4 v[52:55], v14, s[24:27], s63 offen offset:1792 sc1
    s_add_u32 s3, s3, 1
    s_cmp_gt_u32 s3, 40000
    s_cbranch_scc1 L_end
    s_branch L_g2gr_19
L_g2ok_20:
    v_and_b32 v12, 15, v1
    v_lshlrev_b32 v12, 2, v12
    v_mfma_f32_16x16x32_bf16 v[136:139], v[104:107], v[60:63], v[136:139]
    ds_bpermute_b32 v88, v12, v20 offset:0
    ds_bpermute_b32 v100, v12, v21 offset:0
    ds_bpermute_b32 v90, v12, v20 offset:64
    ds_bpermute_b32 v101, v12, v21 offset:64
    ds_bpermute_b32 v92, v12, v20 offset:128
    ds_bpermute_b32 v102, v12, v21 offset:128
    ds_bpermute_b32 v94, v12, v20 offset:192
    ds_bpermute_b32 v103, v12, v21 offset:192
    v_mfma_f32_16x16x32_bf16 v[168:171], v[104:107], v[68:71], v[168:171]
    v_mov_b32 v26, 0
    v_mfma_f32_16x16x32_bf16 v[200:203], v[104:107], v[76:79], v[200:203]
    v_mov_b32 v27, 0
    v_mov_b32 v30, 0
    v_mfma_f32_16x16x32_bf16 v[232:235], v[104:107], v[84:87], v[232:235]
    v_mov_b32 v31, 0
    v_mov_b32 v34, 0
    v_mfma_f32_16x16x32_bf16 v[140:143], v[108:111], v[60:63], v[140:143]
    v_mov_b32 v35, 0
    v_mov_b32 v38, 0
    v_mfma_f32_16x16x32_bf16 v[172:175], v[108:111], v[68:71], v[172:175]
    v_mov_b32 v39, 0
    v_mov_b32 v42, 0
    v_mfma_f32_16x16x32_bf16 v[204:207], v[108:111], v[76:79], v[204:207]
    v_mov_b32 v43, 0
    v_mfma_f32_16x16x32_bf16 v[236:239], v[108:111], v[84:87], v[236:239]
    v_mov_b32 v46, 0
    v_mov_b32 v47, 0
    v_mfma_f32_16x16x32_bf16 v[144:147], v[112:115], v[60:63], v[144:147]
    v_mov_b32 v50, 0
    v_mov_b32 v51, 0
    v_mfma_f32_16x16x32_bf16 v[176:179], v[112:115], v[68:71], v[176:179]
    v_mov_b32 v54, 0
    v_mov_b32 v55, 0
    v_mfma_f32_16x16x32_bf16 v[208:211], v[112:115], v[76:79], v[208:211]
    v_mov_b32 v96, 0
    v_mov_b32 v97, 0
    v_mfma_f32_16x16x32_bf16 v[240:243], v[112:115], v[84:87], v[240:243]
    s_waitcnt lgkmcnt(0)
    v_mfma_f32_16x16x32_bf16 v[148:151], v[116:119], v[60:63], v[148:151]
    v_cvt_pk_bf16_f32 v89, v88, 0
    v_cvt_pk_bf16_f32 v88, v88, v88
    v_mfma_f32_16x16x32_bf16 v[180:183], v[116:119], v[68:71], v[180:183]
    v_cvt_pk_bf16_f32 v91, v90, 0
    v_cvt_pk_bf16_f32 v90, v90, v90
    v_mfma_f32_16x16x32_bf16 v[212:215], v[116:119], v[76:79], v[212:215]
    v_cvt_pk_bf16_f32 v93, v92, 0
    v_cvt_pk_bf16_f32 v92, v92, v92
    v_mfma_f32_16x16x32_bf16 v[244:247], v[116:119], v[84:87], v[244:247]
    v_cvt_pk_bf16_f32 v95, v94, 0
    v_cvt_pk_bf16_f32 v94, v94, v94
    s_setprio 3
    v_lshlrev_b32 v4, 4, v1
    s_mul_i32 s60, s48, 110592
    s_lshl_b32 s61, s49, 11
    s_add_u32 s60, s60, s61
    s_add_u32 s60, s60, 0x1000000
    v_mfma_f32_16x16x32_bf16 v[120:123], v[24:27], v[88:91], v[120:123]
    v_mfma_f32_16x16x32_bf16 v[124:127], v[28:31], v[88:91], v[124:127]
    v_mfma_f32_16x16x32_bf16 v[128:131], v[32:35], v[88:91], v[128:131]
    v_mfma_f32_16x16x32_bf16 v[132:135], v[36:39], v[88:91], v[132:135]
    v_mfma_f32_16x16x32_bf16 v[136:139], v[40:43], v[88:91], v[136:139]
    v_mfma_f32_16x16x32_bf16 v[140:143], v[44:47], v[88:91], v[140:143]
    v_mfma_f32_16x16x32_bf16 v[144:147], v[48:51], v[88:91], v[144:147]
    v_mfma_f32_16x16x32_bf16 v[148:151], v[52:55], v[88:91], v[148:151]
    v_mul_f32 v16, v100, v100
    v_mul_f32 v12, 0xc0135761, v100
    v_mul_f32 v14, 0x3d372713, v16
    v_rcp_f32 v16, v16
    v_mul_f32 v14, v14, v12
    v_mov_b32 v13, v12
    v_mov_b32 v15, v14
    v_mov_b32 v17, v16
    v_pk_mul_f32 v[56:57], v[120:121], v[120:121]
    v_pk_mul_f32 v[58:59], v[122:123], v[122:123]
    v_pk_mul_f32 v[60:61], v[124:125], v[124:125]
    v_pk_mul_f32 v[62:63], v[126:127], v[126:127]
    v_pk_mul_f32 v[64:65], v[128:129], v[128:129]
    v_mfma_f32_16x16x32_bf16 v[152:155], v[24:27], v[90:93], v[152:155]
    v_pk_mul_f32 v[66:67], v[130:131], v[130:131]
    v_pk_mul_f32 v[68:69], v[132:133], v[132:133]
    v_pk_mul_f32 v[70:71], v[134:135], v[134:135]
    v_pk_fma_f32 v[56:57], v[56:57], v[14:15], v[12:13]
    v_pk_fma_f32 v[58:59], v[58:59], v[14:15], v[12:13]
    v_mfma_f32_16x16x32_bf16 v[156:159], v[28:31], v[90:93], v[156:159]
    v_pk_fma_f32 v[60:61], v[60:61], v[14:15], v[12:13]
    v_pk_fma_f32 v[62:63], v[62:63], v[14:15], v[12:13]
    v_pk_fma_f32 v[64:65], v[64:65], v[14:15], v[12:13]
    v_pk_fma_f32 v[66:67], v[66:67], v[14:15], v[12:13]
    v_pk_fma_f32 v[68:69], v[68:69], v[14:15], v[12:13]
    v_mfma_f32_16x16x32_bf16 v[160:163], v[32:35], v[90:93], v[160:163]
    v_pk_fma_f32 v[70:71], v[70:71], v[14:15], v[12:13]
    v_pk_mul_f32 v[56:57], v[56:57], v[120:121]
    v_pk_mul_f32 v[58:59], v[58:59], v[122:123]
    v_pk_mul_f32 v[60:61], v[60:61], v[124:125]
    v_pk_mul_f32 v[62:63], v[62:63], v[126:127]
    v_mfma_f32_16x16x32_bf16 v[164:167], v[36:39], v[90:93], v[164:167]
    v_pk_mul_f32 v[64:65], v[64:65], v[128:129]
    v_pk_mul_f32 v[66:67], v[66:67], v[130:131]
    v_pk_mul_f32 v[68:69], v[68:69], v[132:133]
    v_pk_mul_f32 v[70:71], v[70:71], v[134:135]
    v_exp_f32 v56, v56
    v_mfma_f32_16x16x32_bf16 v[168:171], v[40:43], v[90:93], v[168:171]
    v_exp_f32 v57, v57
    v_exp_f32 v58, v58
    v_exp_f32 v59, v59
    v_exp_f32 v60, v60
    v_exp_f32 v61, v61
    v_mfma_f32_16x16x32_bf16 v[172:175], v[44:47], v[90:93], v[172:175]
    v_exp_f32 v62, v62
    v_exp_f32 v63, v63
    v_exp_f32 v64, v64
    v_exp_f32 v65, v65
    v_exp_f32 v66, v66
    v_mfma_f32_16x16x32_bf16 v[176:179], v[48:51], v[90:93], v[176:179]
    v_exp_f32 v67, v67
    v_exp_f32 v68, v68
    v_exp_f32 v69, v69
    v_exp_f32 v70, v70
    v_exp_f32 v71, v71
    v_mfma_f32_16x16x32_bf16 v[180:183], v[52:55], v[90:93], v[180:183]
    v_pk_mul_f32 v[120:121], v[120:121], v[136:137]
    v_pk_mul_f32 v[122:123], v[122:123], v[138:139]
    v_pk_mul_f32 v[124:125], v[124:125], v[140:141]
    v_pk_mul_f32 v[126:127], v[126:127], v[142:143]
    v_pk_mul_f32 v[128:129], v[128:129], v[144:145]
    v_pk_mul_f32 v[130:131], v[130:131], v[146:147]
    v_pk_mul_f32 v[132:133], v[132:133], v[148:149]
    v_pk_mul_f32 v[134:135], v[134:135], v[150:151]
    v_pk_fma_f32 v[56:57], v[56:57], v[16:17], v[16:17]
    v_pk_fma_f32 v[58:59], v[58:59], v[16:17], v[16:17]
    v_pk_fma_f32 v[60:61], v[60:61], v[16:17], v[16:17]
    v_pk_fma_f32 v[62:63], v[62:63], v[16:17], v[16:17]
    v_pk_fma_f32 v[64:65], v[64:65], v[16:17], v[16:17]
    v_pk_fma_f32 v[66:67], v[66:67], v[16:17], v[16:17]
    v_pk_fma_f32 v[68:69], v[68:69], v[16:17], v[16:17]
    v_pk_fma_f32 v[70:71], v[70:71], v[16:17], v[16:17]
    v_rcp_f32 v56, v56
    v_rcp_f32 v57, v57
    v_rcp_f32 v58, v58
    v_rcp_f32 v59, v59
    v_rcp_f32 v60, v60
    v_rcp_f32 v61, v61
    v_rcp_f32 v62, v62
    v_rcp_f32 v63, v63
    v_rcp_f32 v64, v64
    v_rcp_f32 v65, v65
    v_rcp_f32 v66, v66
    v_rcp_f32 v67, v67
    v_rcp_f32 v68, v68
    v_rcp_f32 v69, v69
    v_rcp_f32 v70, v70
    v_rcp_f32 v71, v71
    v_pk_mul_f32 v[120:121], v[120:121], v[56:57]
    v_pk_mul_f32 v[122:123], v[122:123], v[58:59]
    v_pk_mul_f32 v[124:125], v[124:125], v[60:61]
    v_pk_mul_f32 v[126:127], v[126:127], v[62:63]
    v_pk_mul_f32 v[128:129], v[128:129], v[64:65]
    v_pk_mul_f32 v[130:131], v[130:131], v[66:67]
    v_pk_mul_f32 v[132:133], v[132:133], v[68:69]
    v_pk_mul_f32 v[134:135], v[134:135], v[70:71]
    v_cvt_pk_bf16_f32 v136, v120, v121
    v_cvt_pk_bf16_f32 v137, v122, v123
    v_cvt_pk_bf16_f32 v138, v124, v125
    v_cvt_pk_bf16_f32 v139, v126, v127
    v_cvt_pk_bf16_f32 v140, v128, v129
    v_cvt_pk_bf16_f32 v141, v130, v131
    v_cvt_pk_bf16_f32 v142, v132, v133
    v_cvt_pk_bf16_f32 v143, v134, v135
    buffer_store_dwordx4 v[136:139], v4, s[24:27], s60 offen sc1
    buffer_store_dwordx4 v[140:143], v4, s[24:27], s60 offen offset:1024 sc1
    s_add_u32 s60, s60, 55296
    v_mul_f32 v16, v101, v101
    v_mul_f32 v12, 0xc0135761, v101
    v_mul_f32 v14, 0x3d372713, v16
    v_rcp_f32 v16, v16
    v_mul_f32 v14, v14, v12
    v_mov_b32 v13, v12
    v_mov_b32 v15, v14
    v_mov_b32 v17, v16
    v_pk_mul_f32 v[56:57], v[152:153], v[152:153]
    v_pk_mul_f32 v[58:59], v[154:155], v[154:155]
    v_pk_mul_f32 v[60:61], v[156:157], v[156:157]
    v_pk_mul_f32 v[62:63], v[158:159], v[158:159]
    v_pk_mul_f32 v[64:65], v[160:161], v[160:161]
    v_mfma_f32_16x16x32_bf16 v[184:187], v[24:27], v[92:95], v[184:187]
    v_pk_mul_f32 v[66:67], v[162:163], v[162:163]
    v_pk_mul_f32 v[68:69], v[164:165], v[164:165]
    v_pk_mul_f32 v[70:71], v[166:167], v[166:167]
    v_pk_fma_f32 v[56:57], v[56:57], v[14:15], v[12:13]
    v_pk_fma_f32 v[58:59], v[58:59], v[14:15], v[12:13]
    v_mfma_f32_16x16x32_bf16 v[188:191], v[28:31], v[92:95], v[188:191]
    v_pk_fma_f32 v[60:61], v[60:61], v[14:15], v[12:13]
    v_pk_fma_f32 v[62:63], v[62:63], v[14:15], v[12:13]
    v_pk_fma_f32 v[64:65], v[64:65], v[14:15], v[12:13]
    v_pk_fma_f32 v[66:67], v[66:67], v[14:15], v[12:13]
    v_pk_fma_f32 v[68:69], v[68:69], v[14:15], v[12:13]
    v_mfma_f32_16x16x32_bf16 v[192:195], v[32:35], v[92:95], v[192:195]
    s_branch L_ps_3_0
L_pw_a3_0:
    s_branch L_pw_a3_1
L_pw_b3_0:
    s_branch L_pw_b3_1
L_pw_c3_0:
    s_branch L_pw_c3_1
L_ps_3_0:
    v_pk_fma_f32 v[70:71], v[70:71], v[14:15], v[12:13]
    v_pk_mul_f32 v[56:57], v[56:57], v[152:153]
    v_pk_mul_f32 v[58:59], v[58:59], v[154:155]
    v_pk_mul_f32 v[60:61], v[60:61], v[156:157]
    v_pk_mul_f32 v[62:63], v[62:63], v[158:159]
    v_mfma_f32_16x16x32_bf16 v[196:199], v[36:39], v[92:95], v[196:199]
    v_pk_mul_f32 v[64:65], v[64:65], v[160:161]
    v_pk_mul_f32 v[66:67], v[66:67], v[162:163]
    v_pk_mul_f32 v[68:69], v[68:69], v[164:165]
    v_pk_mul_f32 v[70:71], v[70:71], v[166:167]
    v_exp_f32 v56, v56
    v_mfma_f32_16x16x32_bf16 v[200:203], v[40:43], v[92:95], v[200:203]
    v_exp_f32 v57, v57
    v_exp_f32 v58, v58
    v_exp_f32 v59, v59
    v_exp_f32 v60, v60
    v_exp_f32 v61, v61
    v_mfma_f32_16x16x32_bf16 v[204:207], v[44:47], v[92:95], v[204:207]
    v_exp_f32 v62, v62
    v_exp_f32 v63, v63
    v_exp_f32 v64, v64
    v_exp_f32 v65, v65
    v_exp_f32 v66, v66
    v_mfma_f32_16x16x32_bf16 v[208:211], v[48:51], v[92:95], v[208:211]
    v_exp_f32 v67, v67
    v_exp_f32 v68, v68
    v_exp_f32 v69, v69
    v_exp_f32 v70, v70
    v_exp_f32 v71, v71
    v_mfma_f32_16x16x32_bf16 v[212:215], v[52:55], v[92:95], v[212:215]
    v_pk_mul_f32 v[152:153], v[152:153], v[168:169]
    v_pk_mul_f32 v[154:155], v[154:155], v[170:171]
    v_pk_mul_f32 v[156:157], v[156:157], v[172:173]
    v_pk_mul_f32 v[158:159], v[158:159], v[174:175]
    v_pk_mul_f32 v[160:161], v[160:161], v[176:177]
    v_pk_mul_f32 v[162:163], v[162:163], v[178:179]
    v_pk_mul_f32 v[164:165], v[164:165], v[180:181]
    v_pk_mul_f32 v[166:167], v[166:167], v[182:183]
    v_pk_fma_f32 v[56:57], v[56:57], v[16:17], v[16:17]
    v_pk_fma_f32 v[58:59], v[58:59], v[16:17], v[16:17]
    v_pk_fma_f32 v[60:61], v[60:61], v[16:17], v[16:17]
    v_pk_fma_f32 v[62:63], v[62:63], v[16:17], v[16:17]
    v_pk_fma_f32 v[64:65], v[64:65], v[16:17], v[16:17]
    v_pk_fma_f32 v[66:67], v[66:67], v[16:17], v[16:17]
    v_pk_fma_f32 v[68:69], v[68:69], v[16:17], v[16:17]
    v_pk_fma_f32 v[70:71], v[70:71], v[16:17], v[16:17]
    v_rcp_f32 v56, v56
    v_rcp_f32 v57, v57
    v_rcp_f32 v58, v58
    v_rcp_f32 v59, v59
    v_rcp_f32 v60, v60
    v_rcp_f32 v61, v61
    v_rcp_f32 v62, v62
    v_rcp_f32 v63, v63
    v_rcp_f32 v64, v64
    v_rcp_f32 v65, v65
    v_rcp_f32 v66, v66
    v_rcp_f32 v67, v67
    v_rcp_f32 v68, v68
    v_rcp_f32 v69, v69
    v_rcp_f32 v70, v70
    v_rcp_f32 v71, v71
    v_pk_mul_f32 v[152:153], v[152:153], v[56:57]
    v_pk_mul_f32 v[154:155], v[154:155], v[58:59]
    v_pk_mul_f32 v[156:157], v[156:157], v[60:61]
    v_pk_mul_f32 v[158:159], v[158:159], v[62:63]
    v_pk_mul_f32 v[160:161], v[160:161], v[64:65]
    v_pk_mul_f32 v[162:163], v[162:163], v[66:67]
    v_pk_mul_f32 v[164:165], v[164:165], v[68:69]
    v_pk_mul_f32 v[166:167], v[166:167], v[70:71]
    v_cvt_pk_bf16_f32 v168, v152, v153
    v_cvt_pk_bf16_f32 v169, v154, v155
    v_cvt_pk_bf16_f32 v170, v156, v157
    v_cvt_pk_bf16_f32 v171, v158, v159
    v_cvt_pk_bf16_f32 v172, v160, v161
    v_cvt_pk_bf16_f32 v173, v162, v163
    v_cvt_pk_bf16_f32 v174, v164, v165
    v_cvt_pk_bf16_f32 v175, v166, v167
    buffer_store_dwordx4 v[168:171], v4, s[24:27], s60 offen sc1
    buffer_store_dwordx4 v[172:175], v4, s[24:27], s60 offen offset:1024 sc1
    s_add_u32 s60, s60, 55296
    v_mul_f32 v16, v102, v102
    v_mul_f32 v12, 0xc0135761, v102
    v_mul_f32 v14, 0x3d372713, v16
    v_rcp_f32 v16, v16
    v_mul_f32 v14, v14, v12
    v_mov_b32 v13, v12
    v_mov_b32 v15, v14
    v_mov_b32 v17, v16
    v_pk_mul_f32 v[56:57], v[184:185], v[184:185]
    v_pk_mul_f32 v[58:59], v[186:187], v[186:187]
    v_pk_mul_f32 v[60:61], v[188:189], v[188:189]
    v_pk_mul_f32 v[62:63], v[190:191], v[190:191]
    v_pk_mul_f32 v[64:65], v[192:193], v[192:193]
    v_mfma_f32_16x16x32_bf16 v[216:219], v[24:27], v[94:97], v[216:219]
    v_pk_mul_f32 v[66:67], v[194:195], v[194:195]
    v_pk_mul_f32 v[68:69], v[196:197], v[196:197]
    v_pk_mul_f32 v[70:71], v[198:199], v[198:199]
    v_pk_fma_f32 v[56:57], v[56:57], v[14:15], v[12:13]
    v_pk_fma_f32 v[58:59], v[58:59], v[14:15], v[12:13]
    v_mfma_f32_16x16x32_bf16 v[220:223], v[28:31], v[94:97], v[220:223]
    v_pk_fma_f32 v[60:61], v[60:61], v[14:15], v[12:13]
    v_pk_fma_f32 v[62:63], v[62:63], v[14:15], v[12:13]
    v_pk_fma_f32 v[64:65], v[64:65], v[14:15], v[12:13]
    v_pk_fma_f32 v[66:67], v[66:67], v[14:15], v[12:13]
    v_pk_fma_f32 v[68:69], v[68:69], v[14:15], v[12:13]
    v_mfma_f32_16x16x32_bf16 v[224:227], v[32:35], v[94:97], v[224:227]
    v_pk_fma_f32 v[70:71], v[70:71], v[14:15], v[12:13]
    v_pk_mul_f32 v[56:57], v[56:57], v[184:185]
    v_pk_mul_f32 v[58:59], v[58:59], v[186:187]
    v_pk_mul_f32 v[60:61], v[60:61], v[188:189]
    v_pk_mul_f32 v[62:63], v[62:63], v[190:191]
    v_mfma_f32_16x16x32_bf16 v[228:231], v[36:39], v[94:97], v[228:231]
    v_pk_mul_f32 v[64:65], v[64:65], v[192:193]
    v_pk_mul_f32 v[66:67], v[66:67], v[194:195]
    v_pk_mul_f32 v[68:69], v[68:69], v[196:197]
    v_pk_mul_f32 v[70:71], v[70:71], v[198:199]
    v_exp_f32 v56, v56
    v_mfma_f32_16x16x32_bf16 v[232:235], v[40:43], v[94:97], v[232:235]
    v_exp_f32 v57, v57
    v_exp_f32 v58, v58
    v_exp_f32 v59, v59
    v_exp_f32 v60, v60
    v_exp_f32 v61, v61
    v_mfma_f32_16x16x32_bf16 v[236:239], v[44:47], v[94:97], v[236:239]
    v_exp_f32 v62, v62
    v_exp_f32 v63, v63
    v_exp_f32 v64, v64
    v_exp_f32 v65, v65
    v_exp_f32 v66, v66
    v_mfma_f32_16x16x32_bf16 v[240:243], v[48:51], v[94:97], v[240:243]
    v_exp_f32 v67, v67
    v_exp_f32 v68, v68
    v_exp_f32 v69, v69
    v_exp_f32 v70, v70
    v_exp_f32 v71, v71
    v_mfma_f32_16x16x32_bf16 v[244:247], v[52:55], v[94:97], v[244:247]
    v_pk_mul_f32 v[184:185], v[184:185], v[200:201]
    v_pk_mul_f32 v[186:187], v[186:187], v[202:203]
    v_pk_mul_f32 v[188:189], v[188:189], v[204:205]
    v_pk_mul_f32 v[190:191], v[190:191], v[206:207]
    v_pk_mul_f32 v[192:193], v[192:193], v[208:209]
    v_pk_mul_f32 v[194:195], v[194:195], v[210:211]
    v_pk_mul_f32 v[196:197], v[196:197], v[212:213]
    v_pk_mul_f32 v[198:199], v[198:199], v[214:215]
    v_pk_fma_f32 v[56:57], v[56:57], v[16:17], v[16:17]
    v_pk_fma_f32 v[58:59], v[58:59], v[16:17], v[16:17]
    v_pk_fma_f32 v[60:61], v[60:61], v[16:17], v[16:17]
    v_pk_fma_f32 v[62:63], v[62:63], v[16:17], v[16:17]
    v_pk_fma_f32 v[64:65], v[64:65], v[16:17], v[16:17]
    v_pk_fma_f32 v[66:67], v[66:67], v[16:17], v[16:17]
    v_pk_fma_f32 v[68:69], v[68:69], v[16:17], v[16:17]
    v_pk_fma_f32 v[70:71], v[70:71], v[16:17], v[16:17]
    v_rcp_f32 v56, v56
    v_rcp_f32 v57, v57
    v_rcp_f32 v58, v58
    v_rcp_f32 v59, v59
    v_rcp_f32 v60, v60
    v_rcp_f32 v61, v61
    v_rcp_f32 v62, v62
    v_rcp_f32 v63, v63
    v_rcp_f32 v64, v64
    v_rcp_f32 v65, v65
    v_rcp_f32 v66, v66
    v_rcp_f32 v67, v67
    v_rcp_f32 v68, v68
    v_rcp_f32 v69, v69
    v_rcp_f32 v70, v70
    v_rcp_f32 v71, v71
    v_pk_mul_f32 v[184:185], v[184:185], v[56:57]
    v_pk_mul_f32 v[186:187], v[186:187], v[58:59]
    v_pk_mul_f32 v[188:189], v[188:189], v[60:61]
    v_pk_mul_f32 v[190:191], v[190:191], v[62:63]
    v_pk_mul_f32 v[192:193], v[192:193], v[64:65]
    v_pk_mul_f32 v[194:195], v[194:195], v[66:67]
    v_pk_mul_f32 v[196:197], v[196:197], v[68:69]
    v_pk_mul_f32 v[198:199], v[198:199], v[70:71]
    v_cvt_pk_bf16_f32 v200, v184, v185
    v_cvt_pk_bf16_f32 v201, v186, v187
    v_cvt_pk_bf16_f32 v202, v188, v189
    v_cvt_pk_bf16_f32 v203, v190, v191
    v_cvt_pk_bf16_f32 v204, v192, v193
    v_cvt_pk_bf16_f32 v205, v194, v195
    v_cvt_pk_bf16_f32 v206, v196, v197
    v_cvt_pk_bf16_f32 v207, v198, v199
    buffer_store_dwordx4 v[200:203], v4, s[24:27], s60 offen sc1
    buffer_store_dwordx4 v[204:207], v4, s[24:27], s60 offen offset:1024 sc1
    s_add_u32 s60, s60, 55296
    v_mul_f32 v16, v103, v103
    v_mul_f32 v12, 0xc0135761, v103
    v_mul_f32 v14, 0x3d372713, v16
    v_rcp_f32 v16, v16
    v_mul_f32 v14, v14, v12
    v_mov_b32 v13, v12
    v_mov_b32 v15, v14
    v_mov_b32 v17, v16
    v_pk_mul_f32 v[56:57], v[216:217], v[216:217]
    v_pk_mul_f32 v[58:59], v[218:219], v[218:219]
    v_pk_mul_f32 v[60:61], v[220:221], v[220:221]
    v_pk_mul_f32 v[62:63], v[222:223], v[222:223]
    v_pk_mul_f32 v[64:65], v[224:225], v[224:225]
    v_pk_mul_f32 v[66:67], v[226:227], v[226:227]
    v_pk_mul_f32 v[68:69], v[228:229], v[228:229]
    v_pk_mul_f32 v[70:71], v[230:231], v[230:231]
    v_pk_fma_f32 v[56:57], v[56:57], v[14:15], v[12:13]
    v_pk_fma_f32 v[58:59], v[58:59], v[14:15], v[12:13]
    v_pk_fma_f32 v[60:61], v[60:61], v[14:15], v[12:13]
    v_pk_fma_f32 v[62:63], v[62:63], v[14:15], v[12:13]
    v_pk_fma_f32 v[64:65], v[64:65], v[14:15], v[12:13]
    v_pk_fma_f32 v[66:67], v[66:67], v[14:15], v[12:13]
    v_pk_fma_f32 v[68:69], v[68:69], v[14:15], v[12:13]
    v_pk_fma_f32 v[70:71], v[70:71], v[14:15], v[12:13]
    v_pk_mul_f32 v[56:57], v[56:57], v[216:217]
    v_pk_mul_f32 v[58:59], v[58:59], v[218:219]
    v_pk_mul_f32 v[60:61], v[60:61], v[220:221]
    v_pk_mul_f32 v[62:63], v[62:63], v[222:223]
    v_pk_mul_f32 v[64:65], v[64:65], v[224:225]
    v_pk_mul_f32 v[66:67], v[66:67], v[226:227]
    v_pk_mul_f32 v[68:69], v[68:69], v[228:229]
    v_pk_mul_f32 v[70:71], v[70:71], v[230:231]
    v_exp_f32 v56, v56
    v_exp_f32 v57, v57
    v_exp_f32 v58, v58
    v_exp_f32 v59, v59
    v_exp_f32 v60, v60
    v_exp_f32 v61, v61
    v_exp_f32 v62, v62
    v_exp_f32 v63, v63
    v_exp_f32 v64, v64
    v_exp_f32 v65, v65
    v_exp_f32 v66, v66
    v_exp_f32 v67, v67
    v_exp_f32 v68, v68
    v_exp_f32 v69, v69
    v_exp_f32 v70, v70
    v_exp_f32 v71, v71
    v_pk_mul_f32 v[216:217], v[216:217], v[232:233]
    v_pk_mul_f32 v[218:219], v[218:219], v[234:235]
    v_pk_mul_f32 v[220:221], v[220:221], v[236:237]
    v_pk_mul_f32 v[222:223], v[222:223], v[238:239]
    v_pk_mul_f32 v[224:225], v[224:225], v[240:241]
    v_pk_mul_f32 v[226:227], v[226:227], v[242:243]
    v_pk_mul_f32 v[228:229], v[228:229], v[244:245]
    v_pk_mul_f32 v[230:231], v[230:231], v[246:247]
    v_pk_fma_f32 v[56:57], v[56:57], v[16:17], v[16:17]
    v_pk_fma_f32 v[58:59], v[58:59], v[16:17], v[16:17]
    v_pk_fma_f32 v[60:61], v[60:61], v[16:17], v[16:17]
    v_pk_fma_f32 v[62:63], v[62:63], v[16:17], v[16:17]
    v_pk_fma_f32 v[64:65], v[64:65], v[16:17], v[16:17]
    v_pk_fma_f32 v[66:67], v[66:67], v[16:17], v[16:17]
    v_pk_fma_f32 v[68:69], v[68:69], v[16:17], v[16:17]
    v_pk_fma_f32 v[70:71], v[70:71], v[16:17], v[16:17]
    v_rcp_f32 v56, v56
    v_rcp_f32 v57, v57
    v_rcp_f32 v58, v58
    v_rcp_f32 v59, v59
    v_rcp_f32 v60, v60
    v_rcp_f32 v61, v61
    v_rcp_f32 v62, v62
    v_rcp_f32 v63, v63
    v_rcp_f32 v64, v64
    v_rcp_f32 v65, v65
    v_rcp_f32 v66, v66
    v_rcp_f32 v67, v67
    v_rcp_f32 v68, v68
    v_rcp_f32 v69, v69
    v_rcp_f32 v70, v70
    v_rcp_f32 v71, v71
    v_pk_mul_f32 v[216:217], v[216:217], v[56:57]
    v_pk_mul_f32 v[218:219], v[218:219], v[58:59]
    v_pk_mul_f32 v[220:221], v[220:221], v[60:61]
    v_pk_mul_f32 v[222:223], v[222:223], v[62:63]
    v_pk_mul_f32 v[224:225], v[224:225], v[64:65]
    v_pk_mul_f32 v[226:227], v[226:227], v[66:67]
    v_pk_mul_f32 v[228:229], v[228:229], v[68:69]
    v_pk_mul_f32 v[230:231], v[230:231], v[70:71]
    v_cvt_pk_bf16_f32 v232, v216, v217
    v_cvt_pk_bf16_f32 v233, v218, v219
    v_cvt_pk_bf16_f32 v234, v220, v221
    v_cvt_pk_bf16_f32 v235, v222, v223
    v_cvt_pk_bf16_f32 v236, v224, v225
    v_cvt_pk_bf16_f32 v237, v226, v227
    v_cvt_pk_bf16_f32 v238, v228, v229
    v_cvt_pk_bf16_f32 v239, v230, v231
    buffer_store_dwordx4 v[232:235], v4, s[24:27], s60 offen sc1
    buffer_store_dwordx4 v[236:239], v4, s[24:27], s60 offen offset:1024 sc1
    s_lshl_b32 s60, s48, 7
    s_lshl_b32 s61, s49, 3
    s_add_u32 s60, s60, s61
    s_add_u32 s67, s60, 0x1d10000
    s_branch L_g2_end
L_g2_skip:
    s_setprio 0
    s_cmp_lg_u32 s44, 0
    s_cbranch_scc1 L_sk_tag
    v_mov_b32 v12, 0
    s_mov_b32 s3, 0
L_tag_21:
    buffer_load_dwordx2 v[16:17], v12, s[28:31], 0 offen offset:128 sc1
    s_add_u32 s3, s3, 1
    s_cmp_gt_u32 s3, 40000
    s_cbranch_scc1 L_end
    s_waitcnt vmcnt(0)
    v_readfirstlane_b32 s44, v16
    v_readfirstlane_b32 s45, v17
    s_nop 3
    s_cmp_eq_u32 s44, 0
    s_cbranch_scc1 L_tag_21
L_sk_tag:
    s_cmp_lt_u32 s47, 240
    s_cbranch_scc1 L_cs2_skip
    s_bfe_u32 s48, s47, 0x20001
    s_bfe_u32 s49, s47, 0x10003
    s_lshl_b32 s49, s49, 1
    s_and_b32 s60, s47, 1
    s_add_u32 s49, s49, s60
    s_add_u32 s49, s49, 4
    s_mul_i32 s60, s48, 7
    s_add_u32 s60, s60, s49
    s_cmp_ge_u32 s49, 7
    s_cbranch_scc1 L_cs2b_end
    s_cmp_ge_u32 s60, 27
    s_cbranch_scc1 L_cs2b_end
    s_lshl_b32 s50, s60, 7
    s_lshl_b32 s51, s60, 11
    s_add_u32 s51, s51, 0x1c20000
    s_mov_b32 s32, s12
    s_and_b32 s33, s13, 0xffff
    s_mov_b32 s34, 0x21c000
    s_mov_b32 s35, 0x00020000
    v_and_b32 v1, 63, v0
    v_lshrrev_b32 v2, 3, v1
    v_and_b32 v3, 7, v1
    v_mul_u32_u24 v2, 3456, v2
    v_lshl_add_u32 v3, v3, 4, v2
    s_and_b32 s60, s46, 1
    s_mul_i32 s60, s60, 1105920
    s_add_u32 s60, s60, s50
    s_cmp_lt_u32 s46, 2
    s_cbranch_scc1 L_cs_b_a
    s_mov_b32 s32, s14
    s_and_b32 s33, s15, 0xffff
    s_mov_b32 s34, 0x21c000
    s_mov_b32 s35, 0x00020000
L_cs_b_a:
    buffer_load_dwordx4 v[16:19], v3, s[32:35], s60 offen
    s_add_u32 s60, s60, 27648
    buffer_load_dwordx4 v[20:23], v3, s[32:35], s60 offen
    s_add_u32 s60, s60, 27648
    buffer_load_dwordx4 v[24:27], v3, s[32:35], s60 offen
    s_add_u32 s60, s60, 27648
    buffer_load_dwordx4 v[28:31], v3, s[32:35], s60 offen
    s_add_u32 s60, s60, 27648
    buffer_load_dwordx4 v[32:35], v3, s[32:35], s60 offen
    s_add_u32 s60, s60, 27648
    buffer_load_dwordx4 v[36:39], v3, s[32:35], s60 offen
    s_add_u32 s60, s60, 27648
    buffer_load_dwordx4 v[40:43], v3, s[32:35], s60 offen
    s_add_u32 s60, s60, 27648
    buffer_load_dwordx4 v[44:47], v3, s[32:35], s60 offen
    s_add_u32 s60, s60, 27648
    v_mov_b32 v240, 0
    v_mov_b32 v241, 0
    v_mov_b32 v242, 0
    v_mov_b32 v243, 0
    v_mov_b32 v244, 0
    v_mov_b32 v245, 0
    v_mov_b32 v246, 0
    v_mov_b32 v247, 0
    s_waitcnt vmcnt(7)
    buffer_load_dwordx4 v[48:51], v3, s[32:35], s60 offen
    s_add_u32 s60, s60, 27648
    v_lshlrev_b32 v6, 16, v16
    v_and_b32 v7, 0xffff0000, v16
    v_add_f32 v240, v240, v6
    v_add_f32 v241, v241, v7
    v_lshlrev_b32 v6, 16, v17
    v_and_b32 v7, 0xffff0000, v17
    v_add_f32 v242, v242, v6
    v_add_f32 v243, v243, v7
    v_lshlrev_b32 v6, 16, v18
    v_and_b32 v7, 0xffff0000, v18
    v_add_f32 v244, v244, v6
    v_add_f32 v245, v245, v7
    v_lshlrev_b32 v6, 16, v19
    v_and_b32 v7, 0xffff0000, v19
    v_add_f32 v246, v246, v6
    v_add_f32 v247, v247, v7
    s_waitcnt vmcnt(7)
    buffer_load_dwordx4 v[52:55], v3, s[32:35], s60 offen
    s_add_u32 s60, s60, 27648
    v_lshlrev_b32 v6, 16, v20
    v_and_b32 v7, 0xffff0000, v20
    v_add_f32 v240, v240, v6
    v_add_f32 v241, v241, v7
    v_lshlrev_b32 v6, 16, v21
    v_and_b32 v7, 0xffff0000, v21
    v_add_f32 v242, v242, v6
    v_add_f32 v243, v243, v7
    v_lshlrev_b32 v6, 16, v22
    v_and_b32 v7, 0xffff0000, v22
    v_add_f32 v244, v244, v6
    v_add_f32 v245, v245, v7
    v_lshlrev_b32 v6, 16, v23
    v_and_b32 v7, 0xffff0000, v23
    v_add_f32 v246, v246, v6
    v_add_f32 v247, v247, v7
    s_waitcnt vmcnt(7)
    buffer_load_dwordx4 v[56:59], v3, s[32:35], s60 offen
    s_add_u32 s60, s60, 27648
    v_lshlrev_b32 v6, 16, v24
    v_and_b32 v7, 0xffff0000, v24
    v_add_f32 v240, v240, v6
    v_add_f32 v241, v241, v7
    v_lshlrev_b32 v6, 16, v25
    v_and_b32 v7, 0xffff0000, v25
    v_add_f32 v242, v242, v6
    v_add_f32 v243, v243, v7
    v_lshlrev_b32 v6, 16, v26
    v_and_b32 v7, 0xffff0000, v26
    v_add_f32 v244, v244, v6
    v_add_f32 v245, v245, v7
    v_lshlrev_b32 v6, 16, v27
    v_and_b32 v7, 0xffff0000, v27
    v_add_f32 v246, v246, v6
    v_add_f32 v247, v247, v7
    s_waitcnt vmcnt(7)
    buffer_load_dwordx4 v[60:63], v3, s[32:35], s60 offen
    s_add_u32 s60, s60, 27648
    v_lshlrev_b32 v6, 16, v28
    v_and_b32 v7, 0xffff0000, v28
    v_add_f32 v240, v240, v6
    v_add_f32 v241, v241, v7
    v_lshlrev_b32 v6, 16, v29
    v_and_b32 v7, 0xffff0000, v29
    v_add_f32 v242, v242, v6
    v_add_f32 v243, v243, v7
    v_lshlrev_b32 v6, 16, v30
    v_and_b32 v7, 0xffff0000, v30
    v_add_f32 v244, v244, v6
    v_add_f32 v245, v245, v7
    v_lshlrev_b32 v6, 16, v31
    v_and_b32 v7, 0xffff0000, v31
    v_add_f32 v246, v246, v6
    v_add_f32 v247, v247, v7
    s_waitcnt vmcnt(7)
    buffer_load_dwordx4 v[64:67], v3, s[32:35], s60 offen
    s_add_u32 s60, s60, 27648
    v_lshlrev_b32 v6, 16, v32
    v_and_b32 v7, 0xffff0000, v32
    v_add_f32 v240, v240, v6
    v_add_f32 v241, v241, v7
    v_lshlrev_b32 v6, 16, v33
    v_and_b32 v7, 0xffff0000, v33
    v_add_f32 v242, v242, v6
    v_add_f32 v243, v243, v7
    v_lshlrev_b32 v6, 16, v34
    v_and_b32 v7, 0xffff0000, v34
    v_add_f32 v244, v244, v6
    v_add_f32 v245, v245, v7
    v_lshlrev_b32 v6, 16, v35
    v_and_b32 v7, 0xffff0000, v35
    v_add_f32 v246, v246, v6
    v_add_f32 v247, v247, v7
    s_waitcnt vmcnt(7)
    buffer_load_dwordx4 v[68:71], v3, s[32:35], s60 offen
    s_add_u32 s60, s60, 27648
    v_lshlrev_b32 v6, 16, v36
    v_and_b32 v7, 0xffff0000, v36
    v_add_f32 v240, v240, v6
    v_add_f32 v241, v241, v7
    v_lshlrev_b32 v6, 16, v37
    v_and_b32 v7, 0xffff0000, v37
    v_add_f32 v242, v242, v6
    v_add_f32 v243, v243, v7
    v_lshlrev_b32 v6, 16, v38
    v_and_b32 v7, 0xffff0000, v38
    v_add_f32 v244, v244, v6
    v_add_f32 v245, v245, v7
    v_lshlrev_b32 v6, 16, v39
    v_and_b32 v7, 0xffff0000, v39
    v_add_f32 v246, v246, v6
    v_add_f32 v247, v247, v7
    s_waitcnt vmcnt(7)
    buffer_load_dwordx4 v[72:75], v3, s[32:35], s60 offen
    s_add_u32 s60, s60, 27648
    v_lshlrev_b32 v6, 16, v40
    v_and_b32 v7, 0xffff0000, v40
    v_add_f32 v240, v240, v6
    v_add_f32 v241, v241, v7
    v_lshlrev_b32 v6, 16, v41
    v_and_b32 v7, 0xffff0000, v41
    v_add_f32 v242, v242, v6
    v_add_f32 v243, v243, v7
    v_lshlrev_b32 v6, 16, v42
    v_and_b32 v7, 0xffff0000, v42
    v_add_f32 v244, v244, v6
    v_add_f32 v245, v245, v7
    v_lshlrev_b32 v6, 16, v43
    v_and_b32 v7, 0xffff0000, v43
    v_add_f32 v246, v246, v6
    v_add_f32 v247, v247, v7
    s_waitcnt vmcnt(7)
    buffer_load_dwordx4 v[76:79], v3, s[32:35], s60 offen
    s_add_u32 s60, s60, 27648
    v_lshlrev_b32 v6, 16, v44
    v_and_b32 v7, 0xffff0000, v44
    v_add_f32 v240, v240, v6
    v_add_f32 v241, v241, v7
    v_lshlrev_b32 v6, 16, v45
    v_and_b32 v7, 0xffff0000, v45
    v_add_f32 v242, v242, v6
    v_add_f32 v243, v243, v7
    v_lshlrev_b32 v6, 16, v46
    v_and_b32 v7, 0xffff0000, v46
    v_add_f32 v244, v244, v6
    v_add_f32 v245, v245, v7
    v_lshlrev_b32 v6, 16, v47
    v_and_b32 v7, 0xffff0000, v47
    v_add_f32 v246, v246, v6
    v_add_f32 v247, v247, v7
    s_waitcnt vmcnt(7)
    buffer_load_dwordx4 v[80:83], v3, s[32:35], s60 offen
    s_add_u32 s60, s60, 27648
    v_lshlrev_b32 v6, 16, v48
    v_and_b32 v7, 0xffff0000, v48
    v_add_f32 v240, v240, v6
    v_add_f32 v241, v241, v7
    v_lshlrev_b32 v6, 16, v49
    v_and_b32 v7, 0xffff0000, v49
    v_add_f32 v242, v242, v6
    v_add_f32 v243, v243, v7
    v_lshlrev_b32 v6, 16, v50
    v_and_b32 v7, 0xffff0000, v50
    v_add_f32 v244, v244, v6
    v_add_f32 v245, v245, v7
    v_lshlrev_b32 v6, 16, v51
    v_and_b32 v7, 0xffff0000, v51
    v_add_f32 v246, v246, v6
    v_add_f32 v247, v247, v7
    s_waitcnt vmcnt(7)
    buffer_load_dwordx4 v[84:87], v3, s[32:35], s60 offen
    s_add_u32 s60, s60, 27648
    v_lshlrev_b32 v6, 16, v52
    v_and_b32 v7, 0xffff0000, v52
    v_add_f32 v240, v240, v6
    v_add_f32 v241, v241, v7
    v_lshlrev_b32 v6, 16, v53
    v_and_b32 v7, 0xffff0000, v53
    v_add_f32 v242, v242, v6
    v_add_f32 v243, v243, v7
    v_lshlrev_b32 v6, 16, v54
    v_and_b32 v7, 0xffff0000, v54
    v_add_f32 v244, v244, v6
    v_add_f32 v245, v245, v7
    v_lshlrev_b32 v6, 16, v55
    v_and_b32 v7, 0xffff0000, v55
    v_add_f32 v246, v246, v6
    v_add_f32 v247, v247, v7
    s_waitcnt vmcnt(7)
    buffer_load_dwordx4 v[88:91], v3, s[32:35], s60 offen
    s_add_u32 s60, s60, 27648
    v_lshlrev_b32 v6, 16, v56
    v_and_b32 v7, 0xffff0000, v56
    v_add_f32 v240, v240, v6
    v_add_f32 v241, v241, v7
    v_lshlrev_b32 v6, 16, v57
    v_and_b32 v7, 0xffff0000, v57
    v_add_f32 v242, v242, v6
    v_add_f32 v243, v243, v7
    v_lshlrev_b32 v6, 16, v58
    v_and_b32 v7, 0xffff0000, v58
    v_add_f32 v244, v244, v6
    v_add_f32 v245, v245, v7
    v_lshlrev_b32 v6, 16, v59
    v_and_b32 v7, 0xffff0000, v59
    v_add_f32 v246, v246, v6
    v_add_f32 v247, v247, v7
    s_waitcnt vmcnt(7)
    buffer_load_dwordx4 v[92:95], v3, s[32:35], s60 offen
    s_add_u32 s60, s60, 27648
    v_lshlrev_b32 v6, 16, v60
    v_and_b32 v7, 0xffff0000, v60
    v_add_f32 v240, v240, v6
    v_add_f32 v241, v241, v7
    v_lshlrev_b32 v6, 16, v61
    v_and_b32 v7, 0xffff0000, v61
    v_add_f32 v242, v242, v6
    v_add_f32 v243, v243, v7
    v_lshlrev_b32 v6, 16, v62
    v_and_b32 v7, 0xffff0000, v62
    v_add_f32 v244, v244, v6
    v_add_f32 v245, v245, v7
    v_lshlrev_b32 v6, 16, v63
    v_and_b32 v7, 0xffff0000, v63
    v_add_f32 v246, v246, v6
    v_add_f32 v247, v247, v7
    s_waitcnt vmcnt(7)
    buffer_load_dwordx4 v[96:99], v3, s[32:35], s60 offen
    s_add_u32 s60, s60, 27648
    v_lshlrev_b32 v6, 16, v64
    v_and_b32 v7, 0xffff0000, v64
    v_add_f32 v240, v240, v6
    v_add_f32 v241, v241, v7
    v_lshlrev_b32 v6, 16, v65
    v_and_b32 v7, 0xffff0000, v65
    v_add_f32 v242, v242, v6
    v_add_f32 v243, v243, v7
    v_lshlrev_b32 v6, 16, v66
    v_and_b32 v7, 0xffff0000, v66
    v_add_f32 v244, v244, v6
    v_add_f32 v245, v245, v7
    v_lshlrev_b32 v6, 16, v67
    v_and_b32 v7, 0xffff0000, v67
    v_add_f32 v246, v246, v6
    v_add_f32 v247, v247, v7
    s_waitcnt vmcnt(7)
    buffer_load_dwordx4 v[100:103], v3, s[32:35], s60 offen
    s_add_u32 s60, s60, 27648
    v_lshlrev_b32 v6, 16, v68
    v_and_b32 v7, 0xffff0000, v68
    v_add_f32 v240, v240, v6
    v_add_f32 v241, v241, v7
    v_lshlrev_b32 v6, 16, v69
    v_and_b32 v7, 0xffff0000, v69
    v_add_f32 v242, v242, v6
    v_add_f32 v243, v243, v7
    v_lshlrev_b32 v6, 16, v70
    v_and_b32 v7, 0xffff0000, v70
    v_add_f32 v244, v244, v6
    v_add_f32 v245, v245, v7
    v_lshlrev_b32 v6, 16, v71
    v_and_b32 v7, 0xffff0000, v71
    v_add_f32 v246, v246, v6
    v_add_f32 v247, v247, v7
    s_waitcnt vmcnt(7)
    buffer_load_dwordx4 v[104:107], v3, s[32:35], s60 offen
    s_add_u32 s60, s60, 27648
    v_lshlrev_b32 v6, 16, v72
    v_and_b32 v7, 0xffff0000, v72
    v_add_f32 v240, v240, v6
    v_add_f32 v241, v241, v7
    v_lshlrev_b32 v6, 16, v73
    v_and_b32 v7, 0xffff0000, v73
    v_add_f32 v242, v242, v6
    v_add_f32 v243, v243, v7
    v_lshlrev_b32 v6, 16, v74
    v_and_b32 v7, 0xffff0000, v74
    v_add_f32 v244, v244, v6
    v_add_f32 v245, v245, v7
    v_lshlrev_b32 v6, 16, v75
    v_and_b32 v7, 0xffff0000, v75
    v_add_f32 v246, v246, v6
    v_add_f32 v247, v247, v7
    s_waitcnt vmcnt(7)
    buffer_load_dwordx4 v[108:111], v3, s[32:35], s60 offen
    s_add_u32 s60, s60, 27648
    v_lshlrev_b32 v6, 16, v76
    v_and_b32 v7, 0xffff0000, v76
    v_add_f32 v240, v240, v6
    v_add_f32 v241, v241, v7
    v_lshlrev_b32 v6, 16, v77
    v_and_b32 v7, 0xffff0000, v77
    v_add_f32 v242, v242, v6
    v_add_f32 v243, v243, v7
    v_lshlrev_b32 v6, 16, v78
    v_and_b32 v7, 0xffff0000, v78
    v_add_f32 v244, v244, v6
    v_add_f32 v245, v245, v7
    v_lshlrev_b32 v6, 16, v79
    v_and_b32 v7, 0xffff0000, v79
    v_add_f32 v246, v246, v6
    v_add_f32 v247, v247, v7
    s_waitcnt vmcnt(7)
    buffer_load_dwordx4 v[112:115], v3, s[32:35], s60 offen
    s_add_u32 s60, s60, 27648
    v_lshlrev_b32 v6, 16, v80
    v_and_b32 v7, 0xffff0000, v80
    v_add_f32 v240, v240, v6
    v_add_f32 v241, v241, v7
    v_lshlrev_b32 v6, 16, v81
    v_and_b32 v7, 0xffff0000, v81
    v_add_f32 v242, v242, v6
    v_add_f32 v243, v243, v7
    v_lshlrev_b32 v6, 16, v82
    v_and_b32 v7, 0xffff0000, v82
    v_add_f32 v244, v244, v6
    v_add_f32 v245, v245, v7
    v_lshlrev_b32 v6, 16, v83
    v_and_b32 v7, 0xffff0000, v83
    v_add_f32 v246, v246, v6
    v_add_f32 v247, v247, v7
    s_waitcnt vmcnt(7)
    buffer_load_dwordx4 v[116:119], v3, s[32:35], s60 offen
    s_add_u32 s60, s60, 27648
    v_lshlrev_b32 v6, 16, v84
    v_and_b32 v7, 0xffff0000, v84
    v_add_f32 v240, v240, v6
    v_add_f32 v241, v241, v7
    v_lshlrev_b32 v6, 16, v85
    v_and_b32 v7, 0xffff0000, v85
    v_add_f32 v242, v242, v6
    v_add_f32 v243, v243, v7
    v_lshlrev_b32 v6, 16, v86
    v_and_b32 v7, 0xffff0000, v86
    v_add_f32 v244, v244, v6
    v_add_f32 v245, v245, v7
    v_lshlrev_b32 v6, 16, v87
    v_and_b32 v7, 0xffff0000, v87
    v_add_f32 v246, v246, v6
    v_add_f32 v247, v247, v7
    s_waitcnt vmcnt(7)
    buffer_load_dwordx4 v[120:123], v3, s[32:35], s60 offen
    s_add_u32 s60, s60, 27648
    v_lshlrev_b32 v6, 16, v88
    v_and_b32 v7, 0xffff0000, v88
    v_add_f32 v240, v240, v6
    v_add_f32 v241, v241, v7
    v_lshlrev_b32 v6, 16, v89
    v_and_b32 v7, 0xffff0000, v89
    v_add_f32 v242, v242, v6
    v_add_f32 v243, v243, v7
    v_lshlrev_b32 v6, 16, v90
    v_and_b32 v7, 0xffff0000, v90
    v_add_f32 v244, v244, v6
    v_add_f32 v245, v245, v7
    v_lshlrev_b32 v6, 16, v91
    v_and_b32 v7, 0xffff0000, v91
    v_add_f32 v246, v246, v6
    v_add_f32 v247, v247, v7
    s_waitcnt vmcnt(7)
    buffer_load_dwordx4 v[124:127], v3, s[32:35], s60 offen
    s_add_u32 s60, s60, 27648
    v_lshlrev_b32 v6, 16, v92
    v_and_b32 v7, 0xffff0000, v92
    v_add_f32 v240, v240, v6
    v_add_f32 v241, v241, v7
    v_lshlrev_b32 v6, 16, v93
    v_and_b32 v7, 0xffff0000, v93
    v_add_f32 v242, v242, v6
    v_add_f32 v243, v243, v7
    v_lshlrev_b32 v6, 16, v94
    v_and_b32 v7, 0xffff0000, v94
    v_add_f32 v244, v244, v6
    v_add_f32 v245, v245, v7
    v_lshlrev_b32 v6, 16, v95
    v_and_b32 v7, 0xffff0000, v95
    v_add_f32 v246, v246, v6
    v_add_f32 v247, v247, v7
    s_waitcnt vmcnt(7)
    buffer_load_dwordx4 v[128:131], v3, s[32:35], s60 offen
    s_add_u32 s60, s60, 27648
    v_lshlrev_b32 v6, 16, v96
    v_and_b32 v7, 0xffff0000, v96
    v_add_f32 v240, v240, v6
    v_add_f32 v241, v241, v7
    v_lshlrev_b32 v6, 16, v97
    v_and_b32 v7, 0xffff0000, v97
    v_add_f32 v242, v242, v6
    v_add_f32 v243, v243, v7
    v_lshlrev_b32 v6, 16, v98
    v_and_b32 v7, 0xffff0000, v98
    v_add_f32 v244, v244, v6
    v_add_f32 v245, v245, v7
    v_lshlrev_b32 v6, 16, v99
    v_and_b32 v7, 0xffff0000, v99
    v_add_f32 v246, v246, v6
    v_add_f32 v247, v247, v7
    s_waitcnt vmcnt(7)
    buffer_load_dwordx4 v[132:135], v3, s[32:35], s60 offen
    s_add_u32 s60, s60, 27648
    v_lshlrev_b32 v6, 16, v100
    v_and_b32 v7, 0xffff0000, v100
    v_add_f32 v240, v240, v6
    v_add_f32 v241, v241, v7
    v_lshlrev_b32 v6, 16, v101
    v_and_b32 v7, 0xffff0000, v101
    v_add_f32 v242, v242, v6
    v_add_f32 v243, v243, v7
    v_lshlrev_b32 v6, 16, v102
    v_and_b32 v7, 0xffff0000, v102
    v_add_f32 v244, v244, v6
    v_add_f32 v245, v245, v7
    v_lshlrev_b32 v6, 16, v103
    v_and_b32 v7, 0xffff0000, v103
    v_add_f32 v246, v246, v6
    v_add_f32 v247, v247, v7
    s_waitcnt vmcnt(7)
    buffer_load_dwordx4 v[136:139], v3, s[32:35], s60 offen
    s_add_u32 s60, s60, 27648
    v_lshlrev_b32 v6, 16, v104
    v_and_b32 v7, 0xffff0000, v104
    v_add_f32 v240, v240, v6
    v_add_f32 v241, v241, v7
    v_lshlrev_b32 v6, 16, v105
    v_and_b32 v7, 0xffff0000, v105
    v_add_f32 v242, v242, v6
    v_add_f32 v243, v243, v7
    v_lshlrev_b32 v6, 16, v106
    v_and_b32 v7, 0xffff0000, v106
    v_add_f32 v244, v244, v6
    v_add_f32 v245, v245, v7
    v_lshlrev_b32 v6, 16, v107
    v_and_b32 v7, 0xffff0000, v107
    v_add_f32 v246, v246, v6
    v_add_f32 v247, v247, v7
    s_waitcnt vmcnt(7)
    buffer_load_dwordx4 v[140:143], v3, s[32:35], s60 offen
    s_add_u32 s60, s60, 27648
    v_lshlrev_b32 v6, 16, v108
    v_and_b32 v7, 0xffff0000, v108
    v_add_f32 v240, v240, v6
    v_add_f32 v241, v241, v7
    v_lshlrev_b32 v6, 16, v109
    v_and_b32 v7, 0xffff0000, v109
    v_add_f32 v242, v242, v6
    v_add_f32 v243, v243, v7
    v_lshlrev_b32 v6, 16, v110
    v_and_b32 v7, 0xffff0000, v110
    v_add_f32 v244, v244, v6
    v_add_f32 v245, v245, v7
    v_lshlrev_b32 v6, 16, v111
    v_and_b32 v7, 0xffff0000, v111
    v_add_f32 v246, v246, v6
    v_add_f32 v247, v247, v7
    s_waitcnt vmcnt(7)
    buffer_load_dwordx4 v[144:147], v3, s[32:35], s60 offen
    s_add_u32 s60, s60, 27648
    v_lshlrev_b32 v6, 16, v112
    v_and_b32 v7, 0xffff0000, v112
    v_add_f32 v240, v240, v6
    v_add_f32 v241, v241, v7
    v_lshlrev_b32 v6, 16, v113
    v_and_b32 v7, 0xffff0000, v113
    v_add_f32 v242, v242, v6
    v_add_f32 v243, v243, v7
    v_lshlrev_b32 v6, 16, v114
    v_and_b32 v7, 0xffff0000, v114
    v_add_f32 v244, v244, v6
    v_add_f32 v245, v245, v7
    v_lshlrev_b32 v6, 16, v115
    v_and_b32 v7, 0xffff0000, v115
    v_add_f32 v246, v246, v6
    v_add_f32 v247, v247, v7
    s_waitcnt vmcnt(7)
    buffer_load_dwordx4 v[148:151], v3, s[32:35], s60 offen
    s_add_u32 s60, s60, 27648
    v_lshlrev_b32 v6, 16, v116
    v_and_b32 v7, 0xffff0000, v116
    v_add_f32 v240, v240, v6
    v_add_f32 v241, v241, v7
    v_lshlrev_b32 v6, 16, v117
    v_and_b32 v7, 0xffff0000, v117
    v_add_f32 v242, v242, v6
    v_add_f32 v243, v243, v7
    v_lshlrev_b32 v6, 16, v118
    v_and_b32 v7, 0xffff0000, v118
    v_add_f32 v244, v244, v6
    v_add_f32 v245, v245, v7
    v_lshlrev_b32 v6, 16, v119
    v_and_b32 v7, 0xffff0000, v119
    v_add_f32 v246, v246, v6
    v_add_f32 v247, v247, v7
    s_waitcnt vmcnt(7)
    buffer_load_dwordx4 v[152:155], v3, s[32:35], s60 offen
    s_add_u32 s60, s60, 27648
    v_lshlrev_b32 v6, 16, v120
    v_and_b32 v7, 0xffff0000, v120
    v_add_f32 v240, v240, v6
    v_add_f32 v241, v241, v7
    v_lshlrev_b32 v6, 16, v121
    v_and_b32 v7, 0xffff0000, v121
    v_add_f32 v242, v242, v6
    v_add_f32 v243, v243, v7
    v_lshlrev_b32 v6, 16, v122
    v_and_b32 v7, 0xffff0000, v122
    v_add_f32 v244, v244, v6
    v_add_f32 v245, v245, v7
    v_lshlrev_b32 v6, 16, v123
    v_and_b32 v7, 0xffff0000, v123
    v_add_f32 v246, v246, v6
    v_add_f32 v247, v247, v7
    s_waitcnt vmcnt(7)
    buffer_load_dwordx4 v[156:159], v3, s[32:35], s60 offen
    s_add_u32 s60, s60, 27648
    v_lshlrev_b32 v6, 16, v124
    v_and_b32 v7, 0xffff0000, v124
    v_add_f32 v240, v240, v6
    v_add_f32 v241, v241, v7
    v_lshlrev_b32 v6, 16, v125
    v_and_b32 v7, 0xffff0000, v125
    v_add_f32 v242, v242, v6
    v_add_f32 v243, v243, v7
    v_lshlrev_b32 v6, 16, v126
    v_and_b32 v7, 0xffff0000, v126
    v_add_f32 v244, v244, v6
    v_add_f32 v245, v245, v7
    v_lshlrev_b32 v6, 16, v127
    v_and_b32 v7, 0xffff0000, v127
    v_add_f32 v246, v246, v6
    v_add_f32 v247, v247, v7
    s_waitcnt vmcnt(7)
    buffer_load_dwordx4 v[160:163], v3, s[32:35], s60 offen
    s_add_u32 s60, s60, 27648
    v_lshlrev_b32 v6, 16, v128
    v_and_b32 v7, 0xffff0000, v128
    v_add_f32 v240, v240, v6
    v_add_f32 v241, v241, v7
    v_lshlrev_b32 v6, 16, v129
    v_and_b32 v7, 0xffff0000, v129
    v_add_f32 v242, v242, v6
    v_add_f32 v243, v243, v7
    v_lshlrev_b32 v6, 16, v130
    v_and_b32 v7, 0xffff0000, v130
    v_add_f32 v244, v244, v6
    v_add_f32 v245, v245, v7
    v_lshlrev_b32 v6, 16, v131
    v_and_b32 v7, 0xffff0000, v131
    v_add_f32 v246, v246, v6
    v_add_f32 v247, v247, v7
    s_waitcnt vmcnt(7)
    buffer_load_dwordx4 v[164:167], v3, s[32:35], s60 offen
    s_add_u32 s60, s60, 27648
    v_lshlrev_b32 v6, 16, v132
    v_and_b32 v7, 0xffff0000, v132
    v_add_f32 v240, v240, v6
    v_add_f32 v241, v241, v7
    v_lshlrev_b32 v6, 16, v133
    v_and_b32 v7, 0xffff0000, v133
    v_add_f32 v242, v242, v6
    v_add_f32 v243, v243, v7
    v_lshlrev_b32 v6, 16, v134
    v_and_b32 v7, 0xffff0000, v134
    v_add_f32 v244, v244, v6
    v_add_f32 v245, v245, v7
    v_lshlrev_b32 v6, 16, v135
    v_and_b32 v7, 0xffff0000, v135
    v_add_f32 v246, v246, v6
    v_add_f32 v247, v247, v7
    s_waitcnt vmcnt(7)
    buffer_load_dwordx4 v[168:171], v3, s[32:35], s60 offen
    s_add_u32 s60, s60, 27648
    v_lshlrev_b32 v6, 16, v136
    v_and_b32 v7, 0xffff0000, v136
    v_add_f32 v240, v240, v6
    v_add_f32 v241, v241, v7
    v_lshlrev_b32 v6, 16, v137
    v_and_b32 v7, 0xffff0000, v137
    v_add_f32 v242, v242, v6
    v_add_f32 v243, v243, v7
    v_lshlrev_b32 v6, 16, v138
    v_and_b32 v7, 0xffff0000, v138
    v_add_f32 v244, v244, v6
    v_add_f32 v245, v245, v7
    v_lshlrev_b32 v6, 16, v139
    v_and_b32 v7, 0xffff0000, v139
    v_add_f32 v246, v246, v6
    v_add_f32 v247, v247, v7
    s_waitcnt vmcnt(7)
    buffer_load_dwordx4 v[172:175], v3, s[32:35], s60 offen
    s_add_u32 s60, s60, 27648
    v_lshlrev_b32 v6, 16, v140
    v_and_b32 v7, 0xffff0000, v140
    v_add_f32 v240, v240, v6
    v_add_f32 v241, v241, v7
    v_lshlrev_b32 v6, 16, v141
    v_and_b32 v7, 0xffff0000, v141
    v_add_f32 v242, v242, v6
    v_add_f32 v243, v243, v7
    v_lshlrev_b32 v6, 16, v142
    v_and_b32 v7, 0xffff0000, v142
    v_add_f32 v244, v244, v6
    v_add_f32 v245, v245, v7
    v_lshlrev_b32 v6, 16, v143
    v_and_b32 v7, 0xffff0000, v143
    v_add_f32 v246, v246, v6
    v_add_f32 v247, v247, v7
    s_waitcnt vmcnt(7)
    v_lshlrev_b32 v6, 16, v144
    v_and_b32 v7, 0xffff0000, v144
    v_add_f32 v240, v240, v6
    v_add_f32 v241, v241, v7
    v_lshlrev_b32 v6, 16, v145
    v_and_b32 v7, 0xffff0000, v145
    v_add_f32 v242, v242, v6
    v_add_f32 v243, v243, v7
    v_lshlrev_b32 v6, 16, v146
    v_and_b32 v7, 0xffff0000, v146
    v_add_f32 v244, v244, v6
    v_add_f32 v245, v245, v7
    v_lshlrev_b32 v6, 16, v147
    v_and_b32 v7, 0xffff0000, v147
    v_add_f32 v246, v246, v6
    v_add_f32 v247, v247, v7
    s_waitcnt vmcnt(6)
    v_lshlrev_b32 v6, 16, v148
    v_and_b32 v7, 0xffff0000, v148
    v_add_f32 v240, v240, v6
    v_add_f32 v241, v241, v7
    v_lshlrev_b32 v6, 16, v149
    v_and_b32 v7, 0xffff0000, v149
    v_add_f32 v242, v242, v6
    v_add_f32 v243, v243, v7
    v_lshlrev_b32 v6, 16, v150
    v_and_b32 v7, 0xffff0000, v150
    v_add_f32 v244, v244, v6
    v_add_f32 v245, v245, v7
    v_lshlrev_b32 v6, 16, v151
    v_and_b32 v7, 0xffff0000, v151
    v_add_f32 v246, v246, v6
    v_add_f32 v247, v247, v7
    s_waitcnt vmcnt(5)
    v_lshlrev_b32 v6, 16, v152
    v_and_b32 v7, 0xffff0000, v152
    v_add_f32 v240, v240, v6
    v_add_f32 v241, v241, v7
    v_lshlrev_b32 v6, 16, v153
    v_and_b32 v7, 0xffff0000, v153
    v_add_f32 v242, v242, v6
    v_add_f32 v243, v243, v7
    v_lshlrev_b32 v6, 16, v154
    v_and_b32 v7, 0xffff0000, v154
    v_add_f32 v244, v244, v6
    v_add_f32 v245, v245, v7
    v_lshlrev_b32 v6, 16, v155
    v_and_b32 v7, 0xffff0000, v155
    v_add_f32 v246, v246, v6
    v_add_f32 v247, v247, v7
    s_waitcnt vmcnt(4)
    v_lshlrev_b32 v6, 16, v156
    v_and_b32 v7, 0xffff0000, v156
    v_add_f32 v240, v240, v6
    v_add_f32 v241, v241, v7
    v_lshlrev_b32 v6, 16, v157
    v_and_b32 v7, 0xffff0000, v157
    v_add_f32 v242, v242, v6
    v_add_f32 v243, v243, v7
    v_lshlrev_b32 v6, 16, v158
    v_and_b32 v7, 0xffff0000, v158
    v_add_f32 v244, v244, v6
    v_add_f32 v245, v245, v7
    v_lshlrev_b32 v6, 16, v159
    v_and_b32 v7, 0xffff0000, v159
    v_add_f32 v246, v246, v6
    v_add_f32 v247, v247, v7
    s_waitcnt vmcnt(3)
    v_lshlrev_b32 v6, 16, v160
    v_and_b32 v7, 0xffff0000, v160
    v_add_f32 v240, v240, v6
    v_add_f32 v241, v241, v7
    v_lshlrev_b32 v6, 16, v161
    v_and_b32 v7, 0xffff0000, v161
    v_add_f32 v242, v242, v6
    v_add_f32 v243, v243, v7
    v_lshlrev_b32 v6, 16, v162
    v_and_b32 v7, 0xffff0000, v162
    v_add_f32 v244, v244, v6
    v_add_f32 v245, v245, v7
    v_lshlrev_b32 v6, 16, v163
    v_and_b32 v7, 0xffff0000, v163
    v_add_f32 v246, v246, v6
    v_add_f32 v247, v247, v7
    s_waitcnt vmcnt(2)
    v_lshlrev_b32 v6, 16, v164
    v_and_b32 v7, 0xffff0000, v164
    v_add_f32 v240, v240, v6
    v_add_f32 v241, v241, v7
    v_lshlrev_b32 v6, 16, v165
    v_and_b32 v7, 0xffff0000, v165
    v_add_f32 v242, v242, v6
    v_add_f32 v243, v243, v7
    v_lshlrev_b32 v6, 16, v166
    v_and_b32 v7, 0xffff0000, v166
    v_add_f32 v244, v244, v6
    v_add_f32 v245, v245, v7
    v_lshlrev_b32 v6, 16, v167
    v_and_b32 v7, 0xffff0000, v167
    v_add_f32 v246, v246, v6
    v_add_f32 v247, v247, v7
    s_waitcnt vmcnt(1)
    v_lshlrev_b32 v6, 16, v168
    v_and_b32 v7, 0xffff0000, v168
    v_add_f32 v240, v240, v6
    v_add_f32 v241, v241, v7
    v_lshlrev_b32 v6, 16, v169
    v_and_b32 v7, 0xffff0000, v169
    v_add_f32 v242, v242, v6
    v_add_f32 v243, v243, v7
    v_lshlrev_b32 v6, 16, v170
    v_and_b32 v7, 0xffff0000, v170
    v_add_f32 v244, v244, v6
    v_add_f32 v245, v245, v7
    v_lshlrev_b32 v6, 16, v171
    v_and_b32 v7, 0xffff0000, v171
    v_add_f32 v246, v246, v6
    v_add_f32 v247, v247, v7
    s_waitcnt vmcnt(0)
    v_lshlrev_b32 v6, 16, v172
    v_and_b32 v7, 0xffff0000, v172
    v_add_f32 v240, v240, v6
    v_add_f32 v241, v241, v7
    v_lshlrev_b32 v6, 16, v173
    v_and_b32 v7, 0xffff0000, v173
    v_add_f32 v242, v242, v6
    v_add_f32 v243, v243, v7
    v_lshlrev_b32 v6, 16, v174
    v_and_b32 v7, 0xffff0000, v174
    v_add_f32 v244, v244, v6
    v_add_f32 v245, v245, v7
    v_lshlrev_b32 v6, 16, v175
    v_and_b32 v7, 0xffff0000, v175
    v_add_f32 v246, v246, v6
    v_add_f32 v247, v247, v7
    v_lshlrev_b32 v4, 5, v0
    ds_write_b128 v4, v[240:243]
    ds_write_b128 v4, v[244:247] offset:16
    v_lshlrev_b32 v4, 2, v1
    s_lshl_b32 s60, s46, 11
    v_add_u32 v5, s60, v4
    s_waitcnt lgkmcnt(0)
    ds_read_b32 v16, v5 offset:0
    ds_read_b32 v17, v5 offset:256
    ds_read_b32 v18, v5 offset:512
    ds_read_b32 v19, v5 offset:768
    ds_read_b32 v20, v5 offset:1024
    ds_read_b32 v21, v5 offset:1280
    ds_read_b32 v22, v5 offset:1536
    ds_read_b32 v23, v5 offset:1792
    s_waitcnt lgkmcnt(0)
    v_add_f32 v16, v16, v20
    v_add_f32 v17, v17, v21
    v_add_f32 v18, v18, v22
    v_add_f32 v19, v19, v23
    v_add_f32 v16, v16, v18
    v_add_f32 v17, v17, v19
    v_add_f32 v16, v16, v17
    v_lshlrev_b32 v5, 2, v0
    ds_write_b32 v5, v16 offset:8192
    s_waitcnt lgkmcnt(0)
    s_barrier
    s_bitcmp1_b32 s46, 0
    s_cbranch_scc1 L_cs_b_done
    ds_read_b32 v16, v5 offset:8192
    ds_read_b32 v17, v5 offset:8448
    s_waitcnt lgkmcnt(0)
    v_add_f32 v16, v16, v17
    v_cvt_pk_bf16_f32 v17, v16, v16
    v_and_b32 v17, 0xffff0000, v17
    v_sub_f32 v17, v16, v17
    v_cvt_pk_bf16_f32 v18, v17, v17
    v_and_b32 v18, 0xffff0000, v18
    v_sub_f32 v18, v17, v18
    v_cvt_pk_bf16_f32 v16, v16, v17
    v_cvt_pk_bf16_f32 v17, v18, 0
    v_mov_b32 v18, s44
    v_mov_b32 v19, s45
    s_lshl_b32 s60, s46, 9
    s_add_u32 s60, s60, s51
    v_lshlrev_b32 v4, 4, v1
    buffer_store_dwordx4 v[16:19], v4, s[24:27], s60 offen sc1
L_cs_b_done:
    s_barrier
L_cs2b_end:
L_cs2_skip:
    s_setprio 3
    v_and_b32 v1, 63, v0
    s_sub_u32 s55, s47, 216
    s_lshl_b32 s55, s55, 1
    s_lshr_b32 s60, s46, 1
    s_add_u32 s55, s55, s60
    s_mov_b32 s36, s16
    s_and_b32 s37, s17, 0xffff
    s_mov_b32 s38, 0x21c000
    s_mov_b32 s39, 0x00020000
    s_mov_b32 s56, 10240
    s_mov_b32 s57, 5120
    s_mov_b32 s58, 20480
    s_mul_i32 s52, s55, 40960
    s_cmp_lt_u32 s55, 54
    s_cbranch_scc1 L_rp_go
    s_mov_b32 s36, s8
    s_and_b32 s37, s9, 0xffff
    s_mov_b32 s38, 0xc8000
    s_mov_b32 s39, 0x00020000
    s_mov_b32 s56, 25600
    s_mov_b32 s58, 10240
    s_sub_u32 s60, s55, 54
    s_mul_i32 s52, s60, 51200
    s_cmp_lt_u32 s55, 70
    s_cbranch_scc1 L_rp_go
    s_mov_b32 s56, 102400
    s_mov_b32 s57, 25600
    s_mov_b32 s58, 51200
    s_sub_u32 s60, s55, 70
    s_mul_i32 s52, s60, 204800
    s_add_u32 s52, s52, 20480
L_rp_go:
    s_and_b32 s60, s46, 1
    s_mul_i32 s61, s60, 640
    s_add_u32 s52, s52, s61
    s_mul_i32 s53, s46, 20480
    v_add_u32 v12, 0, v1
    v_mul_u32_u24 v13, 1639, v12
    v_lshrrev_b32 v13, 16, v13
    v_mul_u32_u24 v14, 40, v13
    v_sub_u32 v12, v12, v14
    v_lshlrev_b32 v12, 4, v12
    v_and_b32 v14, 3, v13
    v_mul_u32_u24 v14, 1280, v14
    v_add_u32 v12, v12, v14
    v_bfe_u32 v14, v13, 4, 1
    v_mad_u32_u24 v12, v14, s56, v12
    v_bfe_u32 v14, v13, 2, 1
    v_mad_u32_u24 v12, v14, s57, v12
    v_bfe_u32 v14, v13, 3, 1
    v_mad_u32_u24 v12, v14, s58, v12
    v_mov_b32 v200, v12
    v_add_u32 v12, 64, v1
    v_mul_u32_u24 v13, 1639, v12
    v_lshrrev_b32 v13, 16, v13
    v_mul_u32_u24 v14, 40, v13
    v_sub_u32 v12, v12, v14
    v_lshlrev_b32 v12, 4, v12
    v_and_b32 v14, 3, v13
    v_mul_u32_u24 v14, 1280, v14
    v_add_u32 v12, v12, v14
    v_bfe_u32 v14, v13, 4, 1
    v_mad_u32_u24 v12, v14, s56, v12
    v_bfe_u32 v14, v13, 2, 1
    v_mad_u32_u24 v12, v14, s57, v12
    v_bfe_u32 v14, v13, 3, 1
    v_mad_u32_u24 v12, v14, s58, v12
    v_mov_b32 v201, v12
    v_add_u32 v12, 128, v1
    v_mul_u32_u24 v13, 1639, v12
    v_lshrrev_b32 v13, 16, v13
    v_mul_u32_u24 v14, 40, v13
    v_sub_u32 v12, v12, v14
    v_lshlrev_b32 v12, 4, v12
    v_and_b32 v14, 3, v13
    v_mul_u32_u24 v14, 1280, v14
    v_add_u32 v12, v12, v14
    v_bfe_u32 v14, v13, 4, 1
    v_mad_u32_u24 v12, v14, s56, v12
    v_bfe_u32 v14, v13, 2, 1
    v_mad_u32_u24 v12, v14, s57, v12
    v_bfe_u32 v14, v13, 3, 1
    v_mad_u32_u24 v12, v14, s58, v12
    v_mov_b32 v202, v12
    v_add_u32 v12, 192, v1
    v_mul_u32_u24 v13, 1639, v12
    v_lshrrev_b32 v13, 16, v13
    v_mul_u32_u24 v14, 40, v13
    v_sub_u32 v12, v12, v14
    v_lshlrev_b32 v12, 4, v12
    v_and_b32 v14, 3, v13
    v_mul_u32_u24 v14, 1280, v14
    v_add_u32 v12, v12, v14
    v_bfe_u32 v14, v13, 4, 1
    v_mad_u32_u24 v12, v14, s56, v12
    v_bfe_u32 v14, v13, 2, 1
    v_mad_u32_u24 v12, v14, s57, v12
    v_bfe_u32 v14, v13, 3, 1
    v_mad_u32_u24 v12, v14, s58, v12
    v_mov_b32 v203, v12
    v_add_u32 v12, 256, v1
    v_mul_u32_u24 v13, 1639, v12
    v_lshrrev_b32 v13, 16, v13
    v_mul_u32_u24 v14, 40, v13
    v_sub_u32 v12, v12, v14
    v_lshlrev_b32 v12, 4, v12
    v_and_b32 v14, 3, v13
    v_mul_u32_u24 v14, 1280, v14
    v_add_u32 v12, v12, v14
    v_bfe_u32 v14, v13, 4, 1
    v_mad_u32_u24 v12, v14, s56, v12
    v_bfe_u32 v14, v13, 2, 1
    v_mad_u32_u24 v12, v14, s57, v12
    v_bfe_u32 v14, v13, 3, 1
    v_mad_u32_u24 v12, v14, s58, v12
    v_mov_b32 v204, v12
    v_add_u32 v12, 320, v1
    v_mul_u32_u24 v13, 1639, v12
    v_lshrrev_b32 v13, 16, v13
    v_mul_u32_u24 v14, 40, v13
    v_sub_u32 v12, v12, v14
    v_lshlrev_b32 v12, 4, v12
    v_and_b32 v14, 3, v13
    v_mul_u32_u24 v14, 1280, v14
    v_add_u32 v12, v12, v14
    v_bfe_u32 v14, v13, 4, 1
    v_mad_u32_u24 v12, v14, s56, v12
    v_bfe_u32 v14, v13, 2, 1
    v_mad_u32_u24 v12, v14, s57, v12
    v_bfe_u32 v14, v13, 3, 1
    v_mad_u32_u24 v12, v14, s58, v12
    v_mov_b32 v205, v12
    v_add_u32 v12, 384, v1
    v_mul_u32_u24 v13, 1639, v12
    v_lshrrev_b32 v13, 16, v13
    v_mul_u32_u24 v14, 40, v13
    v_sub_u32 v12, v12, v14
    v_lshlrev_b32 v12, 4, v12
    v_and_b32 v14, 3, v13
    v_mul_u32_u24 v14, 1280, v14
    v_add_u32 v12, v12, v14
    v_bfe_u32 v14, v13, 4, 1
    v_mad_u32_u24 v12, v14, s56, v12
    v_bfe_u32 v14, v13, 2, 1
    v_mad_u32_u24 v12, v14, s57, v12
    v_bfe_u32 v14, v13, 3, 1
    v_mad_u32_u24 v12, v14, s58, v12
    v_mov_b32 v206, v12
    v_add_u32 v12, 448, v1
    v_mul_u32_u24 v13, 1639, v12
    v_lshrrev_b32 v13, 16, v13
    v_mul_u32_u24 v14, 40, v13
    v_sub_u32 v12, v12, v14
    v_lshlrev_b32 v12, 4, v12
    v_and_b32 v14, 3, v13
    v_mul_u32_u24 v14, 1280, v14
    v_add_u32 v12, v12, v14
    v_bfe_u32 v14, v13, 4, 1
    v_mad_u32_u24 v12, v14, s56, v12
    v_bfe_u32 v14, v13, 2, 1
    v_mad_u32_u24 v12, v14, s57, v12
    v_bfe_u32 v14, v13, 3, 1
    v_mad_u32_u24 v12, v14, s58, v12
    v_mov_b32 v207, v12
    v_add_u32 v12, 512, v1
    v_mul_u32_u24 v13, 1639, v12
    v_lshrrev_b32 v13, 16, v13
    v_mul_u32_u24 v14, 40, v13
    v_sub_u32 v12, v12, v14
    v_lshlrev_b32 v12, 4, v12
    v_and_b32 v14, 3, v13
    v_mul_u32_u24 v14, 1280, v14
    v_add_u32 v12, v12, v14
    v_bfe_u32 v14, v13, 4, 1
    v_mad_u32_u24 v12, v14, s56, v12
    v_bfe_u32 v14, v13, 2, 1
    v_mad_u32_u24 v12, v14, s57, v12
    v_bfe_u32 v14, v13, 3, 1
    v_mad_u32_u24 v12, v14, s58, v12
    v_mov_b32 v208, v12
    v_add_u32 v12, 576, v1
    v_mul_u32_u24 v13, 1639, v12
    v_lshrrev_b32 v13, 16, v13
    v_mul_u32_u24 v14, 40, v13
    v_sub_u32 v12, v12, v14
    v_lshlrev_b32 v12, 4, v12
    v_and_b32 v14, 3, v13
    v_mul_u32_u24 v14, 1280, v14
    v_add_u32 v12, v12, v14
    v_bfe_u32 v14, v13, 4, 1
    v_mad_u32_u24 v12, v14, s56, v12
    v_bfe_u32 v14, v13, 2, 1
    v_mad_u32_u24 v12, v14, s57, v12
    v_bfe_u32 v14, v13, 3, 1
    v_mad_u32_u24 v12, v14, s58, v12
    v_mov_b32 v209, v12
    v_add_u32 v12, 640, v1
    v_mul_u32_u24 v13, 1639, v12
    v_lshrrev_b32 v13, 16, v13
    v_mul_u32_u24 v14, 40, v13
    v_sub_u32 v12, v12, v14
    v_lshlrev_b32 v12, 4, v12
    v_and_b32 v14, 3, v13
    v_mul_u32_u24 v14, 1280, v14
    v_add_u32 v12, v12, v14
    v_bfe_u32 v14, v13, 4, 1
    v_mad_u32_u24 v12, v14, s56, v12
    v_bfe_u32 v14, v13, 2, 1
    v_mad_u32_u24 v12, v14, s57, v12
    v_bfe_u32 v14, v13, 3, 1
    v_mad_u32_u24 v12, v14, s58, v12
    v_mov_b32 v210, v12
    v_add_u32 v12, 704, v1
    v_mul_u32_u24 v13, 1639, v12
    v_lshrrev_b32 v13, 16, v13
    v_mul_u32_u24 v14, 40, v13
    v_sub_u32 v12, v12, v14
    v_lshlrev_b32 v12, 4, v12
    v_and_b32 v14, 3, v13
    v_mul_u32_u24 v14, 1280, v14
    v_add_u32 v12, v12, v14
    v_bfe_u32 v14, v13, 4, 1
    v_mad_u32_u24 v12, v14, s56, v12
    v_bfe_u32 v14, v13, 2, 1
    v_mad_u32_u24 v12, v14, s57, v12
    v_bfe_u32 v14, v13, 3, 1
    v_mad_u32_u24 v12, v14, s58, v12
    v_mov_b32 v211, v12
    v_add_u32 v12, 768, v1
    v_mul_u32_u24 v13, 1639, v12
    v_lshrrev_b32 v13, 16, v13
    v_mul_u32_u24 v14, 40, v13
    v_sub_u32 v12, v12, v14
    v_lshlrev_b32 v12, 4, v12
    v_and_b32 v14, 3, v13
    v_mul_u32_u24 v14, 1280, v14
    v_add_u32 v12, v12, v14
    v_bfe_u32 v14, v13, 4, 1
    v_mad_u32_u24 v12, v14, s56, v12
    v_bfe_u32 v14, v13, 2, 1
    v_mad_u32_u24 v12, v14, s57, v12
    v_bfe_u32 v14, v13, 3, 1
    v_mad_u32_u24 v12, v14, s58, v12
    v_mov_b32 v212, v12
    v_add_u32 v12, 832, v1
    v_mul_u32_u24 v13, 1639, v12
    v_lshrrev_b32 v13, 16, v13
    v_mul_u32_u24 v14, 40, v13
    v_sub_u32 v12, v12, v14
    v_lshlrev_b32 v12, 4, v12
    v_and_b32 v14, 3, v13
    v_mul_u32_u24 v14, 1280, v14
    v_add_u32 v12, v12, v14
    v_bfe_u32 v14, v13, 4, 1
    v_mad_u32_u24 v12, v14, s56, v12
    v_bfe_u32 v14, v13, 2, 1
    v_mad_u32_u24 v12, v14, s57, v12
    v_bfe_u32 v14, v13, 3, 1
    v_mad_u32_u24 v12, v14, s58, v12
    v_mov_b32 v213, v12
    v_add_u32 v12, 896, v1
    v_mul_u32_u24 v13, 1639, v12
    v_lshrrev_b32 v13, 16, v13
    v_mul_u32_u24 v14, 40, v13
    v_sub_u32 v12, v12, v14
    v_lshlrev_b32 v12, 4, v12
    v_and_b32 v14, 3, v13
    v_mul_u32_u24 v14, 1280, v14
    v_add_u32 v12, v12, v14
    v_bfe_u32 v14, v13, 4, 1
    v_mad_u32_u24 v12, v14, s56, v12
    v_bfe_u32 v14, v13, 2, 1
    v_mad_u32_u24 v12, v14, s57, v12
    v_bfe_u32 v14, v13, 3, 1
    v_mad_u32_u24 v12, v14, s58, v12
    v_mov_b32 v214, v12
    v_add_u32 v12, 960, v1
    v_mul_u32_u24 v13, 1639, v12
    v_lshrrev_b32 v13, 16, v13
    v_mul_u32_u24 v14, 40, v13
    v_sub_u32 v12, v12, v14
    v_lshlrev_b32 v12, 4, v12
    v_and_b32 v14, 3, v13
    v_mul_u32_u24 v14, 1280, v14
    v_add_u32 v12, v12, v14
    v_bfe_u32 v14, v13, 4, 1
    v_mad_u32_u24 v12, v14, s56, v12
    v_bfe_u32 v14, v13, 2, 1
    v_mad_u32_u24 v12, v14, s57, v12
    v_bfe_u32 v14, v13, 3, 1
    v_mad_u32_u24 v12, v14, s58, v12
    v_mov_b32 v215, v12
    v_add_u32 v12, 1024, v1
    v_mul_u32_u24 v13, 1639, v12
    v_lshrrev_b32 v13, 16, v13
    v_mul_u32_u24 v14, 40, v13
    v_sub_u32 v12, v12, v14
    v_lshlrev_b32 v12, 4, v12
    v_and_b32 v14, 3, v13
    v_mul_u32_u24 v14, 1280, v14
    v_add_u32 v12, v12, v14
    v_bfe_u32 v14, v13, 4, 1
    v_mad_u32_u24 v12, v14, s56, v12
    v_bfe_u32 v14, v13, 2, 1
    v_mad_u32_u24 v12, v14, s57, v12
    v_bfe_u32 v14, v13, 3, 1
    v_mad_u32_u24 v12, v14, s58, v12
    v_mov_b32 v216, v12
    v_add_u32 v12, 1088, v1
    v_mul_u32_u24 v13, 1639, v12
    v_lshrrev_b32 v13, 16, v13
    v_mul_u32_u24 v14, 40, v13
    v_sub_u32 v12, v12, v14
    v_lshlrev_b32 v12, 4, v12
    v_and_b32 v14, 3, v13
    v_mul_u32_u24 v14, 1280, v14
    v_add_u32 v12, v12, v14
    v_bfe_u32 v14, v13, 4, 1
    v_mad_u32_u24 v12, v14, s56, v12
    v_bfe_u32 v14, v13, 2, 1
    v_mad_u32_u24 v12, v14, s57, v12
    v_bfe_u32 v14, v13, 3, 1
    v_mad_u32_u24 v12, v14, s58, v12
    v_mov_b32 v217, v12
    v_add_u32 v12, 1152, v1
    v_mul_u32_u24 v13, 1639, v12
    v_lshrrev_b32 v13, 16, v13
    v_mul_u32_u24 v14, 40, v13
    v_sub_u32 v12, v12, v14
    v_lshlrev_b32 v12, 4, v12
    v_and_b32 v14, 3, v13
    v_mul_u32_u24 v14, 1280, v14
    v_add_u32 v12, v12, v14
    v_bfe_u32 v14, v13, 4, 1
    v_mad_u32_u24 v12, v14, s56, v12
    v_bfe_u32 v14, v13, 2, 1
    v_mad_u32_u24 v12, v14, s57, v12
    v_bfe_u32 v14, v13, 3, 1
    v_mad_u32_u24 v12, v14, s58, v12
    v_mov_b32 v218, v12
    v_add_u32 v12, 1216, v1
    v_mul_u32_u24 v13, 1639, v12
    v_lshrrev_b32 v13, 16, v13
    v_mul_u32_u24 v14, 40, v13
    v_sub_u32 v12, v12, v14
    v_lshlrev_b32 v12, 4, v12
    v_and_b32 v14, 3, v13
    v_mul_u32_u24 v14, 1280, v14
    v_add_u32 v12, v12, v14
    v_bfe_u32 v14, v13, 4, 1
    v_mad_u32_u24 v12, v14, s56, v12
    v_bfe_u32 v14, v13, 2, 1
    v_mad_u32_u24 v12, v14, s57, v12
    v_bfe_u32 v14, v13, 3, 1
    v_mad_u32_u24 v12, v14, s58, v12
    v_mov_b32 v219, v12
    v_lshrrev_b32 v12, 5, v1
    v_bfe_u32 v13, v1, 4, 1
    v_lshlrev_b32 v12, 4, v12
    v_lshl_add_u32 v12, v13, 2, v12
    v_bfe_u32 v13, v1, 2, 2
    v_add_u32 v12, v12, v13
    v_mul_u32_u24 v12, 640, v12
    v_and_b32 v13, 3, v1
    v_lshl_add_u32 v12, v13, 3, v12
    v_add_u32 v220, s53, v12
    v_lshlrev_b32 v221, 4, v1
    s_mul_i32 s61, s55, 40960
    s_mul_i32 s60, s60, 20480
    s_add_u32 s60, s60, s61
    s_add_u32 s54, s60, 0x2000000
    s_setprio 0
    s_cmp_ge_u32 s47, 240
    s_cbranch_scc1 L_rp_nh
    s_cmp_lg_u32 s46, 0
    s_cbranch_scc1 L_hint_23
    s_lshl_b32 s60, s47, 7
    s_add_u32 s60, s60, 0x1d04040
    v_mov_b32 v16, 0
    s_mov_b32 s3, 0
L_hint_22:
    s_sleep 4
    buffer_load_dword v17, v16, s[24:27], s60 offen sc1
    s_add_u32 s3, s3, 1
    s_cmp_gt_u32 s3, 60
    s_cbranch_scc1 L_hint_23
    s_waitcnt vmcnt(0)
    v_readfirstlane_b32 s61, v17
    s_nop 3
    s_sub_u32 s61, s61, s95
    s_cmp_gt_u32 s61, 1000
    s_cbranch_scc1 L_hint_22
L_hint_23:
    s_waitcnt vmcnt(0)
L_rp_nh:
    s_barrier
    s_setprio 3
    s_cmp_ge_u32 s47, 253
    s_cbranch_scc1 L_rp_done
    s_add_u32 m0, s53, 0
    s_nop 0
    buffer_load_dwordx4 v200, s[36:39], s52 offen lds
    s_add_u32 m0, s53, 1024
    s_nop 0
    buffer_load_dwordx4 v201, s[36:39], s52 offen lds
    s_add_u32 m0, s53, 2048
    s_nop 0
    buffer_load_dwordx4 v202, s[36:39], s52 offen lds
    s_add_u32 m0, s53, 3072
    s_nop 0
    buffer_load_dwordx4 v203, s[36:39], s52 offen lds
    s_add_u32 m0, s53, 4096
    s_nop 0
    buffer_load_dwordx4 v204, s[36:39], s52 offen lds
    s_add_u32 m0, s53, 5120
    s_nop 0
    buffer_load_dwordx4 v205, s[36:39], s52 offen lds
    s_add_u32 m0, s53, 6144
    s_nop 0
    buffer_load_dwordx4 v206, s[36:39], s52 offen lds
    s_add_u32 m0, s53, 7168
    s_nop 0
    buffer_load_dwordx4 v207, s[36:39], s52 offen lds
    s_add_u32 m0, s53, 8192
    s_nop 0
    buffer_load_dwordx4 v208, s[36:39], s52 offen lds
    s_add_u32 m0, s53, 9216
    s_nop 0
    buffer_load_dwordx4 v209, s[36:39], s52 offen lds
    s_add_u32 m0, s53, 10240
    s_nop 0
    buffer_load_dwordx4 v210, s[36:39], s52 offen lds
    s_add_u32 m0, s53, 11264
    s_nop 0
    buffer_load_dwordx4 v211, s[36:39], s52 offen lds
    s_add_u32 m0, s53, 12288
    s_nop 0
    buffer_load_dwordx4 v212, s[36:39], s52 offen lds
    s_add_u32 m0, s53, 13312
    s_nop 0
    buffer_load_dwordx4 v213, s[36:39], s52 offen lds
    s_add_u32 m0, s53, 14336
    s_nop 0
    buffer_load_dwordx4 v214, s[36:39], s52 offen lds
    s_add_u32 m0, s53, 15360
    s_nop 0
    buffer_load_dwordx4 v215, s[36:39], s52 offen lds
    s_add_u32 m0, s53, 16384
    s_nop 0
    buffer_load_dwordx4 v216, s[36:39], s52 offen lds
    s_add_u32 m0, s53, 17408
    s_nop 0
    buffer_load_dwordx4 v217, s[36:39], s52 offen lds
    s_add_u32 m0, s53, 18432
    s_nop 0
    buffer_load_dwordx4 v218, s[36:39], s52 offen lds
    s_add_u32 m0, s53, 19456
    s_nop 0
    buffer_load_dwordx4 v219, s[36:39], s52 offen lds
    s_mov_b32 s60, s54
    s_waitcnt vmcnt(0)
    ds_read_b64_tr_b16 v[24:25], v220 offset:0
    ds_read_b64_tr_b16 v[26:27], v220 offset:5120
    ds_read_b64_tr_b16 v[28:29], v220 offset:32
    ds_read_b64_tr_b16 v[30:31], v220 offset:5152
    ds_read_b64_tr_b16 v[32:33], v220 offset:64
    ds_read_b64_tr_b16 v[34:35], v220 offset:5184
    ds_read_b64_tr_b16 v[36:37], v220 offset:96
    ds_read_b64_tr_b16 v[38:39], v220 offset:5216
    ds_read_b64_tr_b16 v[40:41], v220 offset:128
    ds_read_b64_tr_b16 v[42:43], v220 offset:5248
    ds_read_b64_tr_b16 v[44:45], v220 offset:160
    ds_read_b64_tr_b16 v[46:47], v220 offset:5280
    ds_read_b64_tr_b16 v[48:49], v220 offset:192
    ds_read_b64_tr_b16 v[50:51], v220 offset:5312
    ds_read_b64_tr_b16 v[52:53], v220 offset:224
    ds_read_b64_tr_b16 v[54:55], v220 offset:5344
    ds_read_b64_tr_b16 v[56:57], v220 offset:256
    ds_read_b64_tr_b16 v[58:59], v220 offset:5376
    ds_read_b64_tr_b16 v[60:61], v220 offset:288
    ds_read_b64_tr_b16 v[62:63], v220 offset:5408
    ds_read_b64_tr_b16 v[64:65], v220 offset:320
    ds_read_b64_tr_b16 v[66:67], v220 offset:5440
    ds_read_b64_tr_b16 v[68:69], v220 offset:352
    ds_read_b64_tr_b16 v[70:71], v220 offset:5472
    ds_read_b64_tr_b16 v[72:73], v220 offset:384
    ds_read_b64_tr_b16 v[74:75], v220 offset:5504
    ds_read_b64_tr_b16 v[76:77], v220 offset:416
    ds_read_b64_tr_b16 v[78:79], v220 offset:5536
    ds_read_b64_tr_b16 v[80:81], v220 offset:448
    ds_read_b64_tr_b16 v[82:83], v220 offset:5568
    ds_read_b64_tr_b16 v[84:85], v220 offset:480
    ds_read_b64_tr_b16 v[86:87], v220 offset:5600
    ds_read_b64_tr_b16 v[88:89], v220 offset:512
    ds_read_b64_tr_b16 v[90:91], v220 offset:5632
    ds_read_b64_tr_b16 v[92:93], v220 offset:544
    ds_read_b64_tr_b16 v[94:95], v220 offset:5664
    ds_read_b64_tr_b16 v[96:97], v220 offset:576
    ds_read_b64_tr_b16 v[98:99], v220 offset:5696
    ds_read_b64_tr_b16 v[100:101], v220 offset:608
    ds_read_b64_tr_b16 v[102:103], v220 offset:5728
    s_waitcnt lgkmcnt(0)
    buffer_store_dwordx4 v[24:27], v221, s[24:27], s60 offen offset:0 sc1
    buffer_store_dwordx4 v[28:31], v221, s[24:27], s60 offen offset:1024 sc1
    buffer_store_dwordx4 v[32:35], v221, s[24:27], s60 offen offset:2048 sc1
    buffer_store_dwordx4 v[36:39], v221, s[24:27], s60 offen offset:3072 sc1
    s_add_u32 s60, s60, 4096
    buffer_store_dwordx4 v[40:43], v221, s[24:27], s60 offen offset:0 sc1
    buffer_store_dwordx4 v[44:47], v221, s[24:27], s60 offen offset:1024 sc1
    buffer_store_dwordx4 v[48:51], v221, s[24:27], s60 offen offset:2048 sc1
    buffer_store_dwordx4 v[52:55], v221, s[24:27], s60 offen offset:3072 sc1
    s_add_u32 s60, s60, 4096
    buffer_store_dwordx4 v[56:59], v221, s[24:27], s60 offen offset:0 sc1
    buffer_store_dwordx4 v[60:63], v221, s[24:27], s60 offen offset:1024 sc1
    buffer_store_dwordx4 v[64:67], v221, s[24:27], s60 offen offset:2048 sc1
    buffer_store_dwordx4 v[68:71], v221, s[24:27], s60 offen offset:3072 sc1
    s_add_u32 s60, s60, 4096
    buffer_store_dwordx4 v[72:75], v221, s[24:27], s60 offen offset:0 sc1
    buffer_store_dwordx4 v[76:79], v221, s[24:27], s60 offen offset:1024 sc1
    buffer_store_dwordx4 v[80:83], v221, s[24:27], s60 offen offset:2048 sc1
    buffer_store_dwordx4 v[84:87], v221, s[24:27], s60 offen offset:3072 sc1
    s_add_u32 s60, s60, 4096
    buffer_store_dwordx4 v[88:91], v221, s[24:27], s60 offen offset:0 sc1
    buffer_store_dwordx4 v[92:95], v221, s[24:27], s60 offen offset:1024 sc1
    buffer_store_dwordx4 v[96:99], v221, s[24:27], s60 offen offset:2048 sc1
    buffer_store_dwordx4 v[100:103], v221, s[24:27], s60 offen offset:3072 sc1
    s_add_u32 s60, s60, 4096
    s_lshl_b32 s60, s47, 3
    s_add_u32 s60, s60, 0x1d0b940
    s_waitcnt vmcnt(0)
    s_barrier
    s_cmp_lg_u32 s46, 0
    s_cbranch_scc1 L_sig_24
    v_mov_b32 v16, s44
    v_mov_b32 v17, s45
    v_mov_b32 v18, 0
    s_mov_b64 exec, 1
    buffer_store_dwordx2 v[16:17], v18, s[24:27], s60 offen sc1
    s_mov_b64 exec, -1
L_sig_24:
L_rp_done:
    s_mov_b32 s67, 0
    s_setprio 0
    s_branch L_ps_3_1
L_pw_a3_1:
    s_branch L_pw_a3_2
L_pw_b3_1:
    s_branch L_pw_b3_2
L_pw_c3_1:
    s_branch L_pw_c3_2
L_ps_3_1:
L_g2_end:
    s_setprio 3
    s_mov_b32 s40, s4
    s_and_b32 s41, s5, 0xffff
    s_mov_b32 s42, 0x280000
    s_mov_b32 s43, 0x00020000
    s_mov_b32 s32, s22
    s_and_b32 s33, s23, 0xffff
    s_mov_b32 s34, 0x4000000
    s_mov_b32 s35, 0x00020000
    s_and_b32 s60, s47, 4
    s_bfe_u32 s61, s47, 0x20003
    s_add_u32 s49, s60, s61
    s_and_b32 s60, s47, 1
    s_lshl_b32 s60, s60, 4
    s_and_b32 s61, s47, 2
    s_lshl_b32 s61, s61, 2
    s_add_u32 s60, s60, s61
    s_lshr_b32 s61, s47, 5
    s_add_u32 s48, s60, s61
    s_lshl_b32 s57, s48, 8
    v_and_b32 v7, 63, v0
    v_and_b32 v2, 15, v7
    v_mul_u32_u24 v2, 1280, v2
    v_lshrrev_b32 v3, 4, v7
    v_lshl_add_u32 v8, v3, 3, v2
    v_bfe_u32 v3, v7, 4, 1
    v_lshl_add_u32 v2, v3, 5, v2
    v_lshrrev_b32 v3, 5, v7
    v_lshl_add_u32 v6, v3, 4, v2
    s_mul_i32 s63, s48, 81920
    s_mul_i32 s60, s49, 160
    s_add_u32 s63, s63, s60
    s_mul_i32 s60, s46, 20480
    s_add_u32 s63, s63, s60
    buffer_load_dwordx4 v[132:135], v6, s[40:43], s63 offen
    buffer_load_dwordx4 v[136:139], v6, s[40:43], s63 offen offset:64
    buffer_load_dwordx2 v[140:141], v8, s[40:43], s63 offen offset:128
    v_lshlrev_b32 v4, 4, v7
    v_add_u32 v5, 4096, v4
    v_and_b32 v2, 15, v7
    v_lshlrev_b32 v2, 4, v2
    v_lshrrev_b32 v3, 4, v7
    v_lshl_add_u32 v2, v3, 9, v2
    s_add_u32 s60, s46, 0
    s_and_b32 s60, s60, 3
    s_mul_i32 s61, s60, 55296
    v_add_u32 v12, s61, v4
    s_lshr_b32 s61, s60, 1
    s_mul_i32 s61, s61, 40960
    s_and_b32 s60, s60, 1
    s_lshl_b32 s60, s60, 8
    s_add_u32 s61, s61, s60
    v_add_u32 v1, s61, v2
    s_add_u32 s60, s46, 1
    s_and_b32 s60, s60, 3
    s_mul_i32 s61, s60, 55296
    v_add_u32 v13, s61, v4
    s_lshr_b32 s61, s60, 1
    s_mul_i32 s61, s61, 40960
    s_and_b32 s60, s60, 1
    s_lshl_b32 s60, s60, 8
    s_add_u32 s61, s61, s60
    v_add_u32 v9, s61, v2
    s_add_u32 s60, s46, 2
    s_and_b32 s60, s60, 3
    s_mul_i32 s61, s60, 55296
    v_add_u32 v14, s61, v4
    s_lshr_b32 s61, s60, 1
    s_mul_i32 s61, s61, 40960
    s_and_b32 s60, s60, 1
    s_lshl_b32 s60, s60, 8
    s_add_u32 s61, s61, s60
    v_add_u32 v10, s61, v2
    s_add_u32 s60, s46, 3
    s_and_b32 s60, s60, 3
    s_mul_i32 s61, s60, 55296
    v_add_u32 v15, s61, v4
    s_lshr_b32 s61, s60, 1
    s_mul_i32 s61, s61, 40960
    s_and_b32 s60, s60, 1
    s_lshl_b32 s60, s60, 8
    s_add_u32 s61, s61, s60
    v_add_u32 v11, s61, v2
    s_cmp_ge_u32 s46, 2
    s_cselect_b32 s52, 13, 14
    s_mul_i32 s60, s46, 14
    s_cmp_eq_u32 s46, 3
    s_cselect_b32 s62, 1, 0
    s_sub_u32 s60, s60, s62
    s_bfe_u32 s61, s47, 0x20003
    s_mul_i32 s61, s61, 13
    s_lshr_b32 s61, s61, 2
    s_mul_i32 s55, s60, 40960
    s_mul_i32 s62, s49, 5120
    s_add_u32 s62, s62, 0x2000000
    s_add_u32 s55, s55, s62
    s_mul_i32 s56, s52, 40960
    s_add_u32 s56, s56, s55
    s_mul_i32 s51, s61, 40960
    s_add_u32 s51, s51, s55
    s_mul_i32 s53, s48, 221184
    s_lshl_b32 s60, s60, 10
    s_add_u32 s53, s53, s60
    s_add_u32 s53, s53, 0x1000000
    s_lshl_b32 s54, s52, 10
    s_add_u32 s54, s54, s53
    s_lshl_b32 s50, s61, 10
    s_add_u32 s50, s50, s53
    s_lshl_b32 s60, s46, 2
    s_add_u32 s60, s60, 54
    s_mul_i32 s58, s60, 40960
    s_add_u32 s58, s58, s62
    s_add_u32 s60, s46, 70
    s_mul_i32 s59, s60, 40960
    s_add_u32 s59, s59, s62
    s_mul_i32 s60, s48, 81920
    s_add_u32 s60, s60, 0x1800000
    s_lshl_b32 s61, s46, 13
    s_add_u32 s64, s60, s61
    s_add_u32 s65, s64, 4096
    s_lshl_b32 s61, s46, 11
    s_add_u32 s66, s60, s61
    s_add_u32 s66, s66, 32768
    s_mul_i32 s62, s46, 5120
    s_add_u32 s62, s62, 61440
    s_add_u32 s60, s57, 0x1d10000
    v_mov_b32 v2, 0x1d0bf28
    v_mov_b32 v3, s60
    v_cmp_gt_u32 vcc, 27, v7
    s_nop 1
    v_cndmask_b32 v2, v2, v3, vcc
    v_lshl_add_u32 v144, v7, 3, v2
    v_and_b32 v2, 7, v7
    s_lshl_b32 s61, s46, 6
    s_add_u32 s61, s61, s57
    s_add_u32 s61, s61, 0x1d14000
    v_lshl_add_u32 v7, v2, 3, s61
    v_mov_b32 v36, 0
    v_mov_b32 v37, 0
    v_mov_b32 v38, 0
    v_mov_b32 v39, 0
    v_mov_b32 v40, 0
    v_mov_b32 v41, 0
    v_mov_b32 v42, 0
    v_mov_b32 v43, 0
    v_mov_b32 v44, 0
    v_mov_b32 v45, 0
    v_mov_b32 v46, 0
    v_mov_b32 v47, 0
    v_mov_b32 v48, 0
    v_mov_b32 v49, 0
    v_mov_b32 v50, 0
    v_mov_b32 v51, 0
    v_mov_b32 v52, 0
    v_mov_b32 v53, 0
    v_mov_b32 v54, 0
    v_mov_b32 v55, 0
    v_mov_b32 v56, 0
    v_mov_b32 v57, 0
    v_mov_b32 v58, 0
    v_mov_b32 v59, 0
    v_mov_b32 v60, 0
    v_mov_b32 v61, 0
    v_mov_b32 v62, 0
    v_mov_b32 v63, 0
    v_mov_b32 v64, 0
    v_mov_b32 v65, 0
    v_mov_b32 v66, 0
    v_mov_b32 v67, 0
    v_mov_b32 v68, 0
    v_mov_b32 v69, 0
    v_mov_b32 v70, 0
    v_mov_b32 v71, 0
    v_mov_b32 v72, 0
    v_mov_b32 v73, 0
    v_mov_b32 v74, 0
    v_mov_b32 v75, 0
    v_mov_b32 v76, 0
    v_mov_b32 v77, 0
    v_mov_b32 v78, 0
    v_mov_b32 v79, 0
    v_mov_b32 v80, 0
    v_mov_b32 v81, 0
    v_mov_b32 v82, 0
    v_mov_b32 v83, 0
    v_mov_b32 v84, 0
    v_mov_b32 v85, 0
    v_mov_b32 v86, 0
    v_mov_b32 v87, 0
    v_mov_b32 v88, 0
    v_mov_b32 v89, 0
    v_mov_b32 v90, 0
    v_mov_b32 v91, 0
    v_mov_b32 v92, 0
    v_mov_b32 v93, 0
    v_mov_b32 v94, 0
    v_mov_b32 v95, 0
    s_cmp_eq_u32 s67, 0
    s_cbranch_scc1 L_dn_nosig
    v_mov_b32 v2, s44
    v_mov_b32 v3, s45
    v_mov_b32 v16, 0
    s_waitcnt vmcnt(3)
    s_mov_b64 exec, 1
    buffer_store_dwordx2 v[2:3], v16, s[24:27], s67 offen sc1
    s_mov_b64 exec, -1
    s_waitcnt vmcnt(1)
    s_branch L_dn_sig
L_dn_nosig:
    s_waitcnt vmcnt(0)
L_dn_sig:
    v_permlane16_swap_b32 v132, v134
    v_permlane16_swap_b32 v133, v135
    v_permlane16_swap_b32 v136, v138
    v_permlane16_swap_b32 v137, v139
    v_lshlrev_b32 v16, 16, v132
    v_and_b32 v17, 0xffff0000, v132
    v_lshlrev_b32 v18, 16, v133
    v_and_b32 v19, 0xffff0000, v133
    v_lshlrev_b32 v20, 16, v134
    v_and_b32 v21, 0xffff0000, v134
    v_lshlrev_b32 v22, 16, v135
    v_and_b32 v23, 0xffff0000, v135
    v_lshlrev_b32 v24, 16, v136
    v_and_b32 v25, 0xffff0000, v136
    v_lshlrev_b32 v26, 16, v137
    v_and_b32 v27, 0xffff0000, v137
    v_lshlrev_b32 v28, 16, v138
    v_and_b32 v29, 0xffff0000, v138
    v_lshlrev_b32 v30, 16, v139
    v_and_b32 v31, 0xffff0000, v139
    v_lshlrev_b32 v32, 16, v140
    v_and_b32 v33, 0xffff0000, v140
    v_lshlrev_b32 v34, 16, v141
    v_and_b32 v35, 0xffff0000, v141
    s_mov_b32 s40, s18
    s_and_b32 s41, s19, 0xffff
    s_mov_b32 s42, 0x280000
    s_mov_b32 s43, 0x00020000
    s_setprio 0
    s_cmp_lg_u32 s46, 0
    s_cbranch_scc1 L_wait_26
    s_mov_b32 s3, 0
    s_branch L_wait_25_a
L_wait_25:
    s_sleep 8
L_wait_25_a:
    buffer_load_dwordx2 v[2:3], v144, s[24:27], 0 offen sc1
    s_add_u32 s3, s3, 1
    s_cmp_gt_u32 s3, 40000
    s_cbranch_scc1 L_end
    s_waitcnt vmcnt(0)
    v_cmp_ne_u64 vcc, s[44:45], v[2:3]
    s_nop 1
    s_cmp_lg_u64 vcc, 0
    s_cbranch_scc1 L_wait_25
L_wait_26:
    s_barrier
    s_setprio 0
    s_mov_b32 s36, s22
    s_and_b32 s37, s23, 0xffff
    s_mov_b32 s38, 0x4000000
    s_mov_b32 s39, 0x00020000
    s_cmp_eq_u32 s52, 13
    s_cbranch_scc1 L_dn_s0
    buffer_load_dwordx4 v[96:99], v4, s[24:27], s51 offen offset:0 sc1
    buffer_load_dwordx4 v[100:103], v4, s[24:27], s51 offen offset:1024 sc1
    buffer_load_dwordx4 v[104:107], v4, s[24:27], s51 offen offset:2048 sc1
    buffer_load_dwordx4 v[108:111], v4, s[24:27], s51 offen offset:3072 sc1
    buffer_load_dwordx4 v[112:115], v5, s[24:27], s51 offen offset:0 sc1
    s_add_u32 s51, s51, 40960
    s_cmp_eq_u32 s51, s56
    s_cselect_b32 s51, s55, s51
    buffer_load_dwordx4 v[116:119], v12, s[24:27], s50 offen sc1
    buffer_load_dwordx4 v[120:123], v13, s[24:27], s50 offen sc1
    buffer_load_dwordx4 v[124:127], v14, s[24:27], s50 offen sc1
    buffer_load_dwordx4 v[128:131], v15, s[24:27], s50 offen sc1
    s_add_u32 s50, s50, 1024
    s_cmp_eq_u32 s50, s54
    s_cselect_b32 s50, s53, s50
    s_waitcnt vmcnt(0)
    v_mfma_f32_16x16x32_bf16 v[16:19], v[96:99], v[116:119], v[16:19]
    buffer_load_dwordx4 v[132:135], v4, s[24:27], s51 offen offset:0 sc1
    v_mfma_f32_16x16x32_bf16 v[36:39], v[96:99], v[120:123], v[36:39]
    buffer_load_dwordx4 v[136:139], v4, s[24:27], s51 offen offset:1024 sc1
    v_mfma_f32_16x16x32_bf16 v[56:59], v[96:99], v[124:127], v[56:59]
    buffer_load_dwordx4 v[140:143], v4, s[24:27], s51 offen offset:2048 sc1
    v_mfma_f32_16x16x32_bf16 v[76:79], v[96:99], v[128:131], v[76:79]
    buffer_load_dwordx4 v[144:147], v4, s[24:27], s51 offen offset:3072 sc1
    v_mfma_f32_16x16x32_bf16 v[20:23], v[100:103], v[116:119], v[20:23]
    buffer_load_dwordx4 v[148:151], v5, s[24:27], s51 offen offset:0 sc1
    s_add_u32 s51, s51, 40960
    s_cmp_eq_u32 s51, s56
    s_cselect_b32 s51, s55, s51
    v_mfma_f32_16x16x32_bf16 v[40:43], v[100:103], v[120:123], v[40:43]
    buffer_load_dwordx4 v[152:155], v12, s[24:27], s50 offen sc1
    v_mfma_f32_16x16x32_bf16 v[60:63], v[100:103], v[124:127], v[60:63]
    buffer_load_dwordx4 v[156:159], v13, s[24:27], s50 offen sc1
    v_mfma_f32_16x16x32_bf16 v[80:83], v[100:103], v[128:131], v[80:83]
    buffer_load_dwordx4 v[160:163], v14, s[24:27], s50 offen sc1
    v_mfma_f32_16x16x32_bf16 v[24:27], v[104:107], v[116:119], v[24:27]
    buffer_load_dwordx4 v[164:167], v15, s[24:27], s50 offen sc1
    s_add_u32 s50, s50, 1024
    s_cmp_eq_u32 s50, s54
    s_cselect_b32 s50, s53, s50
    v_mfma_f32_16x16x32_bf16 v[44:47], v[104:107], v[120:123], v[44:47]
    v_mfma_f32_16x16x32_bf16 v[64:67], v[104:107], v[124:127], v[64:67]
    v_mfma_f32_16x16x32_bf16 v[84:87], v[104:107], v[128:131], v[84:87]
    v_mfma_f32_16x16x32_bf16 v[28:31], v[108:111], v[116:119], v[28:31]
    v_mfma_f32_16x16x32_bf16 v[48:51], v[108:111], v[120:123], v[48:51]
    v_mfma_f32_16x16x32_bf16 v[68:71], v[108:111], v[124:127], v[68:71]
    v_mfma_f32_16x16x32_bf16 v[88:91], v[108:111], v[128:131], v[88:91]
    v_mfma_f32_16x16x32_bf16 v[32:35], v[112:115], v[116:119], v[32:35]
    v_mfma_f32_16x16x32_bf16 v[52:55], v[112:115], v[120:123], v[52:55]
    v_mfma_f32_16x16x32_bf16 v[72:75], v[112:115], v[124:127], v[72:75]
    v_mfma_f32_16x16x32_bf16 v[92:95], v[112:115], v[128:131], v[92:95]
    s_branch L_dn_s1
L_dn_s0:
    buffer_load_dwordx4 v[132:135], v4, s[24:27], s51 offen offset:0 sc1
    buffer_load_dwordx4 v[136:139], v4, s[24:27], s51 offen offset:1024 sc1
    buffer_load_dwordx4 v[140:143], v4, s[24:27], s51 offen offset:2048 sc1
    buffer_load_dwordx4 v[144:147], v4, s[24:27], s51 offen offset:3072 sc1
    buffer_load_dwordx4 v[148:151], v5, s[24:27], s51 offen offset:0 sc1
    s_add_u32 s51, s51, 40960
    s_cmp_eq_u32 s51, s56
    s_cselect_b32 s51, s55, s51
    buffer_load_dwordx4 v[152:155], v12, s[24:27], s50 offen sc1
    buffer_load_dwordx4 v[156:159], v13, s[24:27], s50 offen sc1
    buffer_load_dwordx4 v[160:163], v14, s[24:27], s50 offen sc1
    buffer_load_dwordx4 v[164:167], v15, s[24:27], s50 offen sc1
    s_add_u32 s50, s50, 1024
    s_cmp_eq_u32 s50, s54
    s_cselect_b32 s50, s53, s50
L_dn_s1:
    s_waitcnt vmcnt(0)
    v_mfma_f32_16x16x32_bf16 v[16:19], v[132:135], v[152:155], v[16:19]
    buffer_load_dwordx4 v[96:99], v4, s[24:27], s51 offen offset:0 sc1
    v_mfma_f32_16x16x32_bf16 v[36:39], v[132:135], v[156:159], v[36:39]
    buffer_load_dwordx4 v[100:103], v4, s[24:27], s51 offen offset:1024 sc1
    v_mfma_f32_16x16x32_bf16 v[56:59], v[132:135], v[160:163], v[56:59]
    buffer_load_dwordx4 v[104:107], v4, s[24:27], s51 offen offset:2048 sc1
    v_mfma_f32_16x16x32_bf16 v[76:79], v[132:135], v[164:167], v[76:79]
    buffer_load_dwordx4 v[108:111], v4, s[24:27], s51 offen offset:3072 sc1
    v_mfma_f32_16x16x32_bf16 v[20:23], v[136:139], v[152:155], v[20:23]
    buffer_load_dwordx4 v[112:115], v5, s[24:27], s51 offen offset:0 sc1
    s_add_u32 s51, s51, 40960
    s_cmp_eq_u32 s51, s56
    s_cselect_b32 s51, s55, s51
    v_mfma_f32_16x16x32_bf16 v[40:43], v[136:139], v[156:159], v[40:43]
    buffer_load_dwordx4 v[116:119], v12, s[24:27], s50 offen sc1
    v_mfma_f32_16x16x32_bf16 v[60:63], v[136:139], v[160:163], v[60:63]
    buffer_load_dwordx4 v[120:123], v13, s[24:27], s50 offen sc1
    v_mfma_f32_16x16x32_bf16 v[80:83], v[136:139], v[164:167], v[80:83]
    buffer_load_dwordx4 v[124:127], v14, s[24:27], s50 offen sc1
    v_mfma_f32_16x16x32_bf16 v[24:27], v[140:143], v[152:155], v[24:27]
    buffer_load_dwordx4 v[128:131], v15, s[24:27], s50 offen sc1
    s_add_u32 s50, s50, 1024
    s_cmp_eq_u32 s50, s54
    s_cselect_b32 s50, s53, s50
    v_mfma_f32_16x16x32_bf16 v[44:47], v[140:143], v[156:159], v[44:47]
    v_mfma_f32_16x16x32_bf16 v[64:67], v[140:143], v[160:163], v[64:67]
    v_mfma_f32_16x16x32_bf16 v[84:87], v[140:143], v[164:167], v[84:87]
    v_mfma_f32_16x16x32_bf16 v[28:31], v[144:147], v[152:155], v[28:31]
    s_mov_b32 m0, s62
    s_nop 0
    buffer_load_dwordx4 v4, s[24:27], s59 offen offset:0 sc1 lds
    v_mfma_f32_16x16x32_bf16 v[48:51], v[144:147], v[156:159], v[48:51]
    v_mfma_f32_16x16x32_bf16 v[68:71], v[144:147], v[160:163], v[68:71]
    v_mfma_f32_16x16x32_bf16 v[88:91], v[144:147], v[164:167], v[88:91]
    v_mfma_f32_16x16x32_bf16 v[32:35], v[148:151], v[152:155], v[32:35]
    buffer_load_dwordx4 v4, s[24:27], s59 offen offset:1024 sc1 lds
    v_mfma_f32_16x16x32_bf16 v[52:55], v[148:151], v[156:159], v[52:55]
    v_mfma_f32_16x16x32_bf16 v[72:75], v[148:151], v[160:163], v[72:75]
    v_mfma_f32_16x16x32_bf16 v[92:95], v[148:151], v[164:167], v[92:95]
    buffer_load_dwordx4 v4, s[24:27], s59 offen offset:2048 sc1 lds
    s_waitcnt vmcnt(3)
    v_mfma_f32_16x16x32_bf16 v[16:19], v[96:99], v[116:119], v[16:19]
    buffer_load_dwordx4 v[132:135], v4, s[24:27], s51 offen offset:0 sc1
    v_mfma_f32_16x16x32_bf16 v[36:39], v[96:99], v[120:123], v[36:39]
    buffer_load_dwordx4 v[136:139], v4, s[24:27], s51 offen offset:1024 sc1
    v_mfma_f32_16x16x32_bf16 v[56:59], v[96:99], v[124:127], v[56:59]
    buffer_load_dwordx4 v[140:143], v4, s[24:27], s51 offen offset:2048 sc1
    v_mfma_f32_16x16x32_bf16 v[76:79], v[96:99], v[128:131], v[76:79]
    buffer_load_dwordx4 v[144:147], v4, s[24:27], s51 offen offset:3072 sc1
    v_mfma_f32_16x16x32_bf16 v[20:23], v[100:103], v[116:119], v[20:23]
    buffer_load_dwordx4 v[148:151], v5, s[24:27], s51 offen offset:0 sc1
    s_add_u32 s51, s51, 40960
    s_cmp_eq_u32 s51, s56
    s_cselect_b32 s51, s55, s51
    v_mfma_f32_16x16x32_bf16 v[40:43], v[100:103], v[120:123], v[40:43]
    buffer_load_dwordx4 v[152:155], v12, s[24:27], s50 offen sc1
    v_mfma_f32_16x16x32_bf16 v[60:63], v[100:103], v[124:127], v[60:63]
    buffer_load_dwordx4 v[156:159], v13, s[24:27], s50 offen sc1
    v_mfma_f32_16x16x32_bf16 v[80:83], v[100:103], v[128:131], v[80:83]
    buffer_load_dwordx4 v[160:163], v14, s[24:27], s50 offen sc1
    v_mfma_f32_16x16x32_bf16 v[24:27], v[104:107], v[116:119], v[24:27]
    buffer_load_dwordx4 v[164:167], v15, s[24:27], s50 offen sc1
    s_add_u32 s50, s50, 1024
    s_cmp_eq_u32 s50, s54
    s_cselect_b32 s50, s53, s50
    v_mfma_f32_16x16x32_bf16 v[44:47], v[104:107], v[120:123], v[44:47]
    v_mfma_f32_16x16x32_bf16 v[64:67], v[104:107], v[124:127], v[64:67]
    v_mfma_f32_16x16x32_bf16 v[84:87], v[104:107], v[128:131], v[84:87]
    v_mfma_f32_16x16x32_bf16 v[28:31], v[108:111], v[116:119], v[28:31]
    v_mfma_f32_16x16x32_bf16 v[48:51], v[108:111], v[120:123], v[48:51]
    v_mfma_f32_16x16x32_bf16 v[68:71], v[108:111], v[124:127], v[68:71]
    buffer_load_dwordx4 v4, s[24:27], s59 offen offset:3072 sc1 lds
    v_mfma_f32_16x16x32_bf16 v[88:91], v[108:111], v[128:131], v[88:91]
    v_mfma_f32_16x16x32_bf16 v[32:35], v[112:115], v[116:119], v[32:35]
    v_mfma_f32_16x16x32_bf16 v[52:55], v[112:115], v[120:123], v[52:55]
    v_mfma_f32_16x16x32_bf16 v[72:75], v[112:115], v[124:127], v[72:75]
    v_mfma_f32_16x16x32_bf16 v[92:95], v[112:115], v[128:131], v[92:95]
    s_add_u32 m0, s62, 4096
    s_branch L_ps_3_2
L_pw_a3_2:
    s_branch L_pw_a3_3
L_pw_b3_2:
    s_branch L_pw_b3_3
L_pw_c3_2:
    s_branch L_pw_c3_3
L_ps_3_2:
    s_nop 0
    buffer_load_dwordx4 v5, s[24:27], s59 offen offset:0 sc1 lds
    s_waitcnt vmcnt(2)
    v_mfma_f32_16x16x32_bf16 v[16:19], v[132:135], v[152:155], v[16:19]
    buffer_load_dwordx4 v[96:99], v4, s[24:27], s51 offen offset:0 sc1
    v_mfma_f32_16x16x32_bf16 v[36:39], v[132:135], v[156:159], v[36:39]
    buffer_load_dwordx4 v[100:103], v4, s[24:27], s51 offen offset:1024 sc1
    v_mfma_f32_16x16x32_bf16 v[56:59], v[132:135], v[160:163], v[56:59]
    buffer_load_dwordx4 v[104:107], v4, s[24:27], s51 offen offset:2048 sc1
    v_mfma_f32_16x16x32_bf16 v[76:79], v[132:135], v[164:167], v[76:79]
    buffer_load_dwordx4 v[108:111], v4, s[24:27], s51 offen offset:3072 sc1
    v_mfma_f32_16x16x32_bf16 v[20:23], v[136:139], v[152:155], v[20:23]
    buffer_load_dwordx4 v[112:115], v5, s[24:27], s51 offen offset:0 sc1
    s_add_u32 s51, s51, 40960
    s_cmp_eq_u32 s51, s56
    s_cselect_b32 s51, s55, s51
    v_mfma_f32_16x16x32_bf16 v[40:43], v[136:139], v[156:159], v[40:43]
    buffer_load_dwordx4 v[116:119], v12, s[24:27], s50 offen sc1
    v_mfma_f32_16x16x32_bf16 v[60:63], v[136:139], v[160:163], v[60:63]
    buffer_load_dwordx4 v[120:123], v13, s[24:27], s50 offen sc1
    v_mfma_f32_16x16x32_bf16 v[80:83], v[136:139], v[164:167], v[80:83]
    buffer_load_dwordx4 v[124:127], v14, s[24:27], s50 offen sc1
    v_mfma_f32_16x16x32_bf16 v[24:27], v[140:143], v[152:155], v[24:27]
    buffer_load_dwordx4 v[128:131], v15, s[24:27], s50 offen sc1
    s_add_u32 s50, s50, 1024
    s_cmp_eq_u32 s50, s54
    s_cselect_b32 s50, s53, s50
    v_mfma_f32_16x16x32_bf16 v[44:47], v[140:143], v[156:159], v[44:47]
    v_mfma_f32_16x16x32_bf16 v[64:67], v[140:143], v[160:163], v[64:67]
    v_mfma_f32_16x16x32_bf16 v[84:87], v[140:143], v[164:167], v[84:87]
    v_mfma_f32_16x16x32_bf16 v[28:31], v[144:147], v[152:155], v[28:31]
    v_mfma_f32_16x16x32_bf16 v[48:51], v[144:147], v[156:159], v[48:51]
    v_mfma_f32_16x16x32_bf16 v[68:71], v[144:147], v[160:163], v[68:71]
    buffer_load_dwordx4 v[168:171], v4, s[24:27], s58 offen offset:0 sc1
    v_mfma_f32_16x16x32_bf16 v[88:91], v[144:147], v[164:167], v[88:91]
    v_mfma_f32_16x16x32_bf16 v[32:35], v[148:151], v[152:155], v[32:35]
    v_mfma_f32_16x16x32_bf16 v[52:55], v[148:151], v[156:159], v[52:55]
    v_mfma_f32_16x16x32_bf16 v[72:75], v[148:151], v[160:163], v[72:75]
    v_mfma_f32_16x16x32_bf16 v[92:95], v[148:151], v[164:167], v[92:95]
    buffer_load_dwordx4 v[172:175], v4, s[24:27], s58 offen offset:1024 sc1
    s_waitcnt vmcnt(2)
    v_mfma_f32_16x16x32_bf16 v[16:19], v[96:99], v[116:119], v[16:19]
    buffer_load_dwordx4 v[132:135], v4, s[24:27], s51 offen offset:0 sc1
    v_mfma_f32_16x16x32_bf16 v[36:39], v[96:99], v[120:123], v[36:39]
    buffer_load_dwordx4 v[136:139], v4, s[24:27], s51 offen offset:1024 sc1
    v_mfma_f32_16x16x32_bf16 v[56:59], v[96:99], v[124:127], v[56:59]
    buffer_load_dwordx4 v[140:143], v4, s[24:27], s51 offen offset:2048 sc1
    v_mfma_f32_16x16x32_bf16 v[76:79], v[96:99], v[128:131], v[76:79]
    buffer_load_dwordx4 v[144:147], v4, s[24:27], s51 offen offset:3072 sc1
    v_mfma_f32_16x16x32_bf16 v[20:23], v[100:103], v[116:119], v[20:23]
    buffer_load_dwordx4 v[148:151], v5, s[24:27], s51 offen offset:0 sc1
    s_add_u32 s51, s51, 40960
    s_cmp_eq_u32 s51, s56
    s_cselect_b32 s51, s55, s51
    v_mfma_f32_16x16x32_bf16 v[40:43], v[100:103], v[120:123], v[40:43]
    buffer_load_dwordx4 v[152:155], v12, s[24:27], s50 offen sc1
    v_mfma_f32_16x16x32_bf16 v[60:63], v[100:103], v[124:127], v[60:63]
    buffer_load_dwordx4 v[156:159], v13, s[24:27], s50 offen sc1
    v_mfma_f32_16x16x32_bf16 v[80:83], v[100:103], v[128:131], v[80:83]
    buffer_load_dwordx4 v[160:163], v14, s[24:27], s50 offen sc1
    v_mfma_f32_16x16x32_bf16 v[24:27], v[104:107], v[116:119], v[24:27]
    buffer_load_dwordx4 v[164:167], v15, s[24:27], s50 offen sc1
    s_add_u32 s50, s50, 1024
    s_cmp_eq_u32 s50, s54
    s_cselect_b32 s50, s53, s50
    v_mfma_f32_16x16x32_bf16 v[44:47], v[104:107], v[120:123], v[44:47]
    v_mfma_f32_16x16x32_bf16 v[64:67], v[104:107], v[124:127], v[64:67]
    v_mfma_f32_16x16x32_bf16 v[84:87], v[104:107], v[128:131], v[84:87]
    v_mfma_f32_16x16x32_bf16 v[28:31], v[108:111], v[116:119], v[28:31]
    buffer_load_dwordx4 v[176:179], v4, s[24:27], s58 offen offset:2048 sc1
    v_mfma_f32_16x16x32_bf16 v[48:51], v[108:111], v[120:123], v[48:51]
    v_mfma_f32_16x16x32_bf16 v[68:71], v[108:111], v[124:127], v[68:71]
    v_mfma_f32_16x16x32_bf16 v[88:91], v[108:111], v[128:131], v[88:91]
    v_mfma_f32_16x16x32_bf16 v[32:35], v[112:115], v[116:119], v[32:35]
    buffer_load_dwordx4 v[180:183], v4, s[24:27], s58 offen offset:3072 sc1
    v_mfma_f32_16x16x32_bf16 v[52:55], v[112:115], v[120:123], v[52:55]
    v_mfma_f32_16x16x32_bf16 v[72:75], v[112:115], v[124:127], v[72:75]
    v_mfma_f32_16x16x32_bf16 v[92:95], v[112:115], v[128:131], v[92:95]
    buffer_load_dwordx4 v[184:187], v5, s[24:27], s58 offen offset:0 sc1
    s_add_u32 s58, s58, 40960
    s_waitcnt vmcnt(3)
    v_mfma_f32_16x16x32_bf16 v[16:19], v[132:135], v[152:155], v[16:19]
    buffer_load_dwordx4 v[96:99], v4, s[24:27], s51 offen offset:0 sc1
    v_mfma_f32_16x16x32_bf16 v[36:39], v[132:135], v[156:159], v[36:39]
    buffer_load_dwordx4 v[100:103], v4, s[24:27], s51 offen offset:1024 sc1
    v_mfma_f32_16x16x32_bf16 v[56:59], v[132:135], v[160:163], v[56:59]
    buffer_load_dwordx4 v[104:107], v4, s[24:27], s51 offen offset:2048 sc1
    v_mfma_f32_16x16x32_bf16 v[76:79], v[132:135], v[164:167], v[76:79]
    buffer_load_dwordx4 v[108:111], v4, s[24:27], s51 offen offset:3072 sc1
    v_mfma_f32_16x16x32_bf16 v[20:23], v[136:139], v[152:155], v[20:23]
    buffer_load_dwordx4 v[112:115], v5, s[24:27], s51 offen offset:0 sc1
    s_add_u32 s51, s51, 40960
    s_cmp_eq_u32 s51, s56
    s_cselect_b32 s51, s55, s51
    v_mfma_f32_16x16x32_bf16 v[40:43], v[136:139], v[156:159], v[40:43]
    buffer_load_dwordx4 v[116:119], v12, s[24:27], s50 offen sc1
    v_mfma_f32_16x16x32_bf16 v[60:63], v[136:139], v[160:163], v[60:63]
    buffer_load_dwordx4 v[120:123], v13, s[24:27], s50 offen sc1
    v_mfma_f32_16x16x32_bf16 v[80:83], v[136:139], v[164:167], v[80:83]
    buffer_load_dwordx4 v[124:127], v14, s[24:27], s50 offen sc1
    v_mfma_f32_16x16x32_bf16 v[24:27], v[140:143], v[152:155], v[24:27]
    buffer_load_dwordx4 v[128:131], v15, s[24:27], s50 offen sc1
    s_add_u32 s50, s50, 1024
    s_cmp_eq_u32 s50, s54
    s_cselect_b32 s50, s53, s50
    v_mfma_f32_16x16x32_bf16 v[44:47], v[140:143], v[156:159], v[44:47]
    v_mfma_f32_16x16x32_bf16 v[64:67], v[140:143], v[160:163], v[64:67]
    v_mfma_f32_16x16x32_bf16 v[84:87], v[140:143], v[164:167], v[84:87]
    v_mfma_f32_16x16x32_bf16 v[28:31], v[144:147], v[152:155], v[28:31]
    v_mfma_f32_16x16x32_bf16 v[48:51], v[144:147], v[156:159], v[48:51]
    v_mfma_f32_16x16x32_bf16 v[68:71], v[144:147], v[160:163], v[68:71]
    buffer_load_dwordx4 v[188:191], v4, s[24:27], s58 offen offset:0 sc1
    v_mfma_f32_16x16x32_bf16 v[88:91], v[144:147], v[164:167], v[88:91]
    v_mfma_f32_16x16x32_bf16 v[32:35], v[148:151], v[152:155], v[32:35]
    v_mfma_f32_16x16x32_bf16 v[52:55], v[148:151], v[156:159], v[52:55]
    v_mfma_f32_16x16x32_bf16 v[72:75], v[148:151], v[160:163], v[72:75]
    v_mfma_f32_16x16x32_bf16 v[92:95], v[148:151], v[164:167], v[92:95]
    buffer_load_dwordx4 v[192:195], v4, s[24:27], s58 offen offset:1024 sc1
    s_waitcnt vmcnt(2)
    v_mfma_f32_16x16x32_bf16 v[16:19], v[96:99], v[116:119], v[16:19]
    buffer_load_dwordx4 v[132:135], v4, s[24:27], s51 offen offset:0 sc1
    v_mfma_f32_16x16x32_bf16 v[36:39], v[96:99], v[120:123], v[36:39]
    buffer_load_dwordx4 v[136:139], v4, s[24:27], s51 offen offset:1024 sc1
    v_mfma_f32_16x16x32_bf16 v[56:59], v[96:99], v[124:127], v[56:59]
    buffer_load_dwordx4 v[140:143], v4, s[24:27], s51 offen offset:2048 sc1
    v_mfma_f32_16x16x32_bf16 v[76:79], v[96:99], v[128:131], v[76:79]
    buffer_load_dwordx4 v[144:147], v4, s[24:27], s51 offen offset:3072 sc1
    v_mfma_f32_16x16x32_bf16 v[20:23], v[100:103], v[116:119], v[20:23]
    buffer_load_dwordx4 v[148:151], v5, s[24:27], s51 offen offset:0 sc1
    s_add_u32 s51, s51, 40960
    s_cmp_eq_u32 s51, s56
    s_cselect_b32 s51, s55, s51
    v_mfma_f32_16x16x32_bf16 v[40:43], v[100:103], v[120:123], v[40:43]
    buffer_load_dwordx4 v[152:155], v12, s[24:27], s50 offen sc1
    v_mfma_f32_16x16x32_bf16 v[60:63], v[100:103], v[124:127], v[60:63]
    buffer_load_dwordx4 v[156:159], v13, s[24:27], s50 offen sc1
    v_mfma_f32_16x16x32_bf16 v[80:83], v[100:103], v[128:131], v[80:83]
    buffer_load_dwordx4 v[160:163], v14, s[24:27], s50 offen sc1
    v_mfma_f32_16x16x32_bf16 v[24:27], v[104:107], v[116:119], v[24:27]
    buffer_load_dwordx4 v[164:167], v15, s[24:27], s50 offen sc1
    s_add_u32 s50, s50, 1024
    s_cmp_eq_u32 s50, s54
    s_cselect_b32 s50, s53, s50
    v_mfma_f32_16x16x32_bf16 v[44:47], v[104:107], v[120:123], v[44:47]
    v_mfma_f32_16x16x32_bf16 v[64:67], v[104:107], v[124:127], v[64:67]
    v_mfma_f32_16x16x32_bf16 v[84:87], v[104:107], v[128:131], v[84:87]
    v_mfma_f32_16x16x32_bf16 v[28:31], v[108:111], v[116:119], v[28:31]
    v_mfma_f32_16x16x32_bf16 v[48:51], v[108:111], v[120:123], v[48:51]
    v_mfma_f32_16x16x32_bf16 v[68:71], v[108:111], v[124:127], v[68:71]
    buffer_load_dwordx4 v[196:199], v4, s[24:27], s58 offen offset:2048 sc1
    v_mfma_f32_16x16x32_bf16 v[88:91], v[108:111], v[128:131], v[88:91]
    v_mfma_f32_16x16x32_bf16 v[32:35], v[112:115], v[116:119], v[32:35]
    v_mfma_f32_16x16x32_bf16 v[52:55], v[112:115], v[120:123], v[52:55]
    v_mfma_f32_16x16x32_bf16 v[72:75], v[112:115], v[124:127], v[72:75]
    v_mfma_f32_16x16x32_bf16 v[92:95], v[112:115], v[128:131], v[92:95]
    buffer_load_dwordx4 v[200:203], v4, s[24:27], s58 offen offset:3072 sc1
    s_waitcnt vmcnt(2)
    v_mfma_f32_16x16x32_bf16 v[16:19], v[132:135], v[152:155], v[16:19]
    buffer_load_dwordx4 v[96:99], v4, s[24:27], s51 offen offset:0 sc1
    v_mfma_f32_16x16x32_bf16 v[36:39], v[132:135], v[156:159], v[36:39]
    buffer_load_dwordx4 v[100:103], v4, s[24:27], s51 offen offset:1024 sc1
    v_mfma_f32_16x16x32_bf16 v[56:59], v[132:135], v[160:163], v[56:59]
    buffer_load_dwordx4 v[104:107], v4, s[24:27], s51 offen offset:2048 sc1
    v_mfma_f32_16x16x32_bf16 v[76:79], v[132:135], v[164:167], v[76:79]
    buffer_load_dwordx4 v[108:111], v4, s[24:27], s51 offen offset:3072 sc1
    v_mfma_f32_16x16x32_bf16 v[20:23], v[136:139], v[152:155], v[20:23]
    buffer_load_dwordx4 v[112:115], v5, s[24:27], s51 offen offset:0 sc1
    s_add_u32 s51, s51, 40960
    s_cmp_eq_u32 s51, s56
    s_cselect_b32 s51, s55, s51
    v_mfma_f32_16x16x32_bf16 v[40:43], v[136:139], v[156:159], v[40:43]
    buffer_load_dwordx4 v[116:119], v12, s[24:27], s50 offen sc1
    v_mfma_f32_16x16x32_bf16 v[60:63], v[136:139], v[160:163], v[60:63]
    buffer_load_dwordx4 v[120:123], v13, s[24:27], s50 offen sc1
    v_mfma_f32_16x16x32_bf16 v[80:83], v[136:139], v[164:167], v[80:83]
    buffer_load_dwordx4 v[124:127], v14, s[24:27], s50 offen sc1
    v_mfma_f32_16x16x32_bf16 v[24:27], v[140:143], v[152:155], v[24:27]
    buffer_load_dwordx4 v[128:131], v15, s[24:27], s50 offen sc1
    s_add_u32 s50, s50, 1024
    s_cmp_eq_u32 s50, s54
    s_cselect_b32 s50, s53, s50
    v_mfma_f32_16x16x32_bf16 v[44:47], v[140:143], v[156:159], v[44:47]
    v_mfma_f32_16x16x32_bf16 v[64:67], v[140:143], v[160:163], v[64:67]
    v_mfma_f32_16x16x32_bf16 v[84:87], v[140:143], v[164:167], v[84:87]
    v_mfma_f32_16x16x32_bf16 v[28:31], v[144:147], v[152:155], v[28:31]
    v_mfma_f32_16x16x32_bf16 v[48:51], v[144:147], v[156:159], v[48:51]
    v_mfma_f32_16x16x32_bf16 v[68:71], v[144:147], v[160:163], v[68:71]
    buffer_load_dwordx4 v[204:207], v5, s[24:27], s58 offen offset:0 sc1
    s_add_u32 s58, s58, 40960
    v_mfma_f32_16x16x32_bf16 v[88:91], v[144:147], v[164:167], v[88:91]
    v_mfma_f32_16x16x32_bf16 v[32:35], v[148:151], v[152:155], v[32:35]
    v_mfma_f32_16x16x32_bf16 v[52:55], v[148:151], v[156:159], v[52:55]
    v_mfma_f32_16x16x32_bf16 v[72:75], v[148:151], v[160:163], v[72:75]
    v_mfma_f32_16x16x32_bf16 v[92:95], v[148:151], v[164:167], v[92:95]
    buffer_load_dwordx4 v[208:211], v4, s[24:27], s58 offen offset:0 sc1
    s_waitcnt vmcnt(2)
    v_mfma_f32_16x16x32_bf16 v[16:19], v[96:99], v[116:119], v[16:19]
    buffer_load_dwordx4 v[132:135], v4, s[24:27], s51 offen offset:0 sc1
    v_mfma_f32_16x16x32_bf16 v[36:39], v[96:99], v[120:123], v[36:39]
    buffer_load_dwordx4 v[136:139], v4, s[24:27], s51 offen offset:1024 sc1
    v_mfma_f32_16x16x32_bf16 v[56:59], v[96:99], v[124:127], v[56:59]
    buffer_load_dwordx4 v[140:143], v4, s[24:27], s51 offen offset:2048 sc1
    v_mfma_f32_16x16x32_bf16 v[76:79], v[96:99], v[128:131], v[76:79]
    buffer_load_dwordx4 v[144:147], v4, s[24:27], s51 offen offset:3072 sc1
    v_mfma_f32_16x16x32_bf16 v[20:23], v[100:103], v[116:119], v[20:23]
    buffer_load_dwordx4 v[148:151], v5, s[24:27], s51 offen offset:0 sc1
    s_add_u32 s51, s51, 40960
    s_cmp_eq_u32 s51, s56
    s_cselect_b32 s51, s55, s51
    v_mfma_f32_16x16x32_bf16 v[40:43], v[100:103], v[120:123], v[40:43]
    buffer_load_dwordx4 v[152:155], v12, s[24:27], s50 offen sc1
    v_mfma_f32_16x16x32_bf16 v[60:63], v[100:103], v[124:127], v[60:63]
    buffer_load_dwordx4 v[156:159], v13, s[24:27], s50 offen sc1
    v_mfma_f32_16x16x32_bf16 v[80:83], v[100:103], v[128:131], v[80:83]
    buffer_load_dwordx4 v[160:163], v14, s[24:27], s50 offen sc1
    v_mfma_f32_16x16x32_bf16 v[24:27], v[104:107], v[116:119], v[24:27]
    buffer_load_dwordx4 v[164:167], v15, s[24:27], s50 offen sc1
    s_add_u32 s50, s50, 1024
    s_cmp_eq_u32 s50, s54
    s_cselect_b32 s50, s53, s50
    v_mfma_f32_16x16x32_bf16 v[44:47], v[104:107], v[120:123], v[44:47]
    v_mfma_f32_16x16x32_bf16 v[64:67], v[104:107], v[124:127], v[64:67]
    v_mfma_f32_16x16x32_bf16 v[84:87], v[104:107], v[128:131], v[84:87]
    v_mfma_f32_16x16x32_bf16 v[28:31], v[108:111], v[116:119], v[28:31]
    buffer_load_dwordx4 v[212:215], v4, s[24:27], s58 offen offset:1024 sc1
    v_mfma_f32_16x16x32_bf16 v[48:51], v[108:111], v[120:123], v[48:51]
    v_mfma_f32_16x16x32_bf16 v[68:71], v[108:111], v[124:127], v[68:71]
    v_mfma_f32_16x16x32_bf16 v[88:91], v[108:111], v[128:131], v[88:91]
    v_mfma_f32_16x16x32_bf16 v[32:35], v[112:115], v[116:119], v[32:35]
    buffer_load_dwordx4 v[216:219], v4, s[24:27], s58 offen offset:2048 sc1
    v_mfma_f32_16x16x32_bf16 v[52:55], v[112:115], v[120:123], v[52:55]
    v_mfma_f32_16x16x32_bf16 v[72:75], v[112:115], v[124:127], v[72:75]
    v_mfma_f32_16x16x32_bf16 v[92:95], v[112:115], v[128:131], v[92:95]
    buffer_load_dwordx4 v[220:223], v4, s[24:27], s58 offen offset:3072 sc1
    s_waitcnt vmcnt(3)
    v_mfma_f32_16x16x32_bf16 v[16:19], v[132:135], v[152:155], v[16:19]
    buffer_load_dwordx4 v[96:99], v4, s[24:27], s51 offen offset:0 sc1
    v_mfma_f32_16x16x32_bf16 v[36:39], v[132:135], v[156:159], v[36:39]
    buffer_load_dwordx4 v[100:103], v4, s[24:27], s51 offen offset:1024 sc1
    v_mfma_f32_16x16x32_bf16 v[56:59], v[132:135], v[160:163], v[56:59]
    buffer_load_dwordx4 v[104:107], v4, s[24:27], s51 offen offset:2048 sc1
    v_mfma_f32_16x16x32_bf16 v[76:79], v[132:135], v[164:167], v[76:79]
    buffer_load_dwordx4 v[108:111], v4, s[24:27], s51 offen offset:3072 sc1
    v_mfma_f32_16x16x32_bf16 v[20:23], v[136:139], v[152:155], v[20:23]
    buffer_load_dwordx4 v[112:115], v5, s[24:27], s51 offen offset:0 sc1
    s_add_u32 s51, s51, 40960
    s_cmp_eq_u32 s51, s56
    s_cselect_b32 s51, s55, s51
    v_mfma_f32_16x16x32_bf16 v[40:43], v[136:139], v[156:159], v[40:43]
    buffer_load_dwordx4 v[116:119], v12, s[24:27], s50 offen sc1
    v_mfma_f32_16x16x32_bf16 v[60:63], v[136:139], v[160:163], v[60:63]
    buffer_load_dwordx4 v[120:123], v13, s[24:27], s50 offen sc1
    v_mfma_f32_16x16x32_bf16 v[80:83], v[136:139], v[164:167], v[80:83]
    buffer_load_dwordx4 v[124:127], v14, s[24:27], s50 offen sc1
    v_mfma_f32_16x16x32_bf16 v[24:27], v[140:143], v[152:155], v[24:27]
    buffer_load_dwordx4 v[128:131], v15, s[24:27], s50 offen sc1
    s_add_u32 s50, s50, 1024
    s_cmp_eq_u32 s50, s54
    s_cselect_b32 s50, s53, s50
    v_mfma_f32_16x16x32_bf16 v[44:47], v[140:143], v[156:159], v[44:47]
    v_mfma_f32_16x16x32_bf16 v[64:67], v[140:143], v[160:163], v[64:67]
    v_mfma_f32_16x16x32_bf16 v[84:87], v[140:143], v[164:167], v[84:87]
    v_mfma_f32_16x16x32_bf16 v[28:31], v[144:147], v[152:155], v[28:31]
    v_mfma_f32_16x16x32_bf16 v[48:51], v[144:147], v[156:159], v[48:51]
    v_mfma_f32_16x16x32_bf16 v[68:71], v[144:147], v[160:163], v[68:71]
    buffer_load_dwordx4 v[224:227], v5, s[24:27], s58 offen offset:0 sc1
    s_add_u32 s58, s58, 40960
    v_mfma_f32_16x16x32_bf16 v[88:91], v[144:147], v[164:167], v[88:91]
    v_mfma_f32_16x16x32_bf16 v[32:35], v[148:151], v[152:155], v[32:35]
    v_mfma_f32_16x16x32_bf16 v[52:55], v[148:151], v[156:159], v[52:55]
    v_mfma_f32_16x16x32_bf16 v[72:75], v[148:151], v[160:163], v[72:75]
    v_mfma_f32_16x16x32_bf16 v[92:95], v[148:151], v[164:167], v[92:95]
    buffer_load_dwordx4 v[228:231], v4, s[24:27], s58 offen offset:0 sc1
    s_waitcnt vmcnt(2)
    v_mfma_f32_16x16x32_bf16 v[16:19], v[96:99], v[116:119], v[16:19]
    buffer_load_dwordx4 v[132:135], v4, s[24:27], s51 offen offset:0 sc1
    v_mfma_f32_16x16x32_bf16 v[36:39], v[96:99], v[120:123], v[36:39]
    buffer_load_dwordx4 v[136:139], v4, s[24:27], s51 offen offset:1024 sc1
    v_mfma_f32_16x16x32_bf16 v[56:59], v[96:99], v[124:127], v[56:59]
    buffer_load_dwordx4 v[140:143], v4, s[24:27], s51 offen offset:2048 sc1
    v_mfma_f32_16x16x32_bf16 v[76:79], v[96:99], v[128:131], v[76:79]
    buffer_load_dwordx4 v[144:147], v4, s[24:27], s51 offen offset:3072 sc1
    v_mfma_f32_16x16x32_bf16 v[20:23], v[100:103], v[116:119], v[20:23]
    buffer_load_dwordx4 v[148:151], v5, s[24:27], s51 offen offset:0 sc1
    s_add_u32 s51, s51, 40960
    s_cmp_eq_u32 s51, s56
    s_cselect_b32 s51, s55, s51
    v_mfma_f32_16x16x32_bf16 v[40:43], v[100:103], v[120:123], v[40:43]
    buffer_load_dwordx4 v[152:155], v12, s[24:27], s50 offen sc1
    v_mfma_f32_16x16x32_bf16 v[60:63], v[100:103], v[124:127], v[60:63]
    buffer_load_dwordx4 v[156:159], v13, s[24:27], s50 offen sc1
    v_mfma_f32_16x16x32_bf16 v[80:83], v[100:103], v[128:131], v[80:83]
    buffer_load_dwordx4 v[160:163], v14, s[24:27], s50 offen sc1
    v_mfma_f32_16x16x32_bf16 v[24:27], v[104:107], v[116:119], v[24:27]
    buffer_load_dwordx4 v[164:167], v15, s[24:27], s50 offen sc1
    s_add_u32 s50, s50, 1024
    s_cmp_eq_u32 s50, s54
    s_cselect_b32 s50, s53, s50
    v_mfma_f32_16x16x32_bf16 v[44:47], v[104:107], v[120:123], v[44:47]
    v_mfma_f32_16x16x32_bf16 v[64:67], v[104:107], v[124:127], v[64:67]
    v_mfma_f32_16x16x32_bf16 v[84:87], v[104:107], v[128:131], v[84:87]
    v_mfma_f32_16x16x32_bf16 v[28:31], v[108:111], v[116:119], v[28:31]
    v_mfma_f32_16x16x32_bf16 v[48:51], v[108:111], v[120:123], v[48:51]
    v_mfma_f32_16x16x32_bf16 v[68:71], v[108:111], v[124:127], v[68:71]
    buffer_load_dwordx4 v[232:235], v4, s[24:27], s58 offen offset:1024 sc1
    v_mfma_f32_16x16x32_bf16 v[88:91], v[108:111], v[128:131], v[88:91]
    v_mfma_f32_16x16x32_bf16 v[32:35], v[112:115], v[116:119], v[32:35]
    v_mfma_f32_16x16x32_bf16 v[52:55], v[112:115], v[120:123], v[52:55]
    v_mfma_f32_16x16x32_bf16 v[72:75], v[112:115], v[124:127], v[72:75]
    v_mfma_f32_16x16x32_bf16 v[92:95], v[112:115], v[128:131], v[92:95]
    buffer_load_dwordx4 v[236:239], v4, s[24:27], s58 offen offset:2048 sc1
    s_waitcnt vmcnt(2)
    v_mfma_f32_16x16x32_bf16 v[16:19], v[132:135], v[152:155], v[16:19]
    buffer_load_dwordx4 v[96:99], v4, s[24:27], s51 offen offset:0 sc1
    v_mfma_f32_16x16x32_bf16 v[36:39], v[132:135], v[156:159], v[36:39]
    buffer_load_dwordx4 v[100:103], v4, s[24:27], s51 offen offset:1024 sc1
    v_mfma_f32_16x16x32_bf16 v[56:59], v[132:135], v[160:163], v[56:59]
    buffer_load_dwordx4 v[104:107], v4, s[24:27], s51 offen offset:2048 sc1
    v_mfma_f32_16x16x32_bf16 v[76:79], v[132:135], v[164:167], v[76:79]
    buffer_load_dwordx4 v[108:111], v4, s[24:27], s51 offen offset:3072 sc1
    v_mfma_f32_16x16x32_bf16 v[20:23], v[136:139], v[152:155], v[20:23]
    buffer_load_dwordx4 v[112:115], v5, s[24:27], s51 offen offset:0 sc1
    s_add_u32 s51, s51, 40960
    s_cmp_eq_u32 s51, s56
    s_cselect_b32 s51, s55, s51
    v_mfma_f32_16x16x32_bf16 v[40:43], v[136:139], v[156:159], v[40:43]
    buffer_load_dwordx4 v[116:119], v12, s[24:27], s50 offen sc1
    v_mfma_f32_16x16x32_bf16 v[60:63], v[136:139], v[160:163], v[60:63]
    buffer_load_dwordx4 v[120:123], v13, s[24:27], s50 offen sc1
    v_mfma_f32_16x16x32_bf16 v[80:83], v[136:139], v[164:167], v[80:83]
    buffer_load_dwordx4 v[124:127], v14, s[24:27], s50 offen sc1
    v_mfma_f32_16x16x32_bf16 v[24:27], v[140:143], v[152:155], v[24:27]
    buffer_load_dwordx4 v[128:131], v15, s[24:27], s50 offen sc1
    s_add_u32 s50, s50, 1024
    s_cmp_eq_u32 s50, s54
    s_cselect_b32 s50, s53, s50
    v_mfma_f32_16x16x32_bf16 v[44:47], v[140:143], v[156:159], v[44:47]
    v_mfma_f32_16x16x32_bf16 v[64:67], v[140:143], v[160:163], v[64:67]
    v_mfma_f32_16x16x32_bf16 v[84:87], v[140:143], v[164:167], v[84:87]
    v_mfma_f32_16x16x32_bf16 v[28:31], v[144:147], v[152:155], v[28:31]
    v_mfma_f32_16x16x32_bf16 v[48:51], v[144:147], v[156:159], v[48:51]
    v_mfma_f32_16x16x32_bf16 v[68:71], v[144:147], v[160:163], v[68:71]
    buffer_load_dwordx4 v[240:243], v4, s[24:27], s58 offen offset:3072 sc1
    v_mfma_f32_16x16x32_bf16 v[88:91], v[144:147], v[164:167], v[88:91]
    v_mfma_f32_16x16x32_bf16 v[32:35], v[148:151], v[152:155], v[32:35]
    v_mfma_f32_16x16x32_bf16 v[52:55], v[148:151], v[156:159], v[52:55]
    v_mfma_f32_16x16x32_bf16 v[72:75], v[148:151], v[160:163], v[72:75]
    v_mfma_f32_16x16x32_bf16 v[92:95], v[148:151], v[164:167], v[92:95]
    buffer_load_dwordx4 v[244:247], v5, s[24:27], s58 offen offset:0 sc1
    s_add_u32 s58, s58, 40960
    s_waitcnt vmcnt(2)
    v_mfma_f32_16x16x32_bf16 v[16:19], v[96:99], v[116:119], v[16:19]
    buffer_load_dwordx4 v[132:135], v4, s[24:27], s51 offen offset:0 sc1
    v_mfma_f32_16x16x32_bf16 v[36:39], v[96:99], v[120:123], v[36:39]
    buffer_load_dwordx4 v[136:139], v4, s[24:27], s51 offen offset:1024 sc1
    v_mfma_f32_16x16x32_bf16 v[56:59], v[96:99], v[124:127], v[56:59]
    buffer_load_dwordx4 v[140:143], v4, s[24:27], s51 offen offset:2048 sc1
    v_mfma_f32_16x16x32_bf16 v[76:79], v[96:99], v[128:131], v[76:79]
    buffer_load_dwordx4 v[144:147], v4, s[24:27], s51 offen offset:3072 sc1
    v_mfma_f32_16x16x32_bf16 v[20:23], v[100:103], v[116:119], v[20:23]
    buffer_load_dwordx4 v[148:151], v5, s[24:27], s51 offen offset:0 sc1
    s_add_u32 s51, s51, 40960
    s_cmp_eq_u32 s51, s56
    s_cselect_b32 s51, s55, s51
    v_mfma_f32_16x16x32_bf16 v[40:43], v[100:103], v[120:123], v[40:43]
    buffer_load_dwordx4 v[152:155], v12, s[24:27], s50 offen sc1
    v_mfma_f32_16x16x32_bf16 v[60:63], v[100:103], v[124:127], v[60:63]
    buffer_load_dwordx4 v[156:159], v13, s[24:27], s50 offen sc1
    v_mfma_f32_16x16x32_bf16 v[80:83], v[100:103], v[128:131], v[80:83]
    buffer_load_dwordx4 v[160:163], v14, s[24:27], s50 offen sc1
    v_mfma_f32_16x16x32_bf16 v[24:27], v[104:107], v[116:119], v[24:27]
    buffer_load_dwordx4 v[164:167], v15, s[24:27], s50 offen sc1
    s_add_u32 s50, s50, 1024
    s_cmp_eq_u32 s50, s54
    s_cselect_b32 s50, s53, s50
    v_mfma_f32_16x16x32_bf16 v[44:47], v[104:107], v[120:123], v[44:47]
    v_mfma_f32_16x16x32_bf16 v[64:67], v[104:107], v[124:127], v[64:67]
    v_mfma_f32_16x16x32_bf16 v[84:87], v[104:107], v[128:131], v[84:87]
    v_mfma_f32_16x16x32_bf16 v[28:31], v[108:111], v[116:119], v[28:31]
    v_mfma_f32_16x16x32_bf16 v[48:51], v[108:111], v[120:123], v[48:51]
    v_mfma_f32_16x16x32_bf16 v[68:71], v[108:111], v[124:127], v[68:71]
    v_mfma_f32_16x16x32_bf16 v[88:91], v[108:111], v[128:131], v[88:91]
    v_mfma_f32_16x16x32_bf16 v[32:35], v[112:115], v[116:119], v[32:35]
    v_mfma_f32_16x16x32_bf16 v[52:55], v[112:115], v[120:123], v[52:55]
    v_mfma_f32_16x16x32_bf16 v[72:75], v[112:115], v[124:127], v[72:75]
    v_mfma_f32_16x16x32_bf16 v[92:95], v[112:115], v[128:131], v[92:95]
    buffer_load_dwordx2 v[2:3], v7, s[24:27], 0 offen sc1
    s_waitcnt vmcnt(1)
    v_mfma_f32_16x16x32_bf16 v[16:19], v[132:135], v[152:155], v[16:19]
    v_mfma_f32_16x16x32_bf16 v[36:39], v[132:135], v[156:159], v[36:39]
    v_mfma_f32_16x16x32_bf16 v[56:59], v[132:135], v[160:163], v[56:59]
    v_mfma_f32_16x16x32_bf16 v[76:79], v[132:135], v[164:167], v[76:79]
    v_mfma_f32_16x16x32_bf16 v[20:23], v[136:139], v[152:155], v[20:23]
    v_mfma_f32_16x16x32_bf16 v[40:43], v[136:139], v[156:159], v[40:43]
    s_waitcnt vmcnt(0)
    v_cmp_ne_u64 vcc, s[44:45], v[2:3]
    v_mfma_f32_16x16x32_bf16 v[60:63], v[136:139], v[160:163], v[60:63]
    v_mfma_f32_16x16x32_bf16 v[80:83], v[136:139], v[164:167], v[80:83]
    s_cmp_eq_u64 vcc, 0
    s_cselect_b32 s67, 1, 0
    s_cselect_b32 s34, 0x4000000, 0
    s_and_b32 s60, vcc_lo, 15
    s_cselect_b32 s68, 0, 1
    s_cselect_b32 s38, 0, 0x4000000
    v_mfma_f32_16x16x32_bf16 v[24:27], v[140:143], v[152:155], v[24:27]
    buffer_load_dwordx4 v[96:99], v1, s[36:39], s64 offen offset:0 sc1
    v_mfma_f32_16x16x32_bf16 v[44:47], v[140:143], v[156:159], v[44:47]
    buffer_load_dwordx4 v[100:103], v9, s[36:39], s64 offen offset:0 sc1
    v_mfma_f32_16x16x32_bf16 v[64:67], v[140:143], v[160:163], v[64:67]
    buffer_load_dwordx4 v[104:107], v10, s[36:39], s64 offen offset:0 sc1
    v_mfma_f32_16x16x32_bf16 v[84:87], v[140:143], v[164:167], v[84:87]
    buffer_load_dwordx4 v[108:111], v11, s[36:39], s64 offen offset:0 sc1
    v_mfma_f32_16x16x32_bf16 v[28:31], v[144:147], v[152:155], v[28:31]
    buffer_load_dwordx4 v[112:115], v1, s[36:39], s64 offen offset:2048 sc1
    v_mfma_f32_16x16x32_bf16 v[48:51], v[144:147], v[156:159], v[48:51]
    buffer_load_dwordx4 v[116:119], v9, s[36:39], s64 offen offset:2048 sc1
    v_mfma_f32_16x16x32_bf16 v[68:71], v[144:147], v[160:163], v[68:71]
    buffer_load_dwordx4 v[120:123], v10, s[36:39], s64 offen offset:2048 sc1
    v_mfma_f32_16x16x32_bf16 v[88:91], v[144:147], v[164:167], v[88:91]
    buffer_load_dwordx4 v[124:127], v11, s[36:39], s64 offen offset:2048 sc1
    v_mfma_f32_16x16x32_bf16 v[32:35], v[148:151], v[152:155], v[32:35]
    buffer_load_dwordx4 v[128:131], v1, s[32:35], s65 offen offset:0 sc1
    v_mfma_f32_16x16x32_bf16 v[52:55], v[148:151], v[156:159], v[52:55]
    buffer_load_dwordx4 v[248:251], v9, s[32:35], s65 offen offset:0 sc1
    v_mfma_f32_16x16x32_bf16 v[72:75], v[148:151], v[160:163], v[72:75]
    buffer_load_dwordx4 v[252:255], v10, s[32:35], s65 offen offset:0 sc1
    v_mfma_f32_16x16x32_bf16 v[92:95], v[148:151], v[164:167], v[92:95]
    s_cmp_lg_u32 s67, 0
    s_cbranch_scc1 L_dn_rdy
    v_add_u32 v12, s62, v4
    s_add_u32 s60, s46, 1
    s_and_b32 s60, s60, 3
    s_mul_i32 s60, s60, 15360
    s_add_u32 s60, s60, 0
    v_add_u32 v13, s60, v4
    s_add_u32 s60, s46, 2
    s_and_b32 s60, s60, 3
    s_mul_i32 s60, s60, 15360
    s_add_u32 s60, s60, 5120
    v_add_u32 v14, s60, v4
    s_add_u32 s60, s46, 3
    s_and_b32 s60, s60, 3
    s_mul_i32 s60, s60, 15360
    s_add_u32 s60, s60, 10240
    v_add_u32 v15, s60, v4
    s_mul_i32 s60, s46, 15360
    v_add_u32 v4, s60, v4
    s_cmp_lg_u32 s68, 0
    s_cbranch_scc1 L_dn_rd1
    s_mov_b32 s3, 0
L_wait_27:
    buffer_load_dwordx2 v[2:3], v7, s[24:27], 0 offen sc1
    s_add_u32 s3, s3, 1
    s_cmp_gt_u32 s3, 40000
    s_cbranch_scc1 L_end
    s_waitcnt vmcnt(0)
    v_cmp_ne_u64 vcc, s[44:45], v[2:3]
    s_nop 1
    s_and_b32 s60, vcc_lo, 15
    s_cbranch_scc1 L_wait_27
    s_cmp_eq_u64 vcc, 0
    s_cbranch_scc1 L_dn_all0
    buffer_load_dwordx4 v[96:99], v1, s[24:27], s64 offen offset:0 sc1
    buffer_load_dwordx4 v[100:103], v9, s[24:27], s64 offen offset:0 sc1
    buffer_load_dwordx4 v[104:107], v10, s[24:27], s64 offen offset:0 sc1
    buffer_load_dwordx4 v[108:111], v11, s[24:27], s64 offen offset:0 sc1
    buffer_load_dwordx4 v[112:115], v1, s[24:27], s64 offen offset:2048 sc1
    buffer_load_dwordx4 v[116:119], v9, s[24:27], s64 offen offset:2048 sc1
    buffer_load_dwordx4 v[120:123], v10, s[24:27], s64 offen offset:2048 sc1
    buffer_load_dwordx4 v[124:127], v11, s[24:27], s64 offen offset:2048 sc1
L_dn_rd1:
    buffer_load_dwordx2 v[2:3], v7, s[24:27], 0 offen sc1
    s_setprio 3
    s_waitcnt vmcnt(5)
    v_mfma_f32_16x16x32_bf16 v[16:19], v[168:171], v[96:99], v[16:19]
    v_mfma_f32_16x16x32_bf16 v[36:39], v[168:171], v[100:103], v[36:39]
    v_mfma_f32_16x16x32_bf16 v[56:59], v[168:171], v[104:107], v[56:59]
    v_mfma_f32_16x16x32_bf16 v[76:79], v[168:171], v[108:111], v[76:79]
    v_mfma_f32_16x16x32_bf16 v[20:23], v[172:175], v[96:99], v[20:23]
    v_mfma_f32_16x16x32_bf16 v[40:43], v[172:175], v[100:103], v[40:43]
    v_mfma_f32_16x16x32_bf16 v[60:63], v[172:175], v[104:107], v[60:63]
    v_mfma_f32_16x16x32_bf16 v[80:83], v[172:175], v[108:111], v[80:83]
    v_mfma_f32_16x16x32_bf16 v[24:27], v[176:179], v[96:99], v[24:27]
    v_mfma_f32_16x16x32_bf16 v[44:47], v[176:179], v[100:103], v[44:47]
    v_mfma_f32_16x16x32_bf16 v[64:67], v[176:179], v[104:107], v[64:67]
    v_mfma_f32_16x16x32_bf16 v[84:87], v[176:179], v[108:111], v[84:87]
    v_mfma_f32_16x16x32_bf16 v[28:31], v[180:183], v[96:99], v[28:31]
    v_mfma_f32_16x16x32_bf16 v[48:51], v[180:183], v[100:103], v[48:51]
    v_mfma_f32_16x16x32_bf16 v[68:71], v[180:183], v[104:107], v[68:71]
    v_mfma_f32_16x16x32_bf16 v[88:91], v[180:183], v[108:111], v[88:91]
    v_mfma_f32_16x16x32_bf16 v[32:35], v[184:187], v[96:99], v[32:35]
    v_mfma_f32_16x16x32_bf16 v[52:55], v[184:187], v[100:103], v[52:55]
    v_mfma_f32_16x16x32_bf16 v[72:75], v[184:187], v[104:107], v[72:75]
    v_mfma_f32_16x16x32_bf16 v[92:95], v[184:187], v[108:111], v[92:95]
    s_waitcnt vmcnt(1)
    v_mfma_f32_16x16x32_bf16 v[16:19], v[188:191], v[112:115], v[16:19]
    v_mfma_f32_16x16x32_bf16 v[36:39], v[188:191], v[116:119], v[36:39]
    v_mfma_f32_16x16x32_bf16 v[56:59], v[188:191], v[120:123], v[56:59]
    v_mfma_f32_16x16x32_bf16 v[76:79], v[188:191], v[124:127], v[76:79]
    ds_read_b128 v[168:171], v12 offset:0
    v_mfma_f32_16x16x32_bf16 v[20:23], v[192:195], v[112:115], v[20:23]
    v_mfma_f32_16x16x32_bf16 v[40:43], v[192:195], v[116:119], v[40:43]
    v_mfma_f32_16x16x32_bf16 v[60:63], v[192:195], v[120:123], v[60:63]
    v_mfma_f32_16x16x32_bf16 v[80:83], v[192:195], v[124:127], v[80:83]
    ds_read_b128 v[172:175], v12 offset:1024
    v_mfma_f32_16x16x32_bf16 v[24:27], v[196:199], v[112:115], v[24:27]
    v_mfma_f32_16x16x32_bf16 v[44:47], v[196:199], v[116:119], v[44:47]
    v_mfma_f32_16x16x32_bf16 v[64:67], v[196:199], v[120:123], v[64:67]
    v_mfma_f32_16x16x32_bf16 v[84:87], v[196:199], v[124:127], v[84:87]
    ds_read_b128 v[176:179], v12 offset:2048
    v_mfma_f32_16x16x32_bf16 v[28:31], v[200:203], v[112:115], v[28:31]
    v_mfma_f32_16x16x32_bf16 v[48:51], v[200:203], v[116:119], v[48:51]
    v_mfma_f32_16x16x32_bf16 v[68:71], v[200:203], v[120:123], v[68:71]
    v_mfma_f32_16x16x32_bf16 v[88:91], v[200:203], v[124:127], v[88:91]
    ds_read_b128 v[180:183], v12 offset:3072
    v_mfma_f32_16x16x32_bf16 v[32:35], v[204:207], v[112:115], v[32:35]
    v_mfma_f32_16x16x32_bf16 v[52:55], v[204:207], v[116:119], v[52:55]
    v_mfma_f32_16x16x32_bf16 v[72:75], v[204:207], v[120:123], v[72:75]
    v_mfma_f32_16x16x32_bf16 v[92:95], v[204:207], v[124:127], v[92:95]
    ds_read_b128 v[184:187], v12 offset:4096
    s_waitcnt vmcnt(0)
    v_cmp_ne_u64 vcc, s[44:45], v[2:3]
    s_nop 1
    s_cmp_eq_u64 vcc, 0
    s_cbranch_scc1 L_dn_rd2
    s_setprio 0
    s_mov_b32 s3, 0
L_wait_29:
    buffer_load_dwordx2 v[2:3], v7, s[24:27], 0 offen sc1
    s_add_u32 s3, s3, 1
    s_cmp_gt_u32 s3, 40000
    s_cbranch_scc1 L_end
    s_waitcnt vmcnt(0)
    v_cmp_ne_u64 vcc, s[44:45], v[2:3]
    s_nop 1
    s_cmp_lg_u64 vcc, 0
    s_cbranch_scc1 L_wait_29
    s_setprio 3
L_dn_rd2:
    buffer_load_dwordx4 v[128:131], v1, s[24:27], s65 offen offset:0 sc1
    buffer_load_dwordx4 v[248:251], v9, s[24:27], s65 offen offset:0 sc1
    buffer_load_dwordx4 v[252:255], v10, s[24:27], s65 offen offset:0 sc1
    buffer_load_dwordx4 v[132:135], v11, s[24:27], s65 offen offset:0 sc1
    buffer_load_dwordx4 v[136:139], v1, s[24:27], s65 offen offset:2048 sc1
    buffer_load_dwordx4 v[140:143], v9, s[24:27], s65 offen offset:2048 sc1
    buffer_load_dwordx4 v[144:147], v10, s[24:27], s65 offen offset:2048 sc1
    buffer_load_dwordx4 v[148:151], v11, s[24:27], s65 offen offset:2048 sc1
    buffer_load_dwordx4 v[152:155], v1, s[24:27], s66 offen offset:0 sc1
    buffer_load_dwordx4 v[156:159], v9, s[24:27], s66 offen offset:0 sc1
    buffer_load_dwordx4 v[160:163], v10, s[24:27], s66 offen offset:0 sc1
    buffer_load_dwordx4 v[164:167], v11, s[24:27], s66 offen offset:0 sc1
    s_branch L_dn_j2
L_dn_all0:
    s_setprio 3
    buffer_load_dwordx4 v[96:99], v1, s[24:27], s64 offen offset:0 sc1
    buffer_load_dwordx4 v[100:103], v9, s[24:27], s64 offen offset:0 sc1
    buffer_load_dwordx4 v[104:107], v10, s[24:27], s64 offen offset:0 sc1
    buffer_load_dwordx4 v[108:111], v11, s[24:27], s64 offen offset:0 sc1
    buffer_load_dwordx4 v[112:115], v1, s[24:27], s64 offen offset:2048 sc1
    buffer_load_dwordx4 v[116:119], v9, s[24:27], s64 offen offset:2048 sc1
    buffer_load_dwordx4 v[120:123], v10, s[24:27], s64 offen offset:2048 sc1
    buffer_load_dwordx4 v[124:127], v11, s[24:27], s64 offen offset:2048 sc1
    buffer_load_dwordx4 v[128:131], v1, s[24:27], s65 offen offset:0 sc1
    buffer_load_dwordx4 v[248:251], v9, s[24:27], s65 offen offset:0 sc1
    buffer_load_dwordx4 v[252:255], v10, s[24:27], s65 offen offset:0 sc1
    buffer_load_dwordx4 v[132:135], v11, s[24:27], s65 offen offset:0 sc1
    buffer_load_dwordx4 v[136:139], v1, s[24:27], s65 offen offset:2048 sc1
    s_branch L_ps_3_3
L_pw_a3_3:
    s_branch L_pw_a_ret
L_pw_b3_3:
    s_branch L_pw_b_ret
L_pw_c3_3:
    s_branch L_pw_c_ret
L_ps_3_3:
    buffer_load_dwordx4 v[140:143], v9, s[24:27], s65 offen offset:2048 sc1
    buffer_load_dwordx4 v[144:147], v10, s[24:27], s65 offen offset:2048 sc1
    buffer_load_dwordx4 v[148:151], v11, s[24:27], s65 offen offset:2048 sc1
    buffer_load_dwordx4 v[152:155], v1, s[24:27], s66 offen offset:0 sc1
    buffer_load_dwordx4 v[156:159], v9, s[24:27], s66 offen offset:0 sc1
    buffer_load_dwordx4 v[160:163], v10, s[24:27], s66 offen offset:0 sc1
    buffer_load_dwordx4 v[164:167], v11, s[24:27], s66 offen offset:0 sc1
    s_branch L_dn_all
L_dn_rdy:
    s_setprio 3
    buffer_load_dwordx4 v[132:135], v11, s[32:35], s65 offen offset:0 sc1
    buffer_load_dwordx4 v[136:139], v1, s[32:35], s65 offen offset:2048 sc1
    buffer_load_dwordx4 v[140:143], v9, s[32:35], s65 offen offset:2048 sc1
    buffer_load_dwordx4 v[144:147], v10, s[32:35], s65 offen offset:2048 sc1
    buffer_load_dwordx4 v[148:151], v11, s[32:35], s65 offen offset:2048 sc1
    buffer_load_dwordx4 v[152:155], v1, s[32:35], s66 offen offset:0 sc1
    buffer_load_dwordx4 v[156:159], v9, s[32:35], s66 offen offset:0 sc1
    buffer_load_dwordx4 v[160:163], v10, s[32:35], s66 offen offset:0 sc1
    buffer_load_dwordx4 v[164:167], v11, s[32:35], s66 offen offset:0 sc1
    v_add_u32 v12, s62, v4
    s_add_u32 s60, s46, 1
    s_and_b32 s60, s60, 3
    s_mul_i32 s60, s60, 15360
    s_add_u32 s60, s60, 0
    v_add_u32 v13, s60, v4
    s_add_u32 s60, s46, 2
    s_and_b32 s60, s60, 3
    s_mul_i32 s60, s60, 15360
    s_add_u32 s60, s60, 5120
    v_add_u32 v14, s60, v4
    s_add_u32 s60, s46, 3
    s_and_b32 s60, s60, 3
    s_mul_i32 s60, s60, 15360
    s_add_u32 s60, s60, 10240
    v_add_u32 v15, s60, v4
    s_mul_i32 s60, s46, 15360
    v_add_u32 v4, s60, v4
L_dn_all:
    s_waitcnt vmcnt(16)
    v_mfma_f32_16x16x32_bf16 v[16:19], v[168:171], v[96:99], v[16:19]
    v_mfma_f32_16x16x32_bf16 v[36:39], v[168:171], v[100:103], v[36:39]
    v_mfma_f32_16x16x32_bf16 v[56:59], v[168:171], v[104:107], v[56:59]
    v_mfma_f32_16x16x32_bf16 v[76:79], v[168:171], v[108:111], v[76:79]
    v_mfma_f32_16x16x32_bf16 v[20:23], v[172:175], v[96:99], v[20:23]
    v_mfma_f32_16x16x32_bf16 v[40:43], v[172:175], v[100:103], v[40:43]
    v_mfma_f32_16x16x32_bf16 v[60:63], v[172:175], v[104:107], v[60:63]
    v_mfma_f32_16x16x32_bf16 v[80:83], v[172:175], v[108:111], v[80:83]
    v_mfma_f32_16x16x32_bf16 v[24:27], v[176:179], v[96:99], v[24:27]
    v_mfma_f32_16x16x32_bf16 v[44:47], v[176:179], v[100:103], v[44:47]
    v_mfma_f32_16x16x32_bf16 v[64:67], v[176:179], v[104:107], v[64:67]
    v_mfma_f32_16x16x32_bf16 v[84:87], v[176:179], v[108:111], v[84:87]
    v_mfma_f32_16x16x32_bf16 v[28:31], v[180:183], v[96:99], v[28:31]
    v_mfma_f32_16x16x32_bf16 v[48:51], v[180:183], v[100:103], v[48:51]
    v_mfma_f32_16x16x32_bf16 v[68:71], v[180:183], v[104:107], v[68:71]
    v_mfma_f32_16x16x32_bf16 v[88:91], v[180:183], v[108:111], v[88:91]
    v_mfma_f32_16x16x32_bf16 v[32:35], v[184:187], v[96:99], v[32:35]
    v_mfma_f32_16x16x32_bf16 v[52:55], v[184:187], v[100:103], v[52:55]
    v_mfma_f32_16x16x32_bf16 v[72:75], v[184:187], v[104:107], v[72:75]
    v_mfma_f32_16x16x32_bf16 v[92:95], v[184:187], v[108:111], v[92:95]
    s_waitcnt vmcnt(12)
    v_mfma_f32_16x16x32_bf16 v[16:19], v[188:191], v[112:115], v[16:19]
    v_mfma_f32_16x16x32_bf16 v[36:39], v[188:191], v[116:119], v[36:39]
    v_mfma_f32_16x16x32_bf16 v[56:59], v[188:191], v[120:123], v[56:59]
    v_mfma_f32_16x16x32_bf16 v[76:79], v[188:191], v[124:127], v[76:79]
    ds_read_b128 v[168:171], v12 offset:0
    v_mfma_f32_16x16x32_bf16 v[20:23], v[192:195], v[112:115], v[20:23]
    v_mfma_f32_16x16x32_bf16 v[40:43], v[192:195], v[116:119], v[40:43]
    v_mfma_f32_16x16x32_bf16 v[60:63], v[192:195], v[120:123], v[60:63]
    v_mfma_f32_16x16x32_bf16 v[80:83], v[192:195], v[124:127], v[80:83]
    ds_read_b128 v[172:175], v12 offset:1024
    v_mfma_f32_16x16x32_bf16 v[24:27], v[196:199], v[112:115], v[24:27]
    v_mfma_f32_16x16x32_bf16 v[44:47], v[196:199], v[116:119], v[44:47]
    v_mfma_f32_16x16x32_bf16 v[64:67], v[196:199], v[120:123], v[64:67]
    v_mfma_f32_16x16x32_bf16 v[84:87], v[196:199], v[124:127], v[84:87]
    ds_read_b128 v[176:179], v12 offset:2048
    v_mfma_f32_16x16x32_bf16 v[28:31], v[200:203], v[112:115], v[28:31]
    v_mfma_f32_16x16x32_bf16 v[48:51], v[200:203], v[116:119], v[48:51]
    v_mfma_f32_16x16x32_bf16 v[68:71], v[200:203], v[120:123], v[68:71]
    v_mfma_f32_16x16x32_bf16 v[88:91], v[200:203], v[124:127], v[88:91]
    ds_read_b128 v[180:183], v12 offset:3072
    v_mfma_f32_16x16x32_bf16 v[32:35], v[204:207], v[112:115], v[32:35]
    v_mfma_f32_16x16x32_bf16 v[52:55], v[204:207], v[116:119], v[52:55]
    v_mfma_f32_16x16x32_bf16 v[72:75], v[204:207], v[120:123], v[72:75]
    v_mfma_f32_16x16x32_bf16 v[92:95], v[204:207], v[124:127], v[92:95]
    ds_read_b128 v[184:187], v12 offset:4096
L_dn_j2:
    s_waitcnt vmcnt(8)
    v_mfma_f32_16x16x32_bf16 v[16:19], v[208:211], v[128:131], v[16:19]
    v_mfma_f32_16x16x32_bf16 v[36:39], v[208:211], v[248:251], v[36:39]
    v_mfma_f32_16x16x32_bf16 v[56:59], v[208:211], v[252:255], v[56:59]
    v_mfma_f32_16x16x32_bf16 v[76:79], v[208:211], v[132:135], v[76:79]
    v_mfma_f32_16x16x32_bf16 v[20:23], v[212:215], v[128:131], v[20:23]
    v_mfma_f32_16x16x32_bf16 v[40:43], v[212:215], v[248:251], v[40:43]
    v_mfma_f32_16x16x32_bf16 v[60:63], v[212:215], v[252:255], v[60:63]
    v_mfma_f32_16x16x32_bf16 v[80:83], v[212:215], v[132:135], v[80:83]
    v_mfma_f32_16x16x32_bf16 v[24:27], v[216:219], v[128:131], v[24:27]
    v_mfma_f32_16x16x32_bf16 v[44:47], v[216:219], v[248:251], v[44:47]
    v_mfma_f32_16x16x32_bf16 v[64:67], v[216:219], v[252:255], v[64:67]
    v_mfma_f32_16x16x32_bf16 v[84:87], v[216:219], v[132:135], v[84:87]
    v_mfma_f32_16x16x32_bf16 v[28:31], v[220:223], v[128:131], v[28:31]
    v_mfma_f32_16x16x32_bf16 v[48:51], v[220:223], v[248:251], v[48:51]
    v_mfma_f32_16x16x32_bf16 v[68:71], v[220:223], v[252:255], v[68:71]
    v_mfma_f32_16x16x32_bf16 v[88:91], v[220:223], v[132:135], v[88:91]
    v_mfma_f32_16x16x32_bf16 v[32:35], v[224:227], v[128:131], v[32:35]
    v_mfma_f32_16x16x32_bf16 v[52:55], v[224:227], v[248:251], v[52:55]
    v_mfma_f32_16x16x32_bf16 v[72:75], v[224:227], v[252:255], v[72:75]
    v_mfma_f32_16x16x32_bf16 v[92:95], v[224:227], v[132:135], v[92:95]
    s_waitcnt vmcnt(4)
    v_mfma_f32_16x16x32_bf16 v[16:19], v[228:231], v[136:139], v[16:19]
    v_mfma_f32_16x16x32_bf16 v[36:39], v[228:231], v[140:143], v[36:39]
    v_mfma_f32_16x16x32_bf16 v[56:59], v[228:231], v[144:147], v[56:59]
    v_mfma_f32_16x16x32_bf16 v[76:79], v[228:231], v[148:151], v[76:79]
    v_mfma_f32_16x16x32_bf16 v[20:23], v[232:235], v[136:139], v[20:23]
    v_mfma_f32_16x16x32_bf16 v[40:43], v[232:235], v[140:143], v[40:43]
    v_mfma_f32_16x16x32_bf16 v[60:63], v[232:235], v[144:147], v[60:63]
    v_mfma_f32_16x16x32_bf16 v[80:83], v[232:235], v[148:151], v[80:83]
    v_mfma_f32_16x16x32_bf16 v[24:27], v[236:239], v[136:139], v[24:27]
    v_mfma_f32_16x16x32_bf16 v[44:47], v[236:239], v[140:143], v[44:47]
    v_mfma_f32_16x16x32_bf16 v[64:67], v[236:239], v[144:147], v[64:67]
    v_mfma_f32_16x16x32_bf16 v[84:87], v[236:239], v[148:151], v[84:87]
    v_mfma_f32_16x16x32_bf16 v[28:31], v[240:243], v[136:139], v[28:31]
    v_mfma_f32_16x16x32_bf16 v[48:51], v[240:243], v[140:143], v[48:51]
    v_mfma_f32_16x16x32_bf16 v[68:71], v[240:243], v[144:147], v[68:71]
    v_mfma_f32_16x16x32_bf16 v[88:91], v[240:243], v[148:151], v[88:91]
    v_mfma_f32_16x16x32_bf16 v[32:35], v[244:247], v[136:139], v[32:35]
    v_mfma_f32_16x16x32_bf16 v[52:55], v[244:247], v[140:143], v[52:55]
    v_mfma_f32_16x16x32_bf16 v[72:75], v[244:247], v[144:147], v[72:75]
    v_mfma_f32_16x16x32_bf16 v[92:95], v[244:247], v[148:151], v[92:95]
L_dn_tail:
    s_waitcnt vmcnt(0) lgkmcnt(0)
    v_mfma_f32_16x16x32_bf16 v[36:39], v[168:171], v[156:159], v[36:39]
    v_mfma_f32_16x16x32_bf16 v[40:43], v[172:175], v[156:159], v[40:43]
    v_mfma_f32_16x16x32_bf16 v[44:47], v[176:179], v[156:159], v[44:47]
    v_mfma_f32_16x16x32_bf16 v[48:51], v[180:183], v[156:159], v[48:51]
    v_mfma_f32_16x16x32_bf16 v[52:55], v[184:187], v[156:159], v[52:55]
    v_mfma_f32_16x16x32_bf16 v[56:59], v[168:171], v[160:163], v[56:59]
    v_mfma_f32_16x16x32_bf16 v[60:63], v[172:175], v[160:163], v[60:63]
    v_mfma_f32_16x16x32_bf16 v[64:67], v[176:179], v[160:163], v[64:67]
    v_mfma_f32_16x16x32_bf16 v[68:71], v[180:183], v[160:163], v[68:71]
    v_mfma_f32_16x16x32_bf16 v[72:75], v[184:187], v[160:163], v[72:75]
    v_mfma_f32_16x16x32_bf16 v[76:79], v[168:171], v[164:167], v[76:79]
    ds_write_b128 v13, v[36:39] offset:0
    v_mfma_f32_16x16x32_bf16 v[80:83], v[172:175], v[164:167], v[80:83]
    ds_write_b128 v13, v[40:43] offset:1024
    v_mfma_f32_16x16x32_bf16 v[84:87], v[176:179], v[164:167], v[84:87]
    ds_write_b128 v13, v[44:47] offset:2048
    v_mfma_f32_16x16x32_bf16 v[88:91], v[180:183], v[164:167], v[88:91]
    ds_write_b128 v13, v[48:51] offset:3072
    v_mfma_f32_16x16x32_bf16 v[92:95], v[184:187], v[164:167], v[92:95]
    ds_write_b128 v13, v[52:55] offset:4096
    v_mfma_f32_16x16x32_bf16 v[16:19], v[168:171], v[152:155], v[16:19]
    ds_write_b128 v14, v[56:59] offset:0
    v_mfma_f32_16x16x32_bf16 v[20:23], v[172:175], v[152:155], v[20:23]
    ds_write_b128 v14, v[60:63] offset:1024
    v_mfma_f32_16x16x32_bf16 v[24:27], v[176:179], v[152:155], v[24:27]
    ds_write_b128 v14, v[64:67] offset:2048
    v_mfma_f32_16x16x32_bf16 v[28:31], v[180:183], v[152:155], v[28:31]
    ds_write_b128 v14, v[68:71] offset:3072
    v_mfma_f32_16x16x32_bf16 v[32:35], v[184:187], v[152:155], v[32:35]
    ds_write_b128 v14, v[72:75] offset:4096
    ds_write_b128 v15, v[76:79] offset:0
    ds_write_b128 v15, v[80:83] offset:1024
    ds_write_b128 v15, v[84:87] offset:2048
    ds_write_b128 v15, v[88:91] offset:3072
    ds_write_b128 v15, v[92:95] offset:4096
    s_waitcnt lgkmcnt(0)
    s_barrier
    ds_read_b128 v[96:99], v4 offset:0
    ds_read_b128 v[100:103], v4 offset:5120
    ds_read_b128 v[104:107], v4 offset:10240
    ds_read_b128 v[108:111], v4 offset:1024
    ds_read_b128 v[112:115], v4 offset:6144
    ds_read_b128 v[116:119], v4 offset:11264
    ds_read_b128 v[120:123], v4 offset:2048
    ds_read_b128 v[124:127], v4 offset:7168
    ds_read_b128 v[128:131], v4 offset:12288
    ds_read_b128 v[132:135], v4 offset:3072
    ds_read_b128 v[136:139], v4 offset:8192
    ds_read_b128 v[140:143], v4 offset:13312
    ds_read_b128 v[144:147], v4 offset:4096
    ds_read_b128 v[148:151], v4 offset:9216
    ds_read_b128 v[152:155], v4 offset:14336
    s_waitcnt lgkmcnt(12)
    v_add_f32 v96, v96, v100
    v_add_f32 v16, v16, v104
    v_add_f32 v97, v97, v101
    v_add_f32 v17, v17, v105
    v_add_f32 v98, v98, v102
    v_add_f32 v18, v18, v106
    v_add_f32 v99, v99, v103
    v_add_f32 v19, v19, v107
    v_add_f32 v16, v16, v96
    v_add_f32 v17, v17, v97
    v_add_f32 v18, v18, v98
    v_add_f32 v19, v19, v99
    v_cvt_pk_bf16_f32 v216, v16, v17
    v_cvt_pk_bf16_f32 v217, v18, v19
    s_waitcnt lgkmcnt(9)
    v_add_f32 v108, v108, v112
    v_add_f32 v20, v20, v116
    v_add_f32 v109, v109, v113
    v_add_f32 v21, v21, v117
    v_add_f32 v110, v110, v114
    v_add_f32 v22, v22, v118
    v_add_f32 v111, v111, v115
    v_add_f32 v23, v23, v119
    v_add_f32 v20, v20, v108
    v_add_f32 v21, v21, v109
    v_add_f32 v22, v22, v110
    v_add_f32 v23, v23, v111
    v_cvt_pk_bf16_f32 v218, v20, v21
    v_cvt_pk_bf16_f32 v219, v22, v23
    s_nop 0
    v_permlane16_swap_b32 v216, v218
    v_permlane16_swap_b32 v217, v219
    buffer_store_dwordx4 v[216:219], v6, s[40:43], s63 offen offset:0
    s_waitcnt lgkmcnt(6)
    v_add_f32 v120, v120, v124
    v_add_f32 v24, v24, v128
    v_add_f32 v121, v121, v125
    v_add_f32 v25, v25, v129
    v_add_f32 v122, v122, v126
    v_add_f32 v26, v26, v130
    v_add_f32 v123, v123, v127
    v_add_f32 v27, v27, v131
    v_add_f32 v24, v24, v120
    v_add_f32 v25, v25, v121
    v_add_f32 v26, v26, v122
    v_add_f32 v27, v27, v123
    v_cvt_pk_bf16_f32 v220, v24, v25
    v_cvt_pk_bf16_f32 v221, v26, v27
    s_waitcnt lgkmcnt(3)
    v_add_f32 v132, v132, v136
    v_add_f32 v28, v28, v140
    v_add_f32 v133, v133, v137
    v_add_f32 v29, v29, v141
    v_add_f32 v134, v134, v138
    v_add_f32 v30, v30, v142
    v_add_f32 v135, v135, v139
    v_add_f32 v31, v31, v143
    v_add_f32 v28, v28, v132
    v_add_f32 v29, v29, v133
    v_add_f32 v30, v30, v134
    v_add_f32 v31, v31, v135
    v_cvt_pk_bf16_f32 v222, v28, v29
    v_cvt_pk_bf16_f32 v223, v30, v31
    s_nop 0
    v_permlane16_swap_b32 v220, v222
    v_permlane16_swap_b32 v221, v223
    buffer_store_dwordx4 v[220:223], v6, s[40:43], s63 offen offset:64
    s_waitcnt lgkmcnt(0)
    v_add_f32 v144, v144, v148
    v_add_f32 v32, v32, v152
    v_add_f32 v145, v145, v149
    v_add_f32 v33, v33, v153
    v_add_f32 v146, v146, v150
    v_add_f32 v34, v34, v154
    v_add_f32 v147, v147, v151
    v_add_f32 v35, v35, v155
    v_add_f32 v32, v32, v144
    v_add_f32 v33, v33, v145
    v_add_f32 v34, v34, v146
    v_add_f32 v35, v35, v147
    v_cvt_pk_bf16_f32 v224, v32, v33
    v_cvt_pk_bf16_f32 v225, v34, v35
    buffer_store_dwordx2 v[224:225], v8, s[40:43], s63 offen offset:128
L_end:
L_exit:
    s_endpgm
.section .rodata,"a"
.p2align 6
.amdhsa_kernel parallel_sum__softmax_full_mha__geglu_ffn__prompt_kernel
  .amdhsa_next_free_vgpr 256
  .amdhsa_next_free_sgpr 96
  .amdhsa_accum_offset 256
  .amdhsa_group_segment_fixed_size 0
  .amdhsa_kernarg_size 80
  .amdhsa_user_sgpr_count 2
  .amdhsa_user_sgpr_kernarg_segment_ptr 1
  .amdhsa_system_sgpr_workgroup_id_x 1
.end_amdhsa_kernel
```
